```python
import torch

def _softmax(x, axis=-1):
    return torch.softmax(x, dim=axis)
def _gelu(x):
    return torch.nn.functional.gelu(x, approximate="tanh")
def _silu(x):
    return torch.nn.functional.silu(x)
def _sigmoid(x):
    return torch.sigmoid(x)
def _layernorm(x, axis=-1, eps=1e-5):
    m = x.mean(dim=axis, keepdim=True)
    v = x.var(dim=axis, keepdim=True, unbiased=False)
    return (x - m) / torch.sqrt(v + eps)
def _scatter_add(tgt, idx, src, axis=0):
    return tgt.clone().index_add_(axis, idx, src)
def _segment_sum(src, seg, n):
    out = torch.zeros((n,) + src.shape[1:], dtype=src.dtype)
    return out.index_add_(0, seg, src)
def _pad(x, pw):
    flat = tuple(v for pair in reversed(pw) for v in pair)
    return torch.nn.functional.pad(x, flat)

kernel_name = 'sequential_preLN__sliding_local_dilated__dense_activation_gelu__prompt'

def setup_inputs():

    _w = (lambda a: (lambda t: t.to(torch.bfloat16) if t.is_floating_point() else t)(torch.as_tensor(a)))
    def _A_setup():
        B, S, D = 1, 2048, 576
        return {
            "x": _w((lambda *s: torch.randn(*s, dtype=torch.bfloat16) * 0.05)(B, S, D)),
            "wqkv": _w((lambda *s: torch.randn(*s, dtype=torch.bfloat16) * 0.05)(D, 3 * D)),
            "wo": _w((lambda *s: torch.randn(*s, dtype=torch.bfloat16) * 0.05)(D, D)),
        }
    _A_in = _A_setup()

    def _B_setup():
        B, S, D, F = 1, 2048, 576, 4608
        return {
            "x": _w((lambda *s: torch.randn(*s, dtype=torch.bfloat16) * 0.05)(B, S, D)),
            "w1": _w((lambda *s: torch.randn(*s, dtype=torch.bfloat16) * 0.8)(D, F) * (D ** -0.5)),
            "b1": _w((lambda *s: torch.randn(*s, dtype=torch.bfloat16) * 0.8)(F) * 0.01),
            "w2": _w((lambda *s: torch.randn(*s, dtype=torch.bfloat16) * 0.8)(F, D) * (F ** -0.5)),
            "b2": _w((lambda *s: torch.randn(*s, dtype=torch.bfloat16) * 0.8)(D) * 0.01),
        }
    _B_in = _B_setup()

    return {
        "A_x": _A_in["x"],
        "A_wqkv": _A_in["wqkv"],
        "A_wo": _A_in["wo"],
        "B_x": _B_in["x"],
        "B_w1": _B_in["w1"],
        "B_b1": _B_in["b1"],
        "B_w2": _B_in["w2"],
        "B_b2": _B_in["b2"],
    }

def reference(A_x, A_wqkv, A_wo, B_x, B_w1, B_b1, B_w2, B_b2):
    def _A_ref(x, wqkv, wo):
        B, S, D = x.shape
        H = 32; Dh = D // H
        W, dil = 8, 2
        qkv = (lambda x, *d: x.permute(*d))((x @ wqkv).reshape(B, S, 3, H, Dh), 2, 0, 3, 1, 4)
        q, k, v = qkv[0], qkv[1], qkv[2]
        scale = Dh ** -0.5
        pos = torch.arange(S)
        off = torch.arange(W) * dil
        idx = pos[:, None] - off[None, :]
        mask = idx >= 0
        idx_c = torch.where(mask, idx, 0).reshape(-1)
        kg = k[:, :, idx_c, :].reshape(B, H, S, W, Dh)
        vg = v[:, :, idx_c, :].reshape(B, H, S, W, Dh)
        logits = torch.einsum("bhsd,bhswd->bhsw", q, kg) * scale
        logits = torch.where(mask[None, None, :, :], logits, -1e9)
        attn = _softmax(logits, axis=-1)
        o = torch.einsum("bhsw,bhswd->bhsd", attn, vg)
        return (lambda x, *d: x.permute(*d))(o, 0, 2, 1, 3).reshape(B, S, D) @ wo

    def _B_ref(x, w1, b1, w2, b2):
        h = torch.einsum("bsd,df->bsf", x, w1) + b1
        h = _gelu(h)
        return torch.einsum("bsf,fd->bsd", h, w2) + b2

    x = A_x
    h = x + _A_ref(_layernorm(x, axis=-1), A_wqkv, A_wo)
    h2 = h + _B_ref(_layernorm(h, axis=-1), B_w1, B_b1, B_w2, B_b2)
    return h2
```

```asm
; @launch grid=(256,1,1) block=(256,1,1) lds=163840
.amdgcn_target "amdgcn-amd-amdhsa--gfx950"
.text
.p2align 12
.globl sequential_preLN__sliding_local_dilated__dense_activation_gelu__prompt_kernel
.p2align 8
.type sequential_preLN__sliding_local_dilated__dense_activation_gelu__prompt_kernel,@function
sequential_preLN__sliding_local_dilated__dense_activation_gelu__prompt_kernel:
    s_cmp_ge_u32 s2, 256
    s_cbranch_scc0 L_go
    s_endpgm
L_go:
    v_lshrrev_b32 v10, 6, v0
    v_and_b32 v1, 63, v0
    v_readfirstlane_b32 s46, v10
    v_lshlrev_b32 v2, 4, v1
    s_cmp_eq_u32 s46, 3
    s_cselect_b32 s49, 0, 8
    s_load_dwordx2 s[68:69], s[0:1], s49
    s_getpc_b64 s[52:53]
L_pc:
    s_lshr_b32 s49, s2, 3
    s_lshl_b32 s49, s49, 11
    v_lshrrev_b32 v11, 4, v0
    v_lshlrev_b32 v11, 7, v11
    v_add_u32 v11, s49, v11
    v_min_u32 v11, L_end-L_pc-4, v11
    global_load_dword v255, v11, s[52:53]
    s_load_dwordx2 s[4:5], s[0:1], 0
    s_load_dwordx2 s[24:25], s[0:1], 80
    s_load_dwordx2 s[32:33], s[0:1], 72
    s_load_dwordx2 s[16:17], s[0:1], 32
    s_load_dwordx2 s[20:21], s[0:1], 48
    s_load_dwordx2 s[12:13], s[0:1], 16
    s_load_dwordx2 s[28:29], s[0:1], 64
    s_load_dwordx2 s[36:37], s[0:1], 40
    s_load_dwordx2 s[40:41], s[0:1], 56
    s_and_b32 s45, s2, 3
    s_lshl_b32 s45, s45, 1
    s_lshr_b32 s44, s2, 3
    s_and_b32 s49, s44, 1
    s_add_u32 s45, s45, s49
    s_and_b32 s49, s2, 7
    s_lshr_b32 s49, s49, 2
    s_lshl_b32 s49, s49, 4
    s_lshr_b32 s44, s44, 1
    s_add_u32 s44, s44, s49
    s_add_u32 s57, s44, s45
    s_mul_i32 s49, s57, 57
    s_lshr_b32 s49, s49, 9
    s_mul_i32 s49, s49, 9
    s_sub_u32 s57, s57, s49
    s_movk_i32 s51, -144
    s_mov_b32 s71, 0x20000
    s_cmp_eq_u32 s46, 3
    s_cbranch_scc0 L_gemm
L_helper:
    v_lshrrev_b32 v10, 3, v1
    v_and_b32 v11, 6, v10
    v_xor_b32 v11, v11, v1
    v_and_b32 v11, 7, v11
    v_lshlrev_b32_e64 v11, 4, v11
    v_mul_u32_u24 v10, 1152, v10
    s_mul_i32 s49, s44, 73728
    v_add3_u32 v10, v10, v11, s49
    s_cmp_eq_u32 s44, 0
    s_cselect_b32 s49, 1073741824, 0
    v_add_u32 v88, 4294952960, v10
    v_add_u32 v89, 4294961152, v10
    v_add_u32 v90, 2048, v10
    v_add_u32 v91, 10240, v10
    v_add_u32 v92, 22528, v10
    v_add_u32 v93, 30720, v10
    v_add_u32 v94, 38912, v10
    v_add_u32 v95, 47104, v10
    v_add_u32 v96, 59392, v10
    v_add_u32 v97, 67584, v10
    v_add_u32 v88, s49, v88
    v_add_u32 v89, s49, v89
    s_mov_b32 s59, 27696
    s_mov_b32 s70, 2363392
    s_lshr_b32 s49, s2, 3
    s_lshl_b32 s50, s49, 2
    s_mov_b32 s66, 0x52666444
    s_mov_b32 s67, 0x8887
    s_lshr_b64 s[66:67], s[66:67], s50
    s_and_b32 s66, s66, 15
    s_lshl_b32 s50, s49, 1
    s_lshr_b32 s50, 0x500924, s50
    s_and_b32 s50, s50, 3
    s_sub_u32 s67, s49, 12
    s_cselect_b32 s50, s50, s67
    s_cselect_b32 s66, s66, 10
    s_lshl_b32 s49, s66, 3
    s_load_dwordx2 s[66:67], s[0:1], s49
    s_lshl_b32 s50, s50, 21
    v_mov_b32 v12, s50
    s_waitcnt lgkmcnt(0)
    s_sub_u32 s68, s68, 4096
    s_subb_u32 s69, s69, 0
    global_load_dword v255, v12, s[66:67] sc1
    s_lshl_b32 s65, s57, 7
    s_add_u32 s57, s57, 1
    s_cmp_eq_u32 s57, 9
    s_cselect_b32 s57, 0, s57
    s_add_u32 m0, s59, 48544
    s_nop 0
    buffer_load_dwordx4 v88, s[68:71], s65 offen offset:0 lds
    buffer_load_dwordx4 v89, s[68:71], s65 offen offset:1024 lds
    buffer_load_dwordx4 v90, s[68:71], s65 offen offset:2048 lds
    buffer_load_dwordx4 v91, s[68:71], s65 offen offset:3072 lds
    s_add_u32 m0, s59, 52640
    s_nop 0
    buffer_load_dwordx4 v92, s[68:71], s65 offen offset:0 lds
    buffer_load_dwordx4 v93, s[68:71], s65 offen offset:1024 lds
    buffer_load_dwordx4 v94, s[68:71], s65 offen offset:2048 lds
    buffer_load_dwordx4 v95, s[68:71], s65 offen offset:3072 lds
    s_add_u32 m0, s59, 56736
    s_nop 0
    buffer_load_dwordx4 v96, s[68:71], s65 offen offset:0 lds
    s_call_b64 s[84:85], L_tour0
    buffer_load_dwordx4 v97, s[68:71], s65 offen offset:1024 lds
    s_branch L_helper2
L_tour0:
    s_mov_b64 exec, 0
    s_cmp_eq_u32 s46, 0
    s_cbranch_scc1 L_pg0
    s_cmp_eq_u32 s46, 1
    s_cbranch_scc1 L_pg1
    s_cmp_eq_u32 s46, 2
    s_cbranch_scc1 L_pg2
    s_branch L_pg3
L_tourx:
    s_mov_b64 exec, -1
    s_setpc_b64 s[84:85]
L_gemm:
    s_movk_i32 s52, 3456
    v_add_u32 v10, 0, v1
    v_add_u32 v12, 0, v2
    v_mul_u32_u24 v11, 7282, v10
    v_lshrrev_b32_e64 v11, 16, v11
    v_mad_i32_i24 v12, v11, s51, v12
    v_bfe_u32 v13, v11, 1, 2
    v_and_or_b32 v13, v11, 56, v13
    v_and_b32_e64 v14, 1, v11
    v_lshl_or_b32 v13, v14, 2, v13
    v_mad_u32_u24 v88, v13, s52, v12
    v_add_u32 v10, 64, v1
    v_add_u32 v12, 0, v2
    v_mul_u32_u24 v11, 7282, v10
    v_lshrrev_b32_e64 v11, 16, v11
    v_mad_i32_i24 v12, v11, s51, v12
    v_bfe_u32 v13, v11, 1, 2
    v_and_or_b32 v13, v11, 56, v13
    v_and_b32_e64 v14, 1, v11
    v_lshl_or_b32 v13, v14, 2, v13
    v_mad_u32_u24 v89, v13, s52, v12
    v_add_u32 v10, 128, v1
    v_add_u32_e64 v12, 0, v2
    v_mul_u32_u24 v11, 7282, v10
    v_lshrrev_b32_e64 v11, 16, v11
    v_mad_i32_i24 v12, v11, s51, v12
    v_bfe_u32 v13, v11, 1, 2
    v_and_or_b32 v13, v11, 56, v13
    v_and_b32_e64 v14, 1, v11
    v_lshl_or_b32 v13, v14, 2, v13
    v_mad_u32_u24 v90, v13, s52, v12
    v_add_u32 v10, 192, v1
    v_add_u32_e64 v12, 0, v2
    v_mul_u32_u24 v11, 7282, v10
    v_lshrrev_b32_e64 v11, 16, v11
    v_mad_i32_i24 v12, v11, s51, v12
    v_bfe_u32 v13, v11, 1, 2
    v_and_or_b32 v13, v11, 56, v13
    v_and_b32_e64 v14, 1, v11
    v_lshl_or_b32 v13, v14, 2, v13
    v_mad_u32_u24 v91, v13, s52, v12
    v_add_u32 v10, 256, v1
    v_add_u32 v12, 4096, v2
    v_mul_u32_u24 v11, 7282, v10
    v_lshrrev_b32_e64 v11, 16, v11
    v_mad_i32_i24 v12, v11, s51, v12
    v_bfe_u32 v13, v11, 1, 2
    v_and_or_b32 v13, v11, 56, v13
    v_and_b32_e64 v14, 1, v11
    v_lshl_or_b32 v13, v14, 2, v13
    v_mad_u32_u24 v92, v13, s52, v12
    v_add_u32 v10, 320, v1
    v_add_u32 v12, 4096, v2
    v_mul_u32_u24 v11, 7282, v10
    v_lshrrev_b32_e64 v11, 16, v11
    v_mad_i32_i24 v12, v11, s51, v12
    v_bfe_u32 v13, v11, 1, 2
    v_and_or_b32 v13, v11, 56, v13
    v_and_b32_e64 v14, 1, v11
    v_lshl_or_b32 v13, v14, 2, v13
    v_mad_u32_u24 v93, v13, s52, v12
    v_add_u32 v10, 384, v1
    v_add_u32 v12, 4096, v2
    v_mul_u32_u24 v11, 7282, v10
    v_lshrrev_b32_e64 v11, 16, v11
    v_mad_i32_i24 v12, v11, s51, v12
    v_bfe_u32 v13, v11, 1, 2
    v_and_or_b32 v13, v11, 56, v13
    v_and_b32_e64 v14, 1, v11
    v_lshl_or_b32 v13, v14, 2, v13
    v_mad_u32_u24 v94, v13, s52, v12
    v_add_u32 v10, 448, v1
    v_add_u32 v12, 4096, v2
    v_mul_u32_u24 v11, 7282, v10
    v_lshrrev_b32_e64 v11, 16, v11
    v_mad_i32_i24 v12, v11, s51, v12
    v_bfe_u32 v13, v11, 1, 2
    v_and_or_b32 v13, v11, 56, v13
    v_and_b32_e64 v14, 1, v11
    v_lshl_or_b32 v13, v14, 2, v13
    v_mad_u32_u24 v95, v13, s52, v12
    v_add_u32 v10, 512, v1
    v_add_u32 v12, 8192, v2
    v_mul_u32_u24 v11, 7282, v10
    v_lshrrev_b32_e64 v11, 16, v11
    v_mad_i32_i24 v12, v11, s51, v12
    v_bfe_u32 v13, v11, 1, 2
    v_and_or_b32 v13, v11, 56, v13
    v_and_b32_e64 v14, 1, v11
    v_lshl_or_b32 v13, v14, 2, v13
    v_mad_u32_u24 v96, v13, s52, v12
    s_mul_i32 s58, s46, 1152
    s_mul_i32 s49, s45, 144
    s_add_u32 s58, s58, s49
    s_mul_i32 s59, s46, 9232
    s_mov_b32 s70, 1990656
    s_waitcnt lgkmcnt(0)
    s_mul_i32 s65, s57, 221184
    s_add_u32 s65, s65, s58
    s_add_u32 s57, s57, 1
    s_cmp_eq_u32 s57, 9
    s_cselect_b32 s57, 0, s57
    s_add_u32 m0, s59, 48544
    s_nop 0
    buffer_load_dwordx4 v88, s[68:71], s65 offen offset:0 lds
    buffer_load_dwordx4 v89, s[68:71], s65 offen offset:1024 lds
    buffer_load_dwordx4 v90, s[68:71], s65 offen offset:2048 lds
    buffer_load_dwordx4 v91, s[68:71], s65 offen offset:3072 lds
    s_add_u32 m0, s59, 52640
    s_nop 0
    buffer_load_dwordx4 v92, s[68:71], s65 offen offset:0 lds
    buffer_load_dwordx4 v93, s[68:71], s65 offen offset:1024 lds
    buffer_load_dwordx4 v94, s[68:71], s65 offen offset:2048 lds
    buffer_load_dwordx4 v95, s[68:71], s65 offen offset:3072 lds
    s_add_u32 m0, s59, 56736
    s_nop 0
    buffer_load_dwordx4 v96, s[68:71], s65 offen offset:0 lds
    s_call_b64 s[84:85], L_tour0
    v_lshrrev_b32_e64 v10, 2, v1
    v_mul_u32_u24 v10, 288, v10
    v_and_b32_e64 v11, 3, v1
    v_lshl_add_u32 v9, v11, 3, v10
    v_bfe_u32 v10, v1, 3, 1
    v_and_b32 v11, 7, v1
    v_lshlrev_b32 v11, 7, v11
    v_lshl_or_b32 v11, v10, 10, v11
    v_lshrrev_b32 v10, 4, v1
    v_and_b32 v12, 6, v1
    v_xor_b32_e64 v10, v10, v12
    v_lshl_or_b32 v108, v10, 4, v11
    v_xor_b32_e64 v109, 64, v108
    v_mov_b32 v110, 163680
    s_mov_b32 s72, 0x00010001
    s_mov_b32 s73, 0x00010001
    s_mov_b32 s26, 67108864
    s_mov_b32 s27, 0x20000
    v_add_u32_e64 v102, s59, v9
    v_add_u32 v104, 76240, v108
    v_add_u32 v105, 76240, v109
    v_add_u32 v98, 48544, v102
    v_cndmask_b32 v106, v104, v110, s[72:73]
    v_cndmask_b32 v107, v105, v110, s[72:73]
    s_mul_i32 s65, s57, 221184
    s_add_u32 s65, s65, s58
    s_add_u32 s57, s57, 1
    s_cmp_eq_u32 s57, 9
    s_cselect_b32 s57, 0, s57
    s_add_u32 m0, s59, 86496
    s_nop 0
    buffer_load_dwordx4 v88, s[68:71], s65 offen offset:0 lds
    buffer_load_dwordx4 v89, s[68:71], s65 offen offset:1024 lds
    buffer_load_dwordx4 v90, s[68:71], s65 offen offset:2048 lds
    buffer_load_dwordx4 v91, s[68:71], s65 offen offset:3072 lds
    s_add_u32 m0, s59, 90592
    s_nop 0
    buffer_load_dwordx4 v92, s[68:71], s65 offen offset:0 lds
    buffer_load_dwordx4 v93, s[68:71], s65 offen offset:1024 lds
    buffer_load_dwordx4 v94, s[68:71], s65 offen offset:2048 lds
    buffer_load_dwordx4 v95, s[68:71], s65 offen offset:3072 lds
    s_add_u32 m0, s59, 94688
    s_nop 0
    buffer_load_dwordx4 v96, s[68:71], s65 offen offset:0 lds
    s_waitcnt vmcnt(9) lgkmcnt(0)
    s_barrier
    s_mul_i32 s65, s57, 221184
    s_add_u32 s65, s65, s58
    s_add_u32 s57, s57, 1
    s_cmp_eq_u32 s57, 9
    s_cselect_b32 s57, 0, s57
    ds_read_b64_tr_b16 v[16:17], v98 offset:0
    ds_read_b64_tr_b16 v[18:19], v98 offset:144
    ds_read_b128 v[48:51], v106 offset:0
    ds_read_b128 v[52:55], v104 offset:2048
    ds_read_b128 v[56:59], v104 offset:4096
    ds_read_b128 v[60:63], v104 offset:6144
    ds_read_b128 v[64:67], v104 offset:8192
    ds_read_b64_tr_b16 v[20:21], v98 offset:32
    ds_read_b64_tr_b16 v[22:23], v98 offset:176
    ds_read_b64_tr_b16 v[24:25], v98 offset:64
    ds_read_b64_tr_b16 v[26:27], v98 offset:208
    ds_read_b64_tr_b16 v[28:29], v98 offset:96
    ds_read_b64_tr_b16 v[30:31], v98 offset:240
    s_add_u32 m0, s59, 124448
    s_nop 0
    buffer_load_dwordx4 v88, s[68:71], s65 offen offset:0 lds
    buffer_load_dwordx4 v89, s[68:71], s65 offen offset:1024 lds
    buffer_load_dwordx4 v90, s[68:71], s65 offen offset:2048 lds
    buffer_load_dwordx4 v91, s[68:71], s65 offen offset:3072 lds
    s_mov_b32 s34, 256
    s_mov_b32 s35, 0x20000
    s_mov_b32 s18, 5308416
    s_mov_b32 s19, 0x20000
    s_mov_b32 s22, 5308416
    s_mov_b32 s23, 0x20000
    s_mov_b32 s14, 663552
    s_mov_b32 s15, 0x20000
    s_mov_b32 s38, 9216
    s_mov_b32 s39, 0x20000
    v_and_b32 v246, 7, v1
    v_lshlrev_b32 v246, 4, v246
    v_lshrrev_b32_e64 v247, 3, v1
    v_mul_u32_u24 v248, 73728, v247
    v_add_u32_e64 v224, v248, v246
    v_lshl_add_u32 v223, v247, 1, v246
    v_lshl_or_b32 v0, v247, 8, v246
    v_lshlrev_b32 v225, 1, v1
    s_waitcnt lgkmcnt(0)
    v_mfma_f32_16x16x32_bf16 a[0:3], v[16:19], v[48:51], 0
    ds_read_b64_tr_b16 v[32:33], v98 offset:4608
    ds_read_b64_tr_b16 v[34:35], v98 offset:4752
    v_mfma_f32_16x16x32_bf16 a[4:7], v[16:19], v[52:55], 0
    ds_read_b128 v[68:71], v107 offset:0
    ds_read_b128 v[72:75], v105 offset:2048
    v_mfma_f32_16x16x32_bf16 a[8:11], v[16:19], v[56:59], 0
    ds_read_b128 v[76:79], v105 offset:4096
    ds_read_b128 v[80:83], v105 offset:6144
    v_mfma_f32_16x16x32_bf16 a[12:15], v[16:19], v[60:63], 0
    ds_read_b128 v[84:87], v105 offset:8192
    ds_read_b64_tr_b16 v[36:37], v98 offset:4640
    v_mfma_f32_16x16x32_bf16 a[16:19], v[16:19], v[64:67], 0
    ds_read_b64_tr_b16 v[38:39], v98 offset:4784
    ds_read_b64_tr_b16 v[40:41], v98 offset:4672
    v_mfma_f32_16x16x32_bf16 a[20:23], v[20:23], v[48:51], 0
    ds_read_b64_tr_b16 v[42:43], v98 offset:4816
    ds_read_b64_tr_b16 v[44:45], v98 offset:4704
    v_mfma_f32_16x16x32_bf16 a[24:27], v[20:23], v[52:55], 0
    ds_read_b64_tr_b16 v[46:47], v98 offset:4848
    s_add_u32 m0, s59, 128544
    s_nop 0
    buffer_load_dwordx4 v92, s[68:71], s65 offen offset:0 lds
    v_mfma_f32_16x16x32_bf16 a[28:31], v[20:23], v[56:59], 0
    v_bfe_u32 v248, v247, 1, 1
    v_and_or_b32 v248, v247, 4, v248
    v_mfma_f32_16x16x32_bf16 a[32:35], v[20:23], v[60:63], 0
    buffer_load_dwordx4 v93, s[68:71], s65 offen offset:1024 lds
    v_and_b32 v247, 1, v247
    v_lshl_or_b32 v248, v247, 5, v248
    v_mfma_f32_16x16x32_bf16 a[36:39], v[20:23], v[64:67], 0
    v_mul_u32_u24 v248, 1152, v248
    v_add_u32_e64 v226, v248, v246
    v_mfma_f32_16x16x32_bf16 a[40:43], v[24:27], v[48:51], 0
    s_mov_b32 s76, 0x05040100
    s_mov_b32 s77, 0x07060302
    v_mfma_f32_16x16x32_bf16 a[44:47], v[24:27], v[52:55], 0
    buffer_load_dwordx4 v94, s[68:71], s65 offen offset:2048 lds
    s_mul_i32 s78, s45, 1327104
    s_add_u32 s78, s78, 8388608
    v_mfma_f32_16x16x32_bf16 a[48:51], v[24:27], v[56:59], 0
    s_lshl_b32 s66, s46, 5
    s_add_u32 s10, s66, s44
    v_mfma_f32_16x16x32_bf16 a[52:55], v[24:27], v[60:63], 0
    s_sub_u32 s66, 127, s10
    v_mfma_f32_16x16x32_bf16 a[56:59], v[24:27], v[64:67], 0
    buffer_load_dwordx4 v95, s[68:71], s65 offen offset:3072 lds
    s_mov_b32 s11, s66
    s_mul_i32 s8, s66, 57
    v_mfma_f32_16x16x32_bf16 a[60:63], v[28:31], v[48:51], 0
    s_lshr_b32 s8, s8, 9
    s_mul_i32 s67, s8, 9
    v_mfma_f32_16x16x32_bf16 a[64:67], v[28:31], v[52:55], 0
    s_sub_u32 s9, s66, s67
    s_mul_i32 s79, s45, 9
    v_mfma_f32_16x16x32_bf16 a[68:71], v[28:31], v[56:59], 0
    s_add_u32 m0, s59, 132640
    s_nop 0
    buffer_load_dwordx4 v96, s[68:71], s65 offen offset:0 lds
    v_add_u32 v104, 114192, v108
    v_add_u32 v105, 114192, v109
    v_mfma_f32_16x16x32_bf16 a[72:75], v[28:31], v[60:63], 0
    v_add_u32 v98, 86496, v102
    v_cndmask_b32 v106, v104, v110, s[72:73]
    v_mfma_f32_16x16x32_bf16 a[76:79], v[28:31], v[64:67], 0
    v_cndmask_b32 v107, v105, v110, s[72:73]
    s_waitcnt vmcnt(9) lgkmcnt(0)
    s_barrier
    s_mul_i32 s65, s57, 221184
    s_add_u32 s65, s65, s58
    s_add_u32 s57, s57, 1
    s_cmp_eq_u32 s57, 9
    s_cselect_b32 s57, 0, s57
    v_mfma_f32_16x16x32_bf16 a[0:3], v[32:35], v[68:71], a[0:3]
    ds_read_b64_tr_b16 v[16:17], v98 offset:0
    ds_read_b64_tr_b16 v[18:19], v98 offset:144
    v_mfma_f32_16x16x32_bf16 a[4:7], v[32:35], v[72:75], a[4:7]
    ds_read_b128 v[48:51], v106 offset:0
    ds_read_b128 v[52:55], v104 offset:2048
    v_mfma_f32_16x16x32_bf16 a[8:11], v[32:35], v[76:79], a[8:11]
    ds_read_b128 v[56:59], v104 offset:4096
    ds_read_b128 v[60:63], v104 offset:6144
    v_mfma_f32_16x16x32_bf16 a[12:15], v[32:35], v[80:83], a[12:15]
    ds_read_b128 v[64:67], v104 offset:8192
    ds_read_b64_tr_b16 v[20:21], v98 offset:32
    v_mfma_f32_16x16x32_bf16 a[16:19], v[32:35], v[84:87], a[16:19]
    ds_read_b64_tr_b16 v[22:23], v98 offset:176
    ds_read_b64_tr_b16 v[24:25], v98 offset:64
    v_mfma_f32_16x16x32_bf16 a[20:23], v[36:39], v[68:71], a[20:23]
    ds_read_b64_tr_b16 v[26:27], v98 offset:208
    ds_read_b64_tr_b16 v[28:29], v98 offset:96
    v_mfma_f32_16x16x32_bf16 a[24:27], v[36:39], v[72:75], a[24:27]
    ds_read_b64_tr_b16 v[30:31], v98 offset:240
    s_add_u32 m0, s59, 48544
    s_nop 0
    buffer_load_dwordx4 v88, s[68:71], s65 offen offset:0 lds
    v_mfma_f32_16x16x32_bf16 a[28:31], v[36:39], v[76:79], a[28:31]
    s_add_u32 s79, s79, s9
    s_mul_i32 s79, s79, 73728
    v_mfma_f32_16x16x32_bf16 a[32:35], v[36:39], v[80:83], a[32:35]
    s_lshl_b32 s67, s8, 7
    v_mfma_f32_16x16x32_bf16 a[36:39], v[36:39], v[84:87], a[36:39]
    buffer_load_dwordx4 v89, s[68:71], s65 offen offset:1024 lds
    s_add_u32 s79, s79, s67
    s_lshl_b32 s64, s11, 11
    v_mfma_f32_16x16x32_bf16 a[40:43], v[40:43], v[68:71], a[40:43]
    s_add_u32 s64, s64, s78
    v_mfma_f32_16x16x32_bf16 a[44:47], v[40:43], v[72:75], a[44:47]
    s_add_u32 s64, s64, 165888
    v_mfma_f32_16x16x32_bf16 a[48:51], v[40:43], v[76:79], a[48:51]
    s_cmp_lt_u32 s11, 81
    s_cselect_b32 s79, s79, 1073741824
    s_cselect_b32 s64, s64, 1073741824
    s_mov_b32 s66, s10
    v_mfma_f32_16x16x32_bf16 a[52:55], v[40:43], v[80:83], a[52:55]
    buffer_load_dwordx4 v90, s[68:71], s65 offen offset:2048 lds
    s_mul_i32 s8, s66, 57
    v_mfma_f32_16x16x32_bf16 a[56:59], v[40:43], v[84:87], a[56:59]
    s_lshr_b32 s8, s8, 9
    s_mul_i32 s67, s8, 9
    v_mfma_f32_16x16x32_bf16 a[60:63], v[44:47], v[68:71], a[60:63]
    s_sub_u32 s9, s66, s67
    v_mfma_f32_16x16x32_bf16 a[64:67], v[44:47], v[72:75], a[64:67]
    buffer_load_dwordx4 v91, s[68:71], s65 offen offset:3072 lds
    s_lshl_b32 s67, s8, 7
    v_mfma_f32_16x16x32_bf16 a[68:71], v[44:47], v[76:79], a[68:71]
    s_mul_i32 s75, s45, 1152
    s_add_u32 s75, s75, s67
    v_mfma_f32_16x16x32_bf16 a[72:75], v[44:47], v[80:83], a[72:75]
    s_mul_i32 s74, s9, 589824
    v_mfma_f32_16x16x32_bf16 a[76:79], v[44:47], v[84:87], a[76:79]
    s_add_u32 s74, s74, s75
    s_waitcnt lgkmcnt(0)
    v_mfma_f32_16x16x32_bf16 a[0:3], v[16:19], v[48:51], a[0:3]
    ds_read_b64_tr_b16 v[32:33], v98 offset:4608
    ds_read_b64_tr_b16 v[34:35], v98 offset:4752
    v_mfma_f32_16x16x32_bf16 a[4:7], v[16:19], v[52:55], a[4:7]
    ds_read_b128 v[68:71], v107 offset:0
    ds_read_b128 v[72:75], v105 offset:2048
    v_mfma_f32_16x16x32_bf16 a[8:11], v[16:19], v[56:59], a[8:11]
    ds_read_b128 v[76:79], v105 offset:4096
    ds_read_b128 v[80:83], v105 offset:6144
    v_mfma_f32_16x16x32_bf16 a[12:15], v[16:19], v[60:63], a[12:15]
    ds_read_b128 v[84:87], v105 offset:8192
    ds_read_b64_tr_b16 v[36:37], v98 offset:4640
    v_mfma_f32_16x16x32_bf16 a[16:19], v[16:19], v[64:67], a[16:19]
    ds_read_b64_tr_b16 v[38:39], v98 offset:4784
    ds_read_b64_tr_b16 v[40:41], v98 offset:4672
    v_mfma_f32_16x16x32_bf16 a[20:23], v[20:23], v[48:51], a[20:23]
    ds_read_b64_tr_b16 v[42:43], v98 offset:4816
    ds_read_b64_tr_b16 v[44:45], v98 offset:4704
    v_mfma_f32_16x16x32_bf16 a[24:27], v[20:23], v[52:55], a[24:27]
    ds_read_b64_tr_b16 v[46:47], v98 offset:4848
    s_add_u32 m0, s59, 52640
    s_nop 0
    buffer_load_dwordx4 v92, s[68:71], s65 offen offset:0 lds
    v_mfma_f32_16x16x32_bf16 a[28:31], v[20:23], v[56:59], a[28:31]
    s_cmp_lt_u32 s10, 81
    s_cselect_b32 s74, s74, 1073741824
    s_cselect_b32 s75, s75, 1073741824
    v_mov_b32 v248, 0x3f803f80
L_pg0:
    s_cbranch_execz L_pg4
    v_mfma_f32_16x16x32_bf16 a[32:35], v[20:23], v[60:63], a[32:35]
    buffer_load_dwordx4 v93, s[68:71], s65 offen offset:1024 lds
    s_mov_b32 s66, 0x10001
    s_mov_b32 s67, 0x10001
    v_mfma_f32_16x16x32_bf16 a[36:39], v[20:23], v[64:67], a[36:39]
    v_cndmask_b32 v247, 0, v248, s[66:67]
    v_accvgpr_write_b32 a96, v247
    v_mfma_f32_16x16x32_bf16 a[40:43], v[24:27], v[48:51], a[40:43]
    v_accvgpr_write_b32 a97, v247
    v_accvgpr_write_b32 a98, v247
    v_mfma_f32_16x16x32_bf16 a[44:47], v[24:27], v[52:55], a[44:47]
    buffer_load_dwordx4 v94, s[68:71], s65 offen offset:2048 lds
    v_accvgpr_write_b32 a99, v247
    s_mov_b32 s66, 0x20002
    v_mfma_f32_16x16x32_bf16 a[48:51], v[24:27], v[56:59], a[48:51]
    s_mov_b32 s67, 0x20002
    v_cndmask_b32 v247, 0, v248, s[66:67]
    v_mfma_f32_16x16x32_bf16 a[52:55], v[24:27], v[60:63], a[52:55]
    v_accvgpr_write_b32 a100, v247
    v_mfma_f32_16x16x32_bf16 a[56:59], v[24:27], v[64:67], a[56:59]
    buffer_load_dwordx4 v95, s[68:71], s65 offen offset:3072 lds
    v_accvgpr_write_b32 a101, v247
    v_accvgpr_write_b32 a102, v247
    v_mfma_f32_16x16x32_bf16 a[60:63], v[28:31], v[48:51], a[60:63]
    v_accvgpr_write_b32 a103, v247
    s_mov_b32 s66, 0x100010
    v_mfma_f32_16x16x32_bf16 a[64:67], v[28:31], v[52:55], a[64:67]
    s_mov_b32 s67, 0x100010
    v_cndmask_b32 v247, 0, v248, s[66:67]
    v_mfma_f32_16x16x32_bf16 a[68:71], v[28:31], v[56:59], a[68:71]
    s_add_u32 m0, s59, 56736
    s_nop 0
    buffer_load_dwordx4 v96, s[68:71], s65 offen offset:0 lds
    v_add_u32 v104, 152144, v108
    v_add_u32 v105, 152144, v109
    v_mfma_f32_16x16x32_bf16 a[72:75], v[28:31], v[60:63], a[72:75]
    v_add_u32 v98, 124448, v102
    v_cndmask_b32 v106, v104, v110, s[72:73]
    v_mfma_f32_16x16x32_bf16 a[76:79], v[28:31], v[64:67], a[76:79]
    v_cndmask_b32 v107, v105, v110, s[72:73]
    s_waitcnt vmcnt(9) lgkmcnt(0)
    s_barrier
    s_mul_i32 s65, s57, 221184
    s_add_u32 s65, s65, s58
    s_add_u32 s57, s57, 1
    s_cmp_eq_u32 s57, 9
    s_cselect_b32 s57, 0, s57
    v_mfma_f32_16x16x32_bf16 a[0:3], v[32:35], v[68:71], a[0:3]
    ds_read_b64_tr_b16 v[16:17], v98 offset:0
    ds_read_b64_tr_b16 v[18:19], v98 offset:144
    v_mfma_f32_16x16x32_bf16 a[4:7], v[32:35], v[72:75], a[4:7]
    ds_read_b128 v[48:51], v106 offset:0
    ds_read_b128 v[52:55], v104 offset:2048
    v_mfma_f32_16x16x32_bf16 a[8:11], v[32:35], v[76:79], a[8:11]
    ds_read_b128 v[56:59], v104 offset:4096
    ds_read_b128 v[60:63], v104 offset:6144
    v_mfma_f32_16x16x32_bf16 a[12:15], v[32:35], v[80:83], a[12:15]
    ds_read_b128 v[64:67], v104 offset:8192
    ds_read_b64_tr_b16 v[20:21], v98 offset:32
    v_mfma_f32_16x16x32_bf16 a[16:19], v[32:35], v[84:87], a[16:19]
    ds_read_b64_tr_b16 v[22:23], v98 offset:176
    ds_read_b64_tr_b16 v[24:25], v98 offset:64
    v_mfma_f32_16x16x32_bf16 a[20:23], v[36:39], v[68:71], a[20:23]
    ds_read_b64_tr_b16 v[26:27], v98 offset:208
    ds_read_b64_tr_b16 v[28:29], v98 offset:96
    v_mfma_f32_16x16x32_bf16 a[24:27], v[36:39], v[72:75], a[24:27]
    ds_read_b64_tr_b16 v[30:31], v98 offset:240
    s_add_u32 m0, s59, 86496
    s_nop 0
    buffer_load_dwordx4 v88, s[68:71], s65 offen offset:0 lds
    v_mfma_f32_16x16x32_bf16 a[28:31], v[36:39], v[76:79], a[28:31]
    v_accvgpr_write_b32 a104, v247
    v_accvgpr_write_b32 a105, v247
    v_mfma_f32_16x16x32_bf16 a[32:35], v[36:39], v[80:83], a[32:35]
    v_accvgpr_write_b32 a106, v247
    v_mfma_f32_16x16x32_bf16 a[36:39], v[36:39], v[84:87], a[36:39]
    buffer_load_dwordx4 v89, s[68:71], s65 offen offset:1024 lds
    v_accvgpr_write_b32 a107, v247
    s_mov_b32 s66, 0x200020
    v_mfma_f32_16x16x32_bf16 a[40:43], v[40:43], v[68:71], a[40:43]
    s_mov_b32 s67, 0x200020
    v_mfma_f32_16x16x32_bf16 a[44:47], v[40:43], v[72:75], a[44:47]
    v_cndmask_b32 v247, 0, v248, s[66:67]
    v_mfma_f32_16x16x32_bf16 a[48:51], v[40:43], v[76:79], a[48:51]
    v_accvgpr_write_b32 a108, v247
    v_accvgpr_write_b32 a109, v247
    v_mfma_f32_16x16x32_bf16 a[52:55], v[40:43], v[80:83], a[52:55]
    buffer_load_dwordx4 v90, s[68:71], s65 offen offset:2048 lds
    v_accvgpr_write_b32 a110, v247
    v_mfma_f32_16x16x32_bf16 a[56:59], v[40:43], v[84:87], a[56:59]
    v_accvgpr_write_b32 a111, v247
    s_mov_b32 s66, 0x1000100
    v_mfma_f32_16x16x32_bf16 a[60:63], v[44:47], v[68:71], a[60:63]
    s_mov_b32 s67, 0x1000100
    v_mfma_f32_16x16x32_bf16 a[64:67], v[44:47], v[72:75], a[64:67]
    buffer_load_dwordx4 v91, s[68:71], s65 offen offset:3072 lds
    v_cndmask_b32 v247, 0, v248, s[66:67]
    v_mfma_f32_16x16x32_bf16 a[68:71], v[44:47], v[76:79], a[68:71]
    v_accvgpr_write_b32 a112, v247
    v_accvgpr_write_b32 a113, v247
    v_mfma_f32_16x16x32_bf16 a[72:75], v[44:47], v[80:83], a[72:75]
    v_accvgpr_write_b32 a114, v247
    v_mfma_f32_16x16x32_bf16 a[76:79], v[44:47], v[84:87], a[76:79]
    v_accvgpr_write_b32 a115, v247
    s_waitcnt lgkmcnt(0)
    v_mfma_f32_16x16x32_bf16 a[0:3], v[16:19], v[48:51], a[0:3]
    ds_read_b64_tr_b16 v[32:33], v98 offset:4608
    ds_read_b64_tr_b16 v[34:35], v98 offset:4752
    v_mfma_f32_16x16x32_bf16 a[4:7], v[16:19], v[52:55], a[4:7]
    ds_read_b128 v[68:71], v107 offset:0
    ds_read_b128 v[72:75], v105 offset:2048
    v_mfma_f32_16x16x32_bf16 a[8:11], v[16:19], v[56:59], a[8:11]
    ds_read_b128 v[76:79], v105 offset:4096
    ds_read_b128 v[80:83], v105 offset:6144
    v_mfma_f32_16x16x32_bf16 a[12:15], v[16:19], v[60:63], a[12:15]
    ds_read_b128 v[84:87], v105 offset:8192
    ds_read_b64_tr_b16 v[36:37], v98 offset:4640
    v_mfma_f32_16x16x32_bf16 a[16:19], v[16:19], v[64:67], a[16:19]
    ds_read_b64_tr_b16 v[38:39], v98 offset:4784
    ds_read_b64_tr_b16 v[40:41], v98 offset:4672
    v_mfma_f32_16x16x32_bf16 a[20:23], v[20:23], v[48:51], a[20:23]
    ds_read_b64_tr_b16 v[42:43], v98 offset:4816
    ds_read_b64_tr_b16 v[44:45], v98 offset:4704
    v_mfma_f32_16x16x32_bf16 a[24:27], v[20:23], v[52:55], a[24:27]
    ds_read_b64_tr_b16 v[46:47], v98 offset:4848
    s_add_u32 m0, s59, 90592
    s_nop 0
    buffer_load_dwordx4 v92, s[68:71], s65 offen offset:0 lds
    v_mfma_f32_16x16x32_bf16 a[28:31], v[20:23], v[56:59], a[28:31]
    s_mov_b32 s66, 0x2000200
    s_mov_b32 s67, 0x2000200
    v_mfma_f32_16x16x32_bf16 a[32:35], v[20:23], v[60:63], a[32:35]
    buffer_load_dwordx4 v93, s[68:71], s65 offen offset:1024 lds
    v_cndmask_b32 v247, 0, v248, s[66:67]
    v_accvgpr_write_b32 a116, v247
    v_mfma_f32_16x16x32_bf16 a[36:39], v[20:23], v[64:67], a[36:39]
    v_accvgpr_write_b32 a117, v247
    v_accvgpr_write_b32 a118, v247
    v_mfma_f32_16x16x32_bf16 a[40:43], v[24:27], v[48:51], a[40:43]
    v_accvgpr_write_b32 a119, v247
    s_mov_b32 s66, 0x10001000
    v_mfma_f32_16x16x32_bf16 a[44:47], v[24:27], v[52:55], a[44:47]
    buffer_load_dwordx4 v94, s[68:71], s65 offen offset:2048 lds
    s_mov_b32 s67, 0x10001000
    v_mfma_f32_16x16x32_bf16 a[48:51], v[24:27], v[56:59], a[48:51]
    v_cndmask_b32 v247, 0, v248, s[66:67]
    v_accvgpr_write_b32 a120, v247
    v_mfma_f32_16x16x32_bf16 a[52:55], v[24:27], v[60:63], a[52:55]
    v_accvgpr_write_b32 a121, v247
    v_accvgpr_write_b32 a122, v247
    v_mfma_f32_16x16x32_bf16 a[56:59], v[24:27], v[64:67], a[56:59]
    buffer_load_dwordx4 v95, s[68:71], s65 offen offset:3072 lds
    v_accvgpr_write_b32 a123, v247
    s_mov_b32 s66, 0x20002000
    v_mfma_f32_16x16x32_bf16 a[60:63], v[28:31], v[48:51], a[60:63]
    s_mov_b32 s67, 0x20002000
    v_mfma_f32_16x16x32_bf16 a[64:67], v[28:31], v[52:55], a[64:67]
    v_cndmask_b32 v247, 0, v248, s[66:67]
    v_accvgpr_write_b32 a124, v247
    v_mfma_f32_16x16x32_bf16 a[68:71], v[28:31], v[56:59], a[68:71]
    s_add_u32 m0, s59, 94688
    s_nop 0
    buffer_load_dwordx4 v96, s[68:71], s65 offen offset:0 lds
    v_add_u32 v104, 76240, v108
    v_add_u32 v105, 76240, v109
    v_mfma_f32_16x16x32_bf16 a[72:75], v[28:31], v[60:63], a[72:75]
    v_add_u32 v98, 48544, v102
    v_cndmask_b32 v106, v104, v110, s[72:73]
    v_mfma_f32_16x16x32_bf16 a[76:79], v[28:31], v[64:67], a[76:79]
    v_cndmask_b32 v107, v105, v110, s[72:73]
    s_waitcnt vmcnt(9) lgkmcnt(0)
    s_barrier
    s_mul_i32 s65, s57, 221184
    s_add_u32 s65, s65, s58
    s_add_u32 s57, s57, 1
    s_cmp_eq_u32 s57, 9
    s_cselect_b32 s57, 0, s57
    v_mfma_f32_16x16x32_bf16 a[0:3], v[32:35], v[68:71], a[0:3]
    ds_read_b64_tr_b16 v[16:17], v98 offset:0
    ds_read_b64_tr_b16 v[18:19], v98 offset:144
    v_mfma_f32_16x16x32_bf16 a[4:7], v[32:35], v[72:75], a[4:7]
    ds_read_b128 v[48:51], v106 offset:0
    ds_read_b128 v[52:55], v104 offset:2048
    v_mfma_f32_16x16x32_bf16 a[8:11], v[32:35], v[76:79], a[8:11]
    ds_read_b128 v[56:59], v104 offset:4096
    ds_read_b128 v[60:63], v104 offset:6144
    v_mfma_f32_16x16x32_bf16 a[12:15], v[32:35], v[80:83], a[12:15]
    ds_read_b128 v[64:67], v104 offset:8192
    ds_read_b64_tr_b16 v[20:21], v98 offset:32
    v_mfma_f32_16x16x32_bf16 a[16:19], v[32:35], v[84:87], a[16:19]
    ds_read_b64_tr_b16 v[22:23], v98 offset:176
    ds_read_b64_tr_b16 v[24:25], v98 offset:64
    v_mfma_f32_16x16x32_bf16 a[20:23], v[36:39], v[68:71], a[20:23]
    ds_read_b64_tr_b16 v[26:27], v98 offset:208
    ds_read_b64_tr_b16 v[28:29], v98 offset:96
    v_mfma_f32_16x16x32_bf16 a[24:27], v[36:39], v[72:75], a[24:27]
    ds_read_b64_tr_b16 v[30:31], v98 offset:240
    s_add_u32 m0, s59, 124448
    s_nop 0
    buffer_load_dwordx4 v88, s[68:71], s65 offen offset:0 lds
    v_mfma_f32_16x16x32_bf16 a[28:31], v[36:39], v[76:79], a[28:31]
    v_accvgpr_write_b32 a125, v247
    v_accvgpr_write_b32 a126, v247
    v_mfma_f32_16x16x32_bf16 a[32:35], v[36:39], v[80:83], a[32:35]
    v_accvgpr_write_b32 a127, v247
    v_mfma_f32_16x16x32_bf16 a[36:39], v[36:39], v[84:87], a[36:39]
    buffer_load_dwordx4 v89, s[68:71], s65 offen offset:1024 lds
    s_mov_b32 s80, 0xff00ff00
    s_mov_b32 s81, 0xff00ff00
    v_mfma_f32_16x16x32_bf16 a[40:43], v[40:43], v[68:71], a[40:43]
    s_movk_i32 s66, 1152
    v_mfma_f32_16x16x32_bf16 a[44:47], v[40:43], v[72:75], a[44:47]
    s_mul_i32 s55, s45, 144
    v_mfma_f32_16x16x32_bf16 a[48:51], v[40:43], v[76:79], a[48:51]
    s_mul_i32 s60, s46, 165888
    s_add_u32 s60, s60, s55
    v_mfma_f32_16x16x32_bf16 a[52:55], v[40:43], v[80:83], a[52:55]
    buffer_load_dwordx4 v90, s[68:71], s65 offen offset:2048 lds
    s_add_u32 s61, s60, 82944
    v_mfma_f32_16x16x32_bf16 a[56:59], v[40:43], v[84:87], a[56:59]
    s_mul_i32 s54, s46, 18432
    s_lshl_b32 s56, s46, 10
    v_mfma_f32_16x16x32_bf16 a[60:63], v[44:47], v[68:71], a[60:63]
    v_add_u32 v246, 0, v1
    v_mfma_f32_16x16x32_bf16 a[64:67], v[44:47], v[72:75], a[64:67]
    buffer_load_dwordx4 v91, s[68:71], s65 offen offset:3072 lds
    v_add_u32_e64 v248, 0, v2
    v_mfma_f32_16x16x32_bf16 a[68:71], v[44:47], v[76:79], a[68:71]
    v_mul_u32_u24 v247, 7282, v246
    v_lshrrev_b32_e64 v247, 16, v247
    v_mfma_f32_16x16x32_bf16 a[72:75], v[44:47], v[80:83], a[72:75]
    v_mad_i32_i24 v248, v247, s51, v248
    v_mfma_f32_16x16x32_bf16 a[76:79], v[44:47], v[84:87], a[76:79]
    v_bfe_u32 v249, v247, 1, 2
    s_waitcnt lgkmcnt(0)
    v_mfma_f32_16x16x32_bf16 a[0:3], v[16:19], v[48:51], a[0:3]
    ds_read_b64_tr_b16 v[32:33], v98 offset:4608
    ds_read_b64_tr_b16 v[34:35], v98 offset:4752
    v_mfma_f32_16x16x32_bf16 a[4:7], v[16:19], v[52:55], a[4:7]
    ds_read_b128 v[68:71], v107 offset:0
    ds_read_b128 v[72:75], v105 offset:2048
    v_mfma_f32_16x16x32_bf16 a[8:11], v[16:19], v[56:59], a[8:11]
    ds_read_b128 v[76:79], v105 offset:4096
    ds_read_b128 v[80:83], v105 offset:6144
    v_mfma_f32_16x16x32_bf16 a[12:15], v[16:19], v[60:63], a[12:15]
    ds_read_b128 v[84:87], v105 offset:8192
    ds_read_b64_tr_b16 v[36:37], v98 offset:4640
    v_mfma_f32_16x16x32_bf16 a[16:19], v[16:19], v[64:67], a[16:19]
    ds_read_b64_tr_b16 v[38:39], v98 offset:4784
    ds_read_b64_tr_b16 v[40:41], v98 offset:4672
    v_mfma_f32_16x16x32_bf16 a[20:23], v[20:23], v[48:51], a[20:23]
    ds_read_b64_tr_b16 v[42:43], v98 offset:4816
    ds_read_b64_tr_b16 v[44:45], v98 offset:4704
    v_mfma_f32_16x16x32_bf16 a[24:27], v[20:23], v[52:55], a[24:27]
    ds_read_b64_tr_b16 v[46:47], v98 offset:4848
    s_add_u32 m0, s59, 128544
    s_nop 0
    buffer_load_dwordx4 v92, s[68:71], s65 offen offset:0 lds
    v_mfma_f32_16x16x32_bf16 a[28:31], v[20:23], v[56:59], a[28:31]
    v_and_b32_e64 v250, 1, v247
    v_lshl_or_b32 v249, v250, 2, v249
    v_mfma_f32_16x16x32_bf16 a[32:35], v[20:23], v[60:63], a[32:35]
    buffer_load_dwordx4 v93, s[68:71], s65 offen offset:1024 lds
    v_lshrrev_b32_e64 v250, 5, v247
    v_lshl_or_b32 v249, v250, 3, v249
    v_mfma_f32_16x16x32_bf16 a[36:39], v[20:23], v[64:67], a[36:39]
    v_bfe_u32 v250, v247, 3, 2
    v_mad_u32_u24 v249, v250, 18, v249
    v_mfma_f32_16x16x32_bf16 a[40:43], v[24:27], v[48:51], a[40:43]
    v_bfe_u32 v250, v247, 3, 1
    v_lshl_add_u32 v249, v250, 1, v249
    v_mfma_f32_16x16x32_bf16 a[44:47], v[24:27], v[52:55], a[44:47]
    buffer_load_dwordx4 v94, s[68:71], s65 offen offset:2048 lds
    v_mad_u32_u24 v228, v249, s66, v248
    v_mfma_f32_16x16x32_bf16 a[48:51], v[24:27], v[56:59], a[48:51]
    v_add_u32 v246, 64, v1
    v_add_u32 v248, 0, v2
    v_mfma_f32_16x16x32_bf16 a[52:55], v[24:27], v[60:63], a[52:55]
    v_mul_u32_u24 v247, 7282, v246
    v_lshrrev_b32_e64 v247, 16, v247
    v_mfma_f32_16x16x32_bf16 a[56:59], v[24:27], v[64:67], a[56:59]
    buffer_load_dwordx4 v95, s[68:71], s65 offen offset:3072 lds
    v_mad_i32_i24 v248, v247, s51, v248
    v_bfe_u32 v249, v247, 1, 2
    v_mfma_f32_16x16x32_bf16 a[60:63], v[28:31], v[48:51], a[60:63]
    v_and_b32_e64 v250, 1, v247
    v_mfma_f32_16x16x32_bf16 a[64:67], v[28:31], v[52:55], a[64:67]
    v_lshl_or_b32 v249, v250, 2, v249
    v_lshrrev_b32_e64 v250, 5, v247
    v_mfma_f32_16x16x32_bf16 a[68:71], v[28:31], v[56:59], a[68:71]
    s_add_u32 m0, s59, 132640
    s_nop 0
    buffer_load_dwordx4 v96, s[68:71], s65 offen offset:0 lds
    v_add_u32 v104, 114192, v108
    v_add_u32 v105, 114192, v109
    v_mfma_f32_16x16x32_bf16 a[72:75], v[28:31], v[60:63], a[72:75]
    v_add_u32 v98, 86496, v102
    v_cndmask_b32 v106, v104, v110, s[72:73]
    v_mfma_f32_16x16x32_bf16 a[76:79], v[28:31], v[64:67], a[76:79]
    v_cndmask_b32 v107, v105, v110, s[72:73]
    s_waitcnt vmcnt(9) lgkmcnt(0)
    s_barrier
    s_mul_i32 s65, s57, 221184
    s_add_u32 s65, s65, s58
    s_add_u32 s57, s57, 1
    s_cmp_eq_u32 s57, 9
    s_cselect_b32 s57, 0, s57
    v_mfma_f32_16x16x32_bf16 a[0:3], v[32:35], v[68:71], a[0:3]
    ds_read_b64_tr_b16 v[16:17], v98 offset:0
    ds_read_b64_tr_b16 v[18:19], v98 offset:144
    v_mfma_f32_16x16x32_bf16 a[4:7], v[32:35], v[72:75], a[4:7]
    ds_read_b128 v[48:51], v106 offset:0
    ds_read_b128 v[52:55], v104 offset:2048
    v_mfma_f32_16x16x32_bf16 a[8:11], v[32:35], v[76:79], a[8:11]
    ds_read_b128 v[56:59], v104 offset:4096
    ds_read_b128 v[60:63], v104 offset:6144
    v_mfma_f32_16x16x32_bf16 a[12:15], v[32:35], v[80:83], a[12:15]
    ds_read_b128 v[64:67], v104 offset:8192
    ds_read_b64_tr_b16 v[20:21], v98 offset:32
    v_mfma_f32_16x16x32_bf16 a[16:19], v[32:35], v[84:87], a[16:19]
    ds_read_b64_tr_b16 v[22:23], v98 offset:176
    ds_read_b64_tr_b16 v[24:25], v98 offset:64
    v_mfma_f32_16x16x32_bf16 a[20:23], v[36:39], v[68:71], a[20:23]
    ds_read_b64_tr_b16 v[26:27], v98 offset:208
    ds_read_b64_tr_b16 v[28:29], v98 offset:96
    v_mfma_f32_16x16x32_bf16 a[24:27], v[36:39], v[72:75], a[24:27]
    ds_read_b64_tr_b16 v[30:31], v98 offset:240
    s_add_u32 m0, s59, 48544
    s_nop 0
    buffer_load_dwordx4 v88, s[68:71], s65 offen offset:0 lds
    v_mfma_f32_16x16x32_bf16 a[28:31], v[36:39], v[76:79], a[28:31]
    v_lshl_or_b32 v249, v250, 3, v249
    v_bfe_u32 v250, v247, 3, 2
    v_mfma_f32_16x16x32_bf16 a[32:35], v[36:39], v[80:83], a[32:35]
    v_mad_u32_u24 v249, v250, 18, v249
    v_mfma_f32_16x16x32_bf16 a[36:39], v[36:39], v[84:87], a[36:39]
    buffer_load_dwordx4 v89, s[68:71], s65 offen offset:1024 lds
    v_bfe_u32 v250, v247, 3, 1
    v_lshl_add_u32 v249, v250, 1, v249
    v_mfma_f32_16x16x32_bf16 a[40:43], v[40:43], v[68:71], a[40:43]
    v_mad_u32_u24 v229, v249, s66, v248
    v_mfma_f32_16x16x32_bf16 a[44:47], v[40:43], v[72:75], a[44:47]
    v_add_u32 v246, 128, v1
    v_mfma_f32_16x16x32_bf16 a[48:51], v[40:43], v[76:79], a[48:51]
    v_add_u32_e64 v248, 0, v2
    v_mul_u32_u24 v247, 7282, v246
    v_mfma_f32_16x16x32_bf16 a[52:55], v[40:43], v[80:83], a[52:55]
    buffer_load_dwordx4 v90, s[68:71], s65 offen offset:2048 lds
    v_lshrrev_b32_e64 v247, 16, v247
    v_mfma_f32_16x16x32_bf16 a[56:59], v[40:43], v[84:87], a[56:59]
    v_mad_i32_i24 v248, v247, s51, v248
    v_bfe_u32 v249, v247, 1, 2
    v_mfma_f32_16x16x32_bf16 a[60:63], v[44:47], v[68:71], a[60:63]
    v_and_b32_e64 v250, 1, v247
    v_mfma_f32_16x16x32_bf16 a[64:67], v[44:47], v[72:75], a[64:67]
    buffer_load_dwordx4 v91, s[68:71], s65 offen offset:3072 lds
    v_lshl_or_b32 v249, v250, 2, v249
    v_mfma_f32_16x16x32_bf16 a[68:71], v[44:47], v[76:79], a[68:71]
    v_lshrrev_b32_e64 v250, 5, v247
    v_lshl_or_b32 v249, v250, 3, v249
    v_mfma_f32_16x16x32_bf16 a[72:75], v[44:47], v[80:83], a[72:75]
    v_bfe_u32 v250, v247, 3, 2
    v_mfma_f32_16x16x32_bf16 a[76:79], v[44:47], v[84:87], a[76:79]
    v_mad_u32_u24 v249, v250, 18, v249
    s_waitcnt lgkmcnt(0)
    v_mfma_f32_16x16x32_bf16 a[0:3], v[16:19], v[48:51], a[0:3]
    ds_read_b64_tr_b16 v[32:33], v98 offset:4608
    ds_read_b64_tr_b16 v[34:35], v98 offset:4752
    v_mfma_f32_16x16x32_bf16 a[4:7], v[16:19], v[52:55], a[4:7]
    ds_read_b128 v[68:71], v107 offset:0
    ds_read_b128 v[72:75], v105 offset:2048
    v_mfma_f32_16x16x32_bf16 a[8:11], v[16:19], v[56:59], a[8:11]
    ds_read_b128 v[76:79], v105 offset:4096
    ds_read_b128 v[80:83], v105 offset:6144
    v_mfma_f32_16x16x32_bf16 a[12:15], v[16:19], v[60:63], a[12:15]
    ds_read_b128 v[84:87], v105 offset:8192
    ds_read_b64_tr_b16 v[36:37], v98 offset:4640
    v_mfma_f32_16x16x32_bf16 a[16:19], v[16:19], v[64:67], a[16:19]
    ds_read_b64_tr_b16 v[38:39], v98 offset:4784
    ds_read_b64_tr_b16 v[40:41], v98 offset:4672
    v_mfma_f32_16x16x32_bf16 a[20:23], v[20:23], v[48:51], a[20:23]
    ds_read_b64_tr_b16 v[42:43], v98 offset:4816
    ds_read_b64_tr_b16 v[44:45], v98 offset:4704
    v_mfma_f32_16x16x32_bf16 a[24:27], v[20:23], v[52:55], a[24:27]
    ds_read_b64_tr_b16 v[46:47], v98 offset:4848
    s_add_u32 m0, s59, 52640
    s_nop 0
    buffer_load_dwordx4 v92, s[68:71], s65 offen offset:0 lds
    v_mfma_f32_16x16x32_bf16 a[28:31], v[20:23], v[56:59], a[28:31]
    v_bfe_u32 v250, v247, 3, 1
    v_lshl_add_u32 v249, v250, 1, v249
    v_mfma_f32_16x16x32_bf16 a[32:35], v[20:23], v[60:63], a[32:35]
    buffer_load_dwordx4 v93, s[68:71], s65 offen offset:1024 lds
    v_mad_u32_u24 v230, v249, s66, v248
    v_add_u32 v246, 192, v1
    v_mfma_f32_16x16x32_bf16 a[36:39], v[20:23], v[64:67], a[36:39]
    v_add_u32_e64 v248, 0, v2
    v_mul_u32_u24 v247, 7282, v246
    v_mfma_f32_16x16x32_bf16 a[40:43], v[24:27], v[48:51], a[40:43]
    v_lshrrev_b32_e64 v247, 16, v247
    v_mad_i32_i24 v248, v247, s51, v248
    v_mfma_f32_16x16x32_bf16 a[44:47], v[24:27], v[52:55], a[44:47]
    buffer_load_dwordx4 v94, s[68:71], s65 offen offset:2048 lds
    v_bfe_u32 v249, v247, 1, 2
    v_mfma_f32_16x16x32_bf16 a[48:51], v[24:27], v[56:59], a[48:51]
    v_and_b32_e64 v250, 1, v247
    v_lshl_or_b32 v249, v250, 2, v249
    v_mfma_f32_16x16x32_bf16 a[52:55], v[24:27], v[60:63], a[52:55]
    v_lshrrev_b32_e64 v250, 5, v247
    v_lshl_or_b32 v249, v250, 3, v249
    v_mfma_f32_16x16x32_bf16 a[56:59], v[24:27], v[64:67], a[56:59]
    buffer_load_dwordx4 v95, s[68:71], s65 offen offset:3072 lds
    v_bfe_u32 v250, v247, 3, 2
    v_mad_u32_u24 v249, v250, 18, v249
    v_mfma_f32_16x16x32_bf16 a[60:63], v[28:31], v[48:51], a[60:63]
    v_bfe_u32 v250, v247, 3, 1
    v_mfma_f32_16x16x32_bf16 a[64:67], v[28:31], v[52:55], a[64:67]
    v_lshl_add_u32 v249, v250, 1, v249
    v_mad_u32_u24 v231, v249, s66, v248
    v_mfma_f32_16x16x32_bf16 a[68:71], v[28:31], v[56:59], a[68:71]
    s_add_u32 m0, s59, 56736
    s_nop 0
    buffer_load_dwordx4 v96, s[68:71], s65 offen offset:0 lds
    v_add_u32 v104, 152144, v108
    v_add_u32 v105, 152144, v109
    v_mfma_f32_16x16x32_bf16 a[72:75], v[28:31], v[60:63], a[72:75]
    v_add_u32 v98, 124448, v102
    v_cndmask_b32 v106, v104, v110, s[72:73]
    v_mfma_f32_16x16x32_bf16 a[76:79], v[28:31], v[64:67], a[76:79]
    v_cndmask_b32 v107, v105, v110, s[72:73]
    s_waitcnt vmcnt(9) lgkmcnt(0)
    s_barrier
    s_mul_i32 s65, s57, 221184
    s_add_u32 s65, s65, s58
    s_add_u32 s57, s57, 1
    s_cmp_eq_u32 s57, 9
    s_cselect_b32 s57, 0, s57
    v_mfma_f32_16x16x32_bf16 a[0:3], v[32:35], v[68:71], a[0:3]
    ds_read_b64_tr_b16 v[16:17], v98 offset:0
    ds_read_b64_tr_b16 v[18:19], v98 offset:144
    v_mfma_f32_16x16x32_bf16 a[4:7], v[32:35], v[72:75], a[4:7]
    ds_read_b128 v[48:51], v106 offset:0
    ds_read_b128 v[52:55], v104 offset:2048
    v_mfma_f32_16x16x32_bf16 a[8:11], v[32:35], v[76:79], a[8:11]
    ds_read_b128 v[56:59], v104 offset:4096
    ds_read_b128 v[60:63], v104 offset:6144
    v_mfma_f32_16x16x32_bf16 a[12:15], v[32:35], v[80:83], a[12:15]
    ds_read_b128 v[64:67], v104 offset:8192
    ds_read_b64_tr_b16 v[20:21], v98 offset:32
    v_mfma_f32_16x16x32_bf16 a[16:19], v[32:35], v[84:87], a[16:19]
    ds_read_b64_tr_b16 v[22:23], v98 offset:176
    ds_read_b64_tr_b16 v[24:25], v98 offset:64
    v_mfma_f32_16x16x32_bf16 a[20:23], v[36:39], v[68:71], a[20:23]
    ds_read_b64_tr_b16 v[26:27], v98 offset:208
    ds_read_b64_tr_b16 v[28:29], v98 offset:96
    v_mfma_f32_16x16x32_bf16 a[24:27], v[36:39], v[72:75], a[24:27]
    ds_read_b64_tr_b16 v[30:31], v98 offset:240
    s_add_u32 m0, s59, 86496
    s_nop 0
    buffer_load_dwordx4 v88, s[68:71], s65 offen offset:0 lds
    v_mfma_f32_16x16x32_bf16 a[28:31], v[36:39], v[76:79], a[28:31]
    v_add_u32 v246, 256, v1
    v_add_u32 v248, 4096, v2
    v_mfma_f32_16x16x32_bf16 a[32:35], v[36:39], v[80:83], a[32:35]
    v_mul_u32_u24 v247, 7282, v246
    v_mfma_f32_16x16x32_bf16 a[36:39], v[36:39], v[84:87], a[36:39]
    buffer_load_dwordx4 v89, s[68:71], s65 offen offset:1024 lds
    v_lshrrev_b32_e64 v247, 16, v247
    v_mad_i32_i24 v248, v247, s51, v248
    v_mfma_f32_16x16x32_bf16 a[40:43], v[40:43], v[68:71], a[40:43]
    v_bfe_u32 v249, v247, 1, 2
    v_mfma_f32_16x16x32_bf16 a[44:47], v[40:43], v[72:75], a[44:47]
    v_and_b32_e64 v250, 1, v247
    v_mfma_f32_16x16x32_bf16 a[48:51], v[40:43], v[76:79], a[48:51]
    v_lshl_or_b32 v249, v250, 2, v249
    v_lshrrev_b32_e64 v250, 5, v247
    v_mfma_f32_16x16x32_bf16 a[52:55], v[40:43], v[80:83], a[52:55]
    buffer_load_dwordx4 v90, s[68:71], s65 offen offset:2048 lds
    v_lshl_or_b32 v249, v250, 3, v249
    v_mfma_f32_16x16x32_bf16 a[56:59], v[40:43], v[84:87], a[56:59]
    v_bfe_u32 v250, v247, 3, 2
    v_mad_u32_u24 v249, v250, 18, v249
    v_mfma_f32_16x16x32_bf16 a[60:63], v[44:47], v[68:71], a[60:63]
    v_bfe_u32 v250, v247, 3, 1
    v_mfma_f32_16x16x32_bf16 a[64:67], v[44:47], v[72:75], a[64:67]
    buffer_load_dwordx4 v91, s[68:71], s65 offen offset:3072 lds
    v_lshl_add_u32 v249, v250, 1, v249
    v_mfma_f32_16x16x32_bf16 a[68:71], v[44:47], v[76:79], a[68:71]
    v_mad_u32_u24 v232, v249, s66, v248
    v_add_u32 v246, 320, v1
    v_mfma_f32_16x16x32_bf16 a[72:75], v[44:47], v[80:83], a[72:75]
    v_add_u32 v248, 4096, v2
    v_mfma_f32_16x16x32_bf16 a[76:79], v[44:47], v[84:87], a[76:79]
    v_mul_u32_u24 v247, 7282, v246
    s_waitcnt lgkmcnt(0)
    v_mfma_f32_16x16x32_bf16 a[0:3], v[16:19], v[48:51], a[0:3]
    ds_read_b64_tr_b16 v[32:33], v98 offset:4608
    ds_read_b64_tr_b16 v[34:35], v98 offset:4752
    v_mfma_f32_16x16x32_bf16 a[4:7], v[16:19], v[52:55], a[4:7]
    ds_read_b128 v[68:71], v107 offset:0
    ds_read_b128 v[72:75], v105 offset:2048
    v_mfma_f32_16x16x32_bf16 a[8:11], v[16:19], v[56:59], a[8:11]
    ds_read_b128 v[76:79], v105 offset:4096
    ds_read_b128 v[80:83], v105 offset:6144
    v_mfma_f32_16x16x32_bf16 a[12:15], v[16:19], v[60:63], a[12:15]
    ds_read_b128 v[84:87], v105 offset:8192
    ds_read_b64_tr_b16 v[36:37], v98 offset:4640
    v_mfma_f32_16x16x32_bf16 a[16:19], v[16:19], v[64:67], a[16:19]
    ds_read_b64_tr_b16 v[38:39], v98 offset:4784
    ds_read_b64_tr_b16 v[40:41], v98 offset:4672
    v_mfma_f32_16x16x32_bf16 a[20:23], v[20:23], v[48:51], a[20:23]
    ds_read_b64_tr_b16 v[42:43], v98 offset:4816
    ds_read_b64_tr_b16 v[44:45], v98 offset:4704
    v_mfma_f32_16x16x32_bf16 a[24:27], v[20:23], v[52:55], a[24:27]
    ds_read_b64_tr_b16 v[46:47], v98 offset:4848
    s_add_u32 m0, s59, 90592
    s_nop 0
    buffer_load_dwordx4 v92, s[68:71], s65 offen offset:0 lds
    v_mfma_f32_16x16x32_bf16 a[28:31], v[20:23], v[56:59], a[28:31]
    v_lshrrev_b32_e64 v247, 16, v247
    v_mad_i32_i24 v248, v247, s51, v248
    v_mfma_f32_16x16x32_bf16 a[32:35], v[20:23], v[60:63], a[32:35]
    buffer_load_dwordx4 v93, s[68:71], s65 offen offset:1024 lds
    v_bfe_u32 v249, v247, 1, 2
    v_and_b32_e64 v250, 1, v247
    v_mfma_f32_16x16x32_bf16 a[36:39], v[20:23], v[64:67], a[36:39]
    v_lshl_or_b32 v249, v250, 2, v249
    v_lshrrev_b32_e64 v250, 5, v247
    v_mfma_f32_16x16x32_bf16 a[40:43], v[24:27], v[48:51], a[40:43]
    v_lshl_or_b32 v249, v250, 3, v249
    v_bfe_u32 v250, v247, 3, 2
    v_mfma_f32_16x16x32_bf16 a[44:47], v[24:27], v[52:55], a[44:47]
    buffer_load_dwordx4 v94, s[68:71], s65 offen offset:2048 lds
    v_mad_u32_u24 v249, v250, 18, v249
L_pg1:
    s_cbranch_execz L_pg5
    v_mfma_f32_16x16x32_bf16 a[48:51], v[24:27], v[56:59], a[48:51]
    v_bfe_u32 v250, v247, 3, 1
    v_lshl_add_u32 v249, v250, 1, v249
    v_mfma_f32_16x16x32_bf16 a[52:55], v[24:27], v[60:63], a[52:55]
    v_mad_u32_u24 v233, v249, s66, v248
    v_add_u32 v246, 384, v1
    v_mfma_f32_16x16x32_bf16 a[56:59], v[24:27], v[64:67], a[56:59]
    buffer_load_dwordx4 v95, s[68:71], s65 offen offset:3072 lds
    v_add_u32 v248, 4096, v2
    v_mul_u32_u24 v247, 7282, v246
    v_mfma_f32_16x16x32_bf16 a[60:63], v[28:31], v[48:51], a[60:63]
    v_lshrrev_b32 v247, 16, v247
    v_mfma_f32_16x16x32_bf16 a[64:67], v[28:31], v[52:55], a[64:67]
    v_mad_i32_i24 v248, v247, s51, v248
    v_bfe_u32 v249, v247, 1, 2
    v_mfma_f32_16x16x32_bf16 a[68:71], v[28:31], v[56:59], a[68:71]
    s_add_u32 m0, s59, 94688
    s_nop 0
    buffer_load_dwordx4 v96, s[68:71], s65 offen offset:0 lds
    v_add_u32 v104, 76240, v108
    v_add_u32 v105, 76240, v109
    v_mfma_f32_16x16x32_bf16 a[72:75], v[28:31], v[60:63], a[72:75]
    v_add_u32 v98, 48544, v102
    v_cndmask_b32 v106, v104, v110, s[72:73]
    v_mfma_f32_16x16x32_bf16 a[76:79], v[28:31], v[64:67], a[76:79]
    v_cndmask_b32 v107, v105, v110, s[72:73]
    s_waitcnt vmcnt(9) lgkmcnt(0)
    s_barrier
    s_mul_i32 s65, s57, 221184
    s_add_u32 s65, s65, s58
    s_add_u32 s57, s57, 1
    s_cmp_eq_u32 s57, 9
    s_cselect_b32 s57, 0, s57
    v_mfma_f32_16x16x32_bf16 a[0:3], v[32:35], v[68:71], a[0:3]
    ds_read_b64_tr_b16 v[16:17], v98 offset:0
    ds_read_b64_tr_b16 v[18:19], v98 offset:144
    v_mfma_f32_16x16x32_bf16 a[4:7], v[32:35], v[72:75], a[4:7]
    ds_read_b128 v[48:51], v106 offset:0
    ds_read_b128 v[52:55], v104 offset:2048
    v_mfma_f32_16x16x32_bf16 a[8:11], v[32:35], v[76:79], a[8:11]
    ds_read_b128 v[56:59], v104 offset:4096
    ds_read_b128 v[60:63], v104 offset:6144
    v_mfma_f32_16x16x32_bf16 a[12:15], v[32:35], v[80:83], a[12:15]
    ds_read_b128 v[64:67], v104 offset:8192
    ds_read_b64_tr_b16 v[20:21], v98 offset:32
    v_mfma_f32_16x16x32_bf16 a[16:19], v[32:35], v[84:87], a[16:19]
    ds_read_b64_tr_b16 v[22:23], v98 offset:176
    ds_read_b64_tr_b16 v[24:25], v98 offset:64
    v_mfma_f32_16x16x32_bf16 a[20:23], v[36:39], v[68:71], a[20:23]
    ds_read_b64_tr_b16 v[26:27], v98 offset:208
    ds_read_b64_tr_b16 v[28:29], v98 offset:96
    v_mfma_f32_16x16x32_bf16 a[24:27], v[36:39], v[72:75], a[24:27]
    ds_read_b64_tr_b16 v[30:31], v98 offset:240
    s_add_u32 m0, s59, 124448
    s_nop 0
    buffer_load_dwordx4 v88, s[68:71], s65 offen offset:0 lds
    v_mfma_f32_16x16x32_bf16 a[28:31], v[36:39], v[76:79], a[28:31]
    v_and_b32_e64 v250, 1, v247
    v_lshl_or_b32 v249, v250, 2, v249
    v_mfma_f32_16x16x32_bf16 a[32:35], v[36:39], v[80:83], a[32:35]
    v_lshrrev_b32_e64 v250, 5, v247
    v_mfma_f32_16x16x32_bf16 a[36:39], v[36:39], v[84:87], a[36:39]
    buffer_load_dwordx4 v89, s[68:71], s65 offen offset:1024 lds
    v_lshl_or_b32 v249, v250, 3, v249
    v_bfe_u32 v250, v247, 3, 2
    v_mfma_f32_16x16x32_bf16 a[40:43], v[40:43], v[68:71], a[40:43]
    v_mad_u32_u24 v249, v250, 18, v249
    v_mfma_f32_16x16x32_bf16 a[44:47], v[40:43], v[72:75], a[44:47]
    v_bfe_u32 v250, v247, 3, 1
    v_mfma_f32_16x16x32_bf16 a[48:51], v[40:43], v[76:79], a[48:51]
    v_lshl_add_u32 v249, v250, 1, v249
    v_mad_u32_u24 v234, v249, s66, v248
    v_mfma_f32_16x16x32_bf16 a[52:55], v[40:43], v[80:83], a[52:55]
    buffer_load_dwordx4 v90, s[68:71], s65 offen offset:2048 lds
    v_add_u32 v246, 448, v1
    v_mfma_f32_16x16x32_bf16 a[56:59], v[40:43], v[84:87], a[56:59]
    v_add_u32 v248, 4096, v2
    v_mul_u32_u24 v247, 7282, v246
    v_mfma_f32_16x16x32_bf16 a[60:63], v[44:47], v[68:71], a[60:63]
    v_lshrrev_b32_e64 v247, 16, v247
    v_mfma_f32_16x16x32_bf16 a[64:67], v[44:47], v[72:75], a[64:67]
    buffer_load_dwordx4 v91, s[68:71], s65 offen offset:3072 lds
    v_mad_i32_i24 v248, v247, s51, v248
    v_mfma_f32_16x16x32_bf16 a[68:71], v[44:47], v[76:79], a[68:71]
    v_bfe_u32 v249, v247, 1, 2
    v_and_b32_e64 v250, 1, v247
    v_mfma_f32_16x16x32_bf16 a[72:75], v[44:47], v[80:83], a[72:75]
    v_lshl_or_b32 v249, v250, 2, v249
    v_mfma_f32_16x16x32_bf16 a[76:79], v[44:47], v[84:87], a[76:79]
    v_lshrrev_b32 v250, 5, v247
    s_waitcnt lgkmcnt(0)
    v_mfma_f32_16x16x32_bf16 a[0:3], v[16:19], v[48:51], a[0:3]
    ds_read_b64_tr_b16 v[32:33], v98 offset:4608
    ds_read_b64_tr_b16 v[34:35], v98 offset:4752
    v_mfma_f32_16x16x32_bf16 a[4:7], v[16:19], v[52:55], a[4:7]
    ds_read_b128 v[68:71], v107 offset:0
    ds_read_b128 v[72:75], v105 offset:2048
    v_mfma_f32_16x16x32_bf16 a[8:11], v[16:19], v[56:59], a[8:11]
    ds_read_b128 v[76:79], v105 offset:4096
    ds_read_b128 v[80:83], v105 offset:6144
    v_mfma_f32_16x16x32_bf16 a[12:15], v[16:19], v[60:63], a[12:15]
    ds_read_b128 v[84:87], v105 offset:8192
    ds_read_b64_tr_b16 v[36:37], v98 offset:4640
    v_mfma_f32_16x16x32_bf16 a[16:19], v[16:19], v[64:67], a[16:19]
    ds_read_b64_tr_b16 v[38:39], v98 offset:4784
    ds_read_b64_tr_b16 v[40:41], v98 offset:4672
    v_mfma_f32_16x16x32_bf16 a[20:23], v[20:23], v[48:51], a[20:23]
    ds_read_b64_tr_b16 v[42:43], v98 offset:4816
    ds_read_b64_tr_b16 v[44:45], v98 offset:4704
    v_mfma_f32_16x16x32_bf16 a[24:27], v[20:23], v[52:55], a[24:27]
    ds_read_b64_tr_b16 v[46:47], v98 offset:4848
    s_add_u32 m0, s59, 128544
    s_nop 0
    buffer_load_dwordx4 v92, s[68:71], s65 offen offset:0 lds
    v_mfma_f32_16x16x32_bf16 a[28:31], v[20:23], v[56:59], a[28:31]
    v_lshl_or_b32 v249, v250, 3, v249
    v_bfe_u32 v250, v247, 3, 2
    v_mfma_f32_16x16x32_bf16 a[32:35], v[20:23], v[60:63], a[32:35]
    buffer_load_dwordx4 v93, s[68:71], s65 offen offset:1024 lds
    v_mad_u32_u24 v249, v250, 18, v249
    v_bfe_u32 v250, v247, 3, 1
    v_mfma_f32_16x16x32_bf16 a[36:39], v[20:23], v[64:67], a[36:39]
    v_lshl_add_u32 v249, v250, 1, v249
    v_mad_u32_u24 v235, v249, s66, v248
    v_mfma_f32_16x16x32_bf16 a[40:43], v[24:27], v[48:51], a[40:43]
    v_add_u32 v246, 512, v1
    v_add_u32 v248, 8192, v2
    v_mfma_f32_16x16x32_bf16 a[44:47], v[24:27], v[52:55], a[44:47]
    buffer_load_dwordx4 v94, s[68:71], s65 offen offset:2048 lds
    v_mul_u32_u24 v247, 7282, v246
    v_mfma_f32_16x16x32_bf16 a[48:51], v[24:27], v[56:59], a[48:51]
    v_lshrrev_b32 v247, 16, v247
    v_mad_i32_i24 v248, v247, s51, v248
    v_mfma_f32_16x16x32_bf16 a[52:55], v[24:27], v[60:63], a[52:55]
    v_bfe_u32 v249, v247, 1, 2
    v_and_b32_e64 v250, 1, v247
    v_mfma_f32_16x16x32_bf16 a[56:59], v[24:27], v[64:67], a[56:59]
    buffer_load_dwordx4 v95, s[68:71], s65 offen offset:3072 lds
    v_lshl_or_b32 v249, v250, 2, v249
    v_lshrrev_b32_e64 v250, 5, v247
    v_mfma_f32_16x16x32_bf16 a[60:63], v[28:31], v[48:51], a[60:63]
    v_lshl_or_b32 v249, v250, 3, v249
    v_mfma_f32_16x16x32_bf16 a[64:67], v[28:31], v[52:55], a[64:67]
    v_bfe_u32 v250, v247, 3, 2
    v_mad_u32_u24 v249, v250, 18, v249
    v_mfma_f32_16x16x32_bf16 a[68:71], v[28:31], v[56:59], a[68:71]
    s_add_u32 m0, s59, 132640
    s_nop 0
    buffer_load_dwordx4 v96, s[68:71], s65 offen offset:0 lds
    v_add_u32 v104, 114192, v108
    v_add_u32 v105, 114192, v109
    v_mfma_f32_16x16x32_bf16 a[72:75], v[28:31], v[60:63], a[72:75]
    v_add_u32 v98, 86496, v102
    v_cndmask_b32 v106, v104, v110, s[72:73]
    v_mfma_f32_16x16x32_bf16 a[76:79], v[28:31], v[64:67], a[76:79]
    v_cndmask_b32 v107, v105, v110, s[72:73]
    s_waitcnt vmcnt(9) lgkmcnt(0)
    s_barrier
    v_mfma_f32_16x16x32_bf16 a[0:3], v[32:35], v[68:71], a[0:3]
    ds_read_b64_tr_b16 v[16:17], v98 offset:0
    ds_read_b64_tr_b16 v[18:19], v98 offset:144
    v_mfma_f32_16x16x32_bf16 a[4:7], v[32:35], v[72:75], a[4:7]
    ds_read_b128 v[48:51], v106 offset:0
    ds_read_b128 v[52:55], v104 offset:2048
    v_mfma_f32_16x16x32_bf16 a[8:11], v[32:35], v[76:79], a[8:11]
    ds_read_b128 v[56:59], v104 offset:4096
    ds_read_b128 v[60:63], v104 offset:6144
    v_mfma_f32_16x16x32_bf16 a[12:15], v[32:35], v[80:83], a[12:15]
    ds_read_b128 v[64:67], v104 offset:8192
    ds_read_b64_tr_b16 v[20:21], v98 offset:32
    v_mfma_f32_16x16x32_bf16 a[16:19], v[32:35], v[84:87], a[16:19]
    ds_read_b64_tr_b16 v[22:23], v98 offset:176
    ds_read_b64_tr_b16 v[24:25], v98 offset:64
    v_mfma_f32_16x16x32_bf16 a[20:23], v[36:39], v[68:71], a[20:23]
    ds_read_b64_tr_b16 v[26:27], v98 offset:208
    ds_read_b64_tr_b16 v[28:29], v98 offset:96
    v_mfma_f32_16x16x32_bf16 a[24:27], v[36:39], v[72:75], a[24:27]
    ds_read_b64_tr_b16 v[30:31], v98 offset:240
    buffer_load_dwordx4 v[190:193], v224, s[16:19], s74 offen
    s_add_u32 s74, s74, 9216
    v_mfma_f32_16x16x32_bf16 a[28:31], v[36:39], v[76:79], a[28:31]
    v_bfe_u32 v250, v247, 3, 1
    v_lshl_add_u32 v249, v250, 1, v249
    v_mfma_f32_16x16x32_bf16 a[32:35], v[36:39], v[80:83], a[32:35]
    v_mad_u32_u24 v236, v249, s66, v248
    v_mfma_f32_16x16x32_bf16 a[36:39], v[36:39], v[84:87], a[36:39]
    buffer_load_dwordx4 v[194:197], v224, s[16:19], s74 offen
    s_add_u32 s74, s74, 9216
    s_lshl_b32 s67, s46, 6
    v_add_u32_e64 v246, s67, v1
    v_mfma_f32_16x16x32_bf16 a[40:43], v[40:43], v[68:71], a[40:43]
    v_lshlrev_b32_e64 v248, 4, v246
    v_mfma_f32_16x16x32_bf16 a[44:47], v[40:43], v[72:75], a[44:47]
    v_mul_u32_u24 v247, 7282, v246
    v_mfma_f32_16x16x32_bf16 a[48:51], v[40:43], v[76:79], a[48:51]
    v_lshrrev_b32_e64 v247, 16, v247
    v_mad_i32_i24 v248, v247, s51, v248
    v_mfma_f32_16x16x32_bf16 a[52:55], v[40:43], v[80:83], a[52:55]
    buffer_load_dwordx4 v[198:201], v224, s[16:19], s74 offen
    s_add_u32 s74, s74, 9216
    v_lshrrev_b32_e64 v249, 3, v247
    v_mfma_f32_16x16x32_bf16 a[56:59], v[40:43], v[84:87], a[56:59]
    v_and_b32_e64 v250, 1, v247
    v_lshl_or_b32 v249, v249, 1, v250
    v_mfma_f32_16x16x32_bf16 a[60:63], v[44:47], v[68:71], a[60:63]
    v_bfe_u32 v250, v247, 1, 2
    v_mfma_f32_16x16x32_bf16 a[64:67], v[44:47], v[72:75], a[64:67]
    buffer_load_dwordx4 v[202:205], v224, s[16:19], s74 offen
    s_add_u32 s74, s74, 9216
    v_or_b32_e64 v250, 16, v250
    v_mfma_f32_16x16x32_bf16 a[68:71], v[44:47], v[76:79], a[68:71]
    v_mad_u32_u24 v249, v249, 36, v250
    v_mad_u32_u24 v237, v249, s66, v248
    v_mfma_f32_16x16x32_bf16 a[72:75], v[44:47], v[80:83], a[72:75]
    s_add_u32 s67, s67, 256
    v_mfma_f32_16x16x32_bf16 a[76:79], v[44:47], v[84:87], a[76:79]
    v_add_u32 v246, s67, v1
    s_waitcnt lgkmcnt(0)
    v_mfma_f32_16x16x32_bf16 a[0:3], v[16:19], v[48:51], a[0:3]
    ds_read_b64_tr_b16 v[32:33], v98 offset:4608
    ds_read_b64_tr_b16 v[34:35], v98 offset:4752
    v_mfma_f32_16x16x32_bf16 a[4:7], v[16:19], v[52:55], a[4:7]
    ds_read_b128 v[68:71], v107 offset:0
    ds_read_b128 v[72:75], v105 offset:2048
    v_mfma_f32_16x16x32_bf16 a[8:11], v[16:19], v[56:59], a[8:11]
    ds_read_b128 v[76:79], v105 offset:4096
    ds_read_b128 v[80:83], v105 offset:6144
    v_mfma_f32_16x16x32_bf16 a[12:15], v[16:19], v[60:63], a[12:15]
    ds_read_b128 v[84:87], v105 offset:8192
    ds_read_b64_tr_b16 v[36:37], v98 offset:4640
    v_mfma_f32_16x16x32_bf16 a[16:19], v[16:19], v[64:67], a[16:19]
    ds_read_b64_tr_b16 v[38:39], v98 offset:4784
    ds_read_b64_tr_b16 v[40:41], v98 offset:4672
    v_mfma_f32_16x16x32_bf16 a[20:23], v[20:23], v[48:51], a[20:23]
    ds_read_b64_tr_b16 v[42:43], v98 offset:4816
    ds_read_b64_tr_b16 v[44:45], v98 offset:4704
    v_mfma_f32_16x16x32_bf16 a[24:27], v[20:23], v[52:55], a[24:27]
    ds_read_b64_tr_b16 v[46:47], v98 offset:4848
    buffer_load_dwordx4 v[206:209], v224, s[16:19], s74 offen
    s_add_u32 s74, s74, 9216
    v_mfma_f32_16x16x32_bf16 a[28:31], v[20:23], v[56:59], a[28:31]
    v_lshlrev_b32_e64 v248, 4, v246
    v_mul_u32_u24 v247, 7282, v246
    v_mfma_f32_16x16x32_bf16 a[32:35], v[20:23], v[60:63], a[32:35]
    buffer_load_dwordx4 v[210:213], v224, s[16:19], s74 offen
    s_add_u32 s74, s74, 9216
    v_lshrrev_b32_e64 v247, 16, v247
    v_mad_i32_i24 v248, v247, s51, v248
    v_mfma_f32_16x16x32_bf16 a[36:39], v[20:23], v[64:67], a[36:39]
    v_lshrrev_b32 v249, 3, v247
    v_and_b32 v250, 1, v247
    v_mfma_f32_16x16x32_bf16 a[40:43], v[24:27], v[48:51], a[40:43]
    v_lshl_or_b32 v249, v249, 1, v250
    v_bfe_u32 v250, v247, 1, 2
    v_mfma_f32_16x16x32_bf16 a[44:47], v[24:27], v[52:55], a[44:47]
    buffer_load_dwordx4 v[214:217], v224, s[16:19], s74 offen
    s_add_u32 s74, s74, 9216
    v_or_b32_e64 v250, 16, v250
    v_mfma_f32_16x16x32_bf16 a[48:51], v[24:27], v[56:59], a[48:51]
    v_mad_u32_u24 v249, v249, 36, v250
    v_mad_u32_u24 v238, v249, s66, v248
    v_mfma_f32_16x16x32_bf16 a[52:55], v[24:27], v[60:63], a[52:55]
    v_add_u32 v246, 512, v1
    v_add_u32 v248, 8192, v2
    v_mfma_f32_16x16x32_bf16 a[56:59], v[24:27], v[64:67], a[56:59]
    buffer_load_dwordx4 v[218:221], v224, s[16:19], s74 offen
    v_mul_u32_u24 v247, 7282, v246
    v_lshrrev_b32_e64 v247, 16, v247
    v_mfma_f32_16x16x32_bf16 a[60:63], v[28:31], v[48:51], a[60:63]
    v_mad_i32_i24 v248, v247, s51, v248
    v_mfma_f32_16x16x32_bf16 a[64:67], v[28:31], v[52:55], a[64:67]
    v_lshrrev_b32 v249, 3, v247
    v_and_b32 v250, 1, v247
    v_mfma_f32_16x16x32_bf16 a[68:71], v[28:31], v[56:59], a[68:71]
    buffer_load_ushort v222, v223, s[36:39], s75 offen
    v_add_u32 v104, 152144, v108
    v_add_u32 v105, 152144, v109
    v_mfma_f32_16x16x32_bf16 a[72:75], v[28:31], v[60:63], a[72:75]
    v_add_u32 v98, 124448, v102
    v_cndmask_b32 v106, v104, v110, s[72:73]
    v_mfma_f32_16x16x32_bf16 a[76:79], v[28:31], v[64:67], a[76:79]
    v_cndmask_b32 v107, v105, v110, s[72:73]
    s_waitcnt vmcnt(9) lgkmcnt(0)
    s_barrier
    v_mfma_f32_16x16x32_bf16 a[0:3], v[32:35], v[68:71], a[0:3]
    ds_read_b64_tr_b16 v[16:17], v98 offset:0
    ds_read_b64_tr_b16 v[18:19], v98 offset:144
    v_mfma_f32_16x16x32_bf16 a[4:7], v[32:35], v[72:75], a[4:7]
    ds_read_b128 v[48:51], v106 offset:0
    ds_read_b128 v[52:55], v104 offset:2048
    v_mfma_f32_16x16x32_bf16 a[8:11], v[32:35], v[76:79], a[8:11]
    ds_read_b128 v[56:59], v104 offset:4096
    ds_read_b128 v[60:63], v104 offset:6144
    v_mfma_f32_16x16x32_bf16 a[12:15], v[32:35], v[80:83], a[12:15]
    ds_read_b128 v[64:67], v104 offset:8192
    ds_read_b64_tr_b16 v[20:21], v98 offset:32
    v_mfma_f32_16x16x32_bf16 a[16:19], v[32:35], v[84:87], a[16:19]
    ds_read_b64_tr_b16 v[22:23], v98 offset:176
    ds_read_b64_tr_b16 v[24:25], v98 offset:64
    v_mfma_f32_16x16x32_bf16 a[20:23], v[36:39], v[68:71], a[20:23]
    ds_read_b64_tr_b16 v[26:27], v98 offset:208
    ds_read_b64_tr_b16 v[28:29], v98 offset:96
    v_mfma_f32_16x16x32_bf16 a[24:27], v[36:39], v[72:75], a[24:27]
    ds_read_b64_tr_b16 v[30:31], v98 offset:240
    buffer_load_dwordx4 a[128:131], v226, s[20:23], s79 offen
    v_mfma_f32_16x16x32_bf16 a[28:31], v[36:39], v[76:79], a[28:31]
    v_lshl_or_b32 v249, v249, 1, v250
    v_bfe_u32 v250, v247, 1, 2
    v_mfma_f32_16x16x32_bf16 a[32:35], v[36:39], v[80:83], a[32:35]
    v_or_b32_e64 v250, 16, v250
    v_mfma_f32_16x16x32_bf16 a[36:39], v[36:39], v[84:87], a[36:39]
    v_mad_u32_u24 v249, v249, 36, v250
    v_mad_u32_u24 v239, v249, s66, v248
    v_mfma_f32_16x16x32_bf16 a[40:43], v[40:43], v[68:71], a[40:43]
    s_mov_b32 s6, 2359296
    v_mfma_f32_16x16x32_bf16 a[44:47], v[40:43], v[72:75], a[44:47]
    s_mov_b32 s7, 0x20000
    v_mfma_f32_16x16x32_bf16 a[48:51], v[40:43], v[76:79], a[48:51]
    s_mov_b32 s30, 2359296
    s_mov_b32 s31, 0x20000
    v_mfma_f32_16x16x32_bf16 a[52:55], v[40:43], v[80:83], a[52:55]
    buffer_load_dwordx4 a[144:147], v226, s[20:23], s79 offen offset:2304
    s_add_u32 s79, s79, 9216
    s_mov_b32 s42, 1152
    v_mfma_f32_16x16x32_bf16 a[56:59], v[40:43], v[84:87], a[56:59]
    s_mov_b32 s43, 0x20000
    s_lshl_b32 s47, s44, 2
    v_mfma_f32_16x16x32_bf16 a[60:63], v[44:47], v[68:71], a[60:63]
    s_add_u32 s47, s47, s46
    v_mfma_f32_16x16x32_bf16 a[64:67], v[44:47], v[72:75], a[64:67]
    s_lshl_b32 s48, s44, 13
    v_mfma_f32_16x16x32_bf16 a[68:71], v[44:47], v[76:79], a[68:71]
    s_lshl_b32 s67, s46, 7
    s_add_u32 s48, s48, s67
    v_mfma_f32_16x16x32_bf16 a[72:75], v[44:47], v[80:83], a[72:75]
    v_min_u32 v254, 1, v1
    v_mfma_f32_16x16x32_bf16 a[76:79], v[44:47], v[84:87], a[76:79]
    v_lshlrev_b32 v254, 30, v254
    s_waitcnt lgkmcnt(0)
    v_mfma_f32_16x16x32_bf16 a[0:3], v[16:19], v[48:51], a[0:3]
    ds_read_b64_tr_b16 v[32:33], v98 offset:4608
    ds_read_b64_tr_b16 v[34:35], v98 offset:4752
    v_mfma_f32_16x16x32_bf16 a[4:7], v[16:19], v[52:55], a[4:7]
    ds_read_b128 v[68:71], v107 offset:0
    ds_read_b128 v[72:75], v105 offset:2048
    v_mfma_f32_16x16x32_bf16 a[8:11], v[16:19], v[56:59], a[8:11]
    ds_read_b128 v[76:79], v105 offset:4096
    ds_read_b128 v[80:83], v105 offset:6144
    v_mfma_f32_16x16x32_bf16 a[12:15], v[16:19], v[60:63], a[12:15]
    ds_read_b128 v[84:87], v105 offset:8192
    ds_read_b64_tr_b16 v[36:37], v98 offset:4640
    v_mfma_f32_16x16x32_bf16 a[16:19], v[16:19], v[64:67], a[16:19]
    ds_read_b64_tr_b16 v[38:39], v98 offset:4784
    ds_read_b64_tr_b16 v[40:41], v98 offset:4672
    v_mfma_f32_16x16x32_bf16 a[20:23], v[20:23], v[48:51], a[20:23]
    ds_read_b64_tr_b16 v[42:43], v98 offset:4816
    ds_read_b64_tr_b16 v[44:45], v98 offset:4704
    v_mfma_f32_16x16x32_bf16 a[24:27], v[20:23], v[52:55], a[24:27]
    ds_read_b64_tr_b16 v[46:47], v98 offset:4848
    buffer_load_dwordx4 a[132:135], v226, s[20:23], s79 offen
    v_mfma_f32_16x16x32_bf16 a[28:31], v[20:23], v[56:59], a[28:31]
    v_lshrrev_b32 v246, 4, v1
    v_and_b32 v247, 1, v246
    v_mfma_f32_16x16x32_bf16 a[32:35], v[20:23], v[60:63], a[32:35]
    v_mul_u32_u24 v248, 72, v246
    v_mfma_f32_16x16x32_bf16 a[36:39], v[20:23], v[64:67], a[36:39]
    v_add_u32 v248, 86496, v248
    v_lshl_add_u32 v5, v247, 3, v248
    v_mfma_f32_16x16x32_bf16 a[40:43], v[24:27], v[48:51], a[40:43]
    v_xor_b32_e64 v247, 1, v247
    v_mfma_f32_16x16x32_bf16 a[44:47], v[24:27], v[52:55], a[44:47]
    v_lshl_add_u32 v6, v247, 6, v248
    v_mfma_f32_16x16x32_bf16 a[48:51], v[24:27], v[56:59], a[48:51]
    v_and_b32 v247, 15, v1
    s_lshl_b32 s67, s46, 4
    v_mfma_f32_16x16x32_bf16 a[52:55], v[24:27], v[60:63], a[52:55]
    buffer_load_dwordx4 a[148:151], v226, s[20:23], s79 offen offset:2304
    s_add_u32 s79, s79, 9216
    s_add_u32 s67, s67, 2
    v_mfma_f32_16x16x32_bf16 a[56:59], v[24:27], v[64:67], a[56:59]
    v_add_u32 v248, s67, v247
    v_mul_u32_u24 v249, 288, v248
    v_mfma_f32_16x16x32_bf16 a[60:63], v[28:31], v[48:51], a[60:63]
    v_add_u32_e64 v3, v5, v249
    v_mfma_f32_16x16x32_bf16 a[64:67], v[28:31], v[52:55], a[64:67]
    v_add_u32_e64 v4, v6, v249
    v_mfma_f32_16x16x32_bf16 a[68:71], v[28:31], v[56:59], a[68:71]
    v_lshlrev_b32_e64 v248, 3, v248
    v_add_u32 v7, 162400, v248
    v_mfma_f32_16x16x32_bf16 a[72:75], v[28:31], v[60:63], a[72:75]
    v_lshlrev_b32_e64 v247, 4, v247
    v_mfma_f32_16x16x32_bf16 a[76:79], v[28:31], v[64:67], a[76:79]
    v_lshl_add_u32 v8, v246, 2, v247
    s_waitcnt lgkmcnt(0)
    s_barrier
    v_and_b32_e64 v10, 15, v1
    v_mul_u32_u24 v11, 288, v10
    v_and_b32_e64 v12, 48, v1
    s_mul_i32 s49, s46, 23040
    s_add_u32 s49, s49, 86496
    v_add3_u32 v11, v11, v12, s49
    v_mfma_f32_16x16x32_bf16 a[0:3], v[32:35], v[68:71], a[0:3]
    buffer_load_dwordx4 a[136:139], v226, s[20:23], s79 offen
    v_mfma_f32_16x16x32_bf16 a[4:7], v[32:35], v[72:75], a[4:7]
    v_mfma_f32_16x16x32_bf16 a[8:11], v[32:35], v[76:79], a[8:11]
    v_mfma_f32_16x16x32_bf16 a[12:15], v[32:35], v[80:83], a[12:15]
    v_mfma_f32_16x16x32_bf16 a[16:19], v[32:35], v[84:87], a[16:19]
    v_mfma_f32_16x16x32_bf16 a[20:23], v[36:39], v[68:71], a[20:23]
    v_mfma_f32_16x16x32_bf16 a[24:27], v[36:39], v[72:75], a[24:27]
    v_mfma_f32_16x16x32_bf16 a[28:31], v[36:39], v[76:79], a[28:31]
    v_mfma_f32_16x16x32_bf16 a[32:35], v[36:39], v[80:83], a[32:35]
    ds_write_b128 v11, a[0:3] offset:0
    buffer_load_dwordx4 a[152:155], v226, s[20:23], s79 offen offset:2304
    s_add_u32 s79, s79, 9216
    v_mfma_f32_16x16x32_bf16 a[36:39], v[36:39], v[84:87], a[36:39]
    ds_write_b128 v11, a[4:7] offset:4608
    v_mfma_f32_16x16x32_bf16 a[40:43], v[40:43], v[68:71], a[40:43]
    ds_write_b128 v11, a[8:11] offset:9216
    v_mfma_f32_16x16x32_bf16 a[44:47], v[40:43], v[72:75], a[44:47]
    ds_write_b128 v11, a[12:15] offset:13824
    buffer_load_dwordx4 a[140:143], v226, s[20:23], s79 offen
    v_mfma_f32_16x16x32_bf16 a[48:51], v[40:43], v[76:79], a[48:51]
    ds_write_b128 v11, a[16:19] offset:18432
    v_mfma_f32_16x16x32_bf16 a[52:55], v[40:43], v[80:83], a[52:55]
    ds_write_b128 v11, a[20:23] offset:64
    v_mfma_f32_16x16x32_bf16 a[56:59], v[40:43], v[84:87], a[56:59]
    ds_write_b128 v11, a[24:27] offset:4672
    buffer_load_dwordx4 a[156:159], v226, s[20:23], s79 offen offset:2304
    v_mfma_f32_16x16x32_bf16 a[60:63], v[44:47], v[68:71], a[60:63]
    ds_write_b128 v11, a[28:31] offset:9280
    v_mfma_f32_16x16x32_bf16 a[64:67], v[44:47], v[72:75], a[64:67]
    ds_write_b128 v11, a[32:35] offset:13888
    v_mfma_f32_16x16x32_bf16 a[68:71], v[44:47], v[76:79], a[68:71]
    ds_write_b128 v11, a[36:39] offset:18496
    s_add_u32 m0, s54, 0
    s_nop 0
    buffer_load_dwordx4 v228, s[12:15], s60 offen offset:0 lds
    v_mfma_f32_16x16x32_bf16 a[72:75], v[44:47], v[80:83], a[72:75]
    ds_write_b128 v11, a[40:43] offset:128
    v_mfma_f32_16x16x32_bf16 a[76:79], v[44:47], v[84:87], a[76:79]
    ds_write_b128 v11, a[44:47] offset:4736
    ds_write_b128 v11, a[48:51] offset:9344
    buffer_load_dwordx4 v229, s[12:15], s60 offen offset:1024 lds
    ds_write_b128 v11, a[52:55] offset:13952
    ds_write_b128 v11, a[56:59] offset:18560
    ds_write_b128 v11, a[60:63] offset:192
    buffer_load_dwordx4 v230, s[12:15], s60 offen offset:2048 lds
    ds_write_b128 v11, a[64:67] offset:4800
    ds_write_b128 v11, a[68:71] offset:9408
    ds_write_b128 v11, a[72:75] offset:14016
    ds_write_b128 v11, a[76:79] offset:18624
L_join:
    s_waitcnt lgkmcnt(0)
    s_barrier
    ds_read_b64 v[70:71], v7 offset:112
    ds_read_b128 v[16:19], v3 offset:4032
    ds_read_b128 v[20:23], v3 offset:4048
    ds_read_b128 v[24:27], v3 offset:4064
    ds_read_b128 v[28:31], v3 offset:4080
    ds_read_b64 v[32:33], v4 offset:4032
    ds_read_b128 v[34:37], v5 offset:0
    ds_read_b128 v[38:41], v5 offset:16
    ds_read_b128 v[42:45], v5 offset:32
    ds_read_b128 v[46:49], v5 offset:48
    ds_read_b64 v[50:51], v6 offset:0
    ds_read_b128 v[52:55], v5 offset:23040
    ds_read_b128 v[56:59], v5 offset:23056
    ds_read_b128 v[60:63], v5 offset:23072
    ds_read_b128 v[64:67], v5 offset:23088
    ds_read_b64 v[68:69], v6 offset:23040
    ds_read_b128 v[86:89], v3 offset:27072
    ds_read_b128 v[90:93], v3 offset:27088
    ds_read_b128 v[94:97], v3 offset:27104
    ds_read_b128 v[98:101], v3 offset:27120
    ds_read_b64 v[102:103], v4 offset:27072
    buffer_load_dwordx4 v231, s[12:15], s60 offen offset:3072 lds
    s_waitcnt lgkmcnt(10)
    v_mul_f32 v184, 0x3eae1a93, v71
    v_pk_fma_f32 v[16:17], v[34:35], v[70:71], v[16:17] op_sel:[0,0,0] op_sel_hi:[1,0,1]
    v_pk_fma_f32 v[18:19], v[36:37], v[70:71], v[18:19] op_sel:[0,0,0] op_sel_hi:[1,0,1]
    v_pk_fma_f32 v[20:21], v[38:39], v[70:71], v[20:21] op_sel:[0,0,0] op_sel_hi:[1,0,1]
    v_pk_fma_f32 v[22:23], v[40:41], v[70:71], v[22:23] op_sel:[0,0,0] op_sel_hi:[1,0,1]
    v_pk_fma_f32 v[24:25], v[42:43], v[70:71], v[24:25] op_sel:[0,0,0] op_sel_hi:[1,0,1]
    v_pk_fma_f32 v[26:27], v[44:45], v[70:71], v[26:27] op_sel:[0,0,0] op_sel_hi:[1,0,1]
    v_pk_fma_f32 v[28:29], v[46:47], v[70:71], v[28:29] op_sel:[0,0,0] op_sel_hi:[1,0,1]
    v_pk_fma_f32 v[30:31], v[48:49], v[70:71], v[30:31] op_sel:[0,0,0] op_sel_hi:[1,0,1]
    v_pk_fma_f32 v[32:33], v[50:51], v[70:71], v[32:33] op_sel:[0,0,0] op_sel_hi:[1,0,1]
    ds_read_b128 v[104:107], v3 offset:26496
    ds_read_b128 v[108:111], v3 offset:26512
    ds_read_b128 v[112:115], v3 offset:26528
    ds_read_b128 v[116:119], v3 offset:26544
    ds_read_b64 v[120:121], v4 offset:26496
    ds_read_b64 v[72:73], v7 offset:96
    s_add_u32 m0, s54, 4096
    s_nop 0
    buffer_load_dwordx4 v232, s[12:15], s60 offen offset:0 lds
    v_pk_mul_f32 v[16:17], v[16:17], v[184:185] op_sel:[0,0] op_sel_hi:[1,0]
    v_pk_mul_f32 v[18:19], v[18:19], v[184:185] op_sel:[0,0] op_sel_hi:[1,0]
    v_pk_mul_f32 v[20:21], v[20:21], v[184:185] op_sel:[0,0] op_sel_hi:[1,0]
    v_pk_mul_f32 v[22:23], v[22:23], v[184:185] op_sel:[0,0] op_sel_hi:[1,0]
    v_pk_mul_f32 v[24:25], v[24:25], v[184:185] op_sel:[0,0] op_sel_hi:[1,0]
    v_pk_mul_f32 v[26:27], v[26:27], v[184:185] op_sel:[0,0] op_sel_hi:[1,0]
    v_pk_mul_f32 v[28:29], v[28:29], v[184:185] op_sel:[0,0] op_sel_hi:[1,0]
    v_pk_mul_f32 v[30:31], v[30:31], v[184:185] op_sel:[0,0] op_sel_hi:[1,0]
    v_pk_mul_f32 v[32:33], v[32:33], v[184:185] op_sel:[0,0] op_sel_hi:[1,0]
    s_waitcnt lgkmcnt(11)
    ds_read_b128 v[122:125], v3 offset:25920
    ds_read_b128 v[126:129], v3 offset:25936
    ds_read_b128 v[130:133], v3 offset:25952
    ds_read_b128 v[134:137], v3 offset:25968
    ds_read_b64 v[138:139], v4 offset:25920
    ds_read_b64 v[74:75], v7 offset:80
    buffer_load_dwordx4 v233, s[12:15], s60 offen offset:1024 lds
    v_pk_mul_f32 v[186:187], v[16:17], v[52:53]
    v_pk_fma_f32 v[186:187], v[18:19], v[54:55], v[186:187]
    v_pk_fma_f32 v[186:187], v[20:21], v[56:57], v[186:187]
    v_pk_fma_f32 v[186:187], v[22:23], v[58:59], v[186:187]
    v_pk_fma_f32 v[186:187], v[24:25], v[60:61], v[186:187]
    v_pk_fma_f32 v[186:187], v[26:27], v[62:63], v[186:187]
    v_pk_fma_f32 v[186:187], v[28:29], v[64:65], v[186:187]
    v_pk_fma_f32 v[186:187], v[30:31], v[66:67], v[186:187]
    v_pk_fma_f32 v[186:187], v[32:33], v[68:69], v[186:187]
    v_add_f32 v184, v186, v187
    s_waitcnt lgkmcnt(12)
    ds_read_b128 v[140:143], v3 offset:25344
    ds_read_b128 v[144:147], v3 offset:25360
    ds_read_b128 v[148:151], v3 offset:25376
    ds_read_b128 v[152:155], v3 offset:25392
    ds_read_b64 v[156:157], v4 offset:25344
    ds_read_b64 v[76:77], v7 offset:64
    buffer_load_dwordx4 v234, s[12:15], s60 offen offset:2048 lds
    v_pk_mul_f32 v[186:187], v[16:17], v[86:87]
    v_pk_fma_f32 v[186:187], v[18:19], v[88:89], v[186:187]
    v_pk_fma_f32 v[186:187], v[20:21], v[90:91], v[186:187]
    v_pk_fma_f32 v[186:187], v[22:23], v[92:93], v[186:187]
    v_pk_fma_f32 v[186:187], v[24:25], v[94:95], v[186:187]
    v_pk_fma_f32 v[186:187], v[26:27], v[96:97], v[186:187]
    v_pk_fma_f32 v[186:187], v[28:29], v[98:99], v[186:187]
L_pg2:
    s_cbranch_execz L_pg6
    v_pk_fma_f32 v[186:187], v[30:31], v[100:101], v[186:187]
    v_pk_fma_f32 v[186:187], v[32:33], v[102:103], v[186:187]
    v_add_f32 v186, v186, v187
    v_fmac_f32 v186, v184, v70
    v_mul_f32 v158, v186, v71
    s_waitcnt lgkmcnt(12)
    ds_read_b128 v[86:89], v3 offset:24768
    ds_read_b128 v[90:93], v3 offset:24784
    ds_read_b128 v[94:97], v3 offset:24800
    ds_read_b128 v[98:101], v3 offset:24816
    ds_read_b64 v[102:103], v4 offset:24768
    ds_read_b64 v[78:79], v7 offset:48
    buffer_load_dwordx4 v235, s[12:15], s60 offen offset:3072 lds
    v_pk_mul_f32 v[186:187], v[16:17], v[104:105]
    v_pk_fma_f32 v[186:187], v[18:19], v[106:107], v[186:187]
    v_pk_fma_f32 v[186:187], v[20:21], v[108:109], v[186:187]
    v_pk_fma_f32 v[186:187], v[22:23], v[110:111], v[186:187]
    v_pk_fma_f32 v[186:187], v[24:25], v[112:113], v[186:187]
    v_pk_fma_f32 v[186:187], v[26:27], v[114:115], v[186:187]
    v_pk_fma_f32 v[186:187], v[28:29], v[116:117], v[186:187]
    v_pk_fma_f32 v[186:187], v[30:31], v[118:119], v[186:187]
    v_pk_fma_f32 v[186:187], v[32:33], v[120:121], v[186:187]
    v_add_f32 v186, v186, v187
    v_fmac_f32 v186, v184, v72
    v_mul_f32 v159, v186, v73
    s_waitcnt lgkmcnt(12)
    ds_read_b128 v[104:107], v3 offset:24192
    ds_read_b128 v[108:111], v3 offset:24208
    ds_read_b128 v[112:115], v3 offset:24224
    ds_read_b128 v[116:119], v3 offset:24240
    ds_read_b64 v[120:121], v4 offset:24192
    ds_read_b64 v[80:81], v7 offset:32
    s_add_u32 m0, s54, 8192
    s_nop 0
    buffer_load_dwordx4 v236, s[12:15], s60 offen offset:0 lds
    v_pk_mul_f32 v[186:187], v[16:17], v[122:123]
    v_pk_fma_f32 v[186:187], v[18:19], v[124:125], v[186:187]
    v_pk_fma_f32 v[186:187], v[20:21], v[126:127], v[186:187]
    v_pk_fma_f32 v[186:187], v[22:23], v[128:129], v[186:187]
    v_pk_fma_f32 v[186:187], v[24:25], v[130:131], v[186:187]
    v_pk_fma_f32 v[186:187], v[26:27], v[132:133], v[186:187]
    v_pk_fma_f32 v[186:187], v[28:29], v[134:135], v[186:187]
    v_pk_fma_f32 v[186:187], v[30:31], v[136:137], v[186:187]
    v_pk_fma_f32 v[186:187], v[32:33], v[138:139], v[186:187]
    v_add_f32 v186, v186, v187
    v_fmac_f32_e64 v186, v184, v74
    v_mul_f32 v160, v186, v75
    s_waitcnt lgkmcnt(12)
    ds_read_b128 v[122:125], v3 offset:23616
    ds_read_b128 v[126:129], v3 offset:23632
    ds_read_b128 v[130:133], v3 offset:23648
    ds_read_b128 v[134:137], v3 offset:23664
    ds_read_b64 v[138:139], v4 offset:23616
    ds_read_b64 v[82:83], v7 offset:16
    s_add_u32 m0, s54, 9216
    s_nop 0
    buffer_load_dwordx4 v228, s[12:15], s61 offen offset:0 lds
    v_pk_mul_f32 v[186:187], v[16:17], v[140:141]
    v_pk_fma_f32 v[186:187], v[18:19], v[142:143], v[186:187]
    v_pk_fma_f32 v[186:187], v[20:21], v[144:145], v[186:187]
    v_pk_fma_f32 v[186:187], v[22:23], v[146:147], v[186:187]
    v_pk_fma_f32 v[186:187], v[24:25], v[148:149], v[186:187]
    v_pk_fma_f32 v[186:187], v[26:27], v[150:151], v[186:187]
    v_pk_fma_f32 v[186:187], v[28:29], v[152:153], v[186:187]
    v_pk_fma_f32 v[186:187], v[30:31], v[154:155], v[186:187]
    v_pk_fma_f32 v[186:187], v[32:33], v[156:157], v[186:187]
    v_add_f32 v186, v186, v187
    v_fmac_f32_e64 v186, v184, v76
    v_mul_f32 v161, v186, v77
    s_waitcnt lgkmcnt(12)
    ds_read_b128 v[140:143], v3 offset:23040
    ds_read_b128 v[144:147], v3 offset:23056
    ds_read_b128 v[148:151], v3 offset:23072
    ds_read_b128 v[152:155], v3 offset:23088
    ds_read_b64 v[156:157], v4 offset:23040
    ds_read_b64 v[84:85], v7 offset:0
    buffer_load_dwordx4 v229, s[12:15], s61 offen offset:1024 lds
    v_pk_mul_f32 v[186:187], v[16:17], v[86:87]
    v_pk_fma_f32 v[186:187], v[18:19], v[88:89], v[186:187]
    v_pk_fma_f32 v[186:187], v[20:21], v[90:91], v[186:187]
    v_pk_fma_f32 v[186:187], v[22:23], v[92:93], v[186:187]
    v_pk_fma_f32 v[186:187], v[24:25], v[94:95], v[186:187]
    v_pk_fma_f32 v[186:187], v[26:27], v[96:97], v[186:187]
    v_pk_fma_f32 v[186:187], v[28:29], v[98:99], v[186:187]
    v_pk_fma_f32 v[186:187], v[30:31], v[100:101], v[186:187]
    v_pk_fma_f32 v[186:187], v[32:33], v[102:103], v[186:187]
    v_add_f32 v186, v186, v187
    v_fmac_f32 v186, v184, v78
    v_mul_f32 v162, v186, v79
    s_waitcnt lgkmcnt(12)
    ds_read_b128 v[34:37], v3 offset:50112
    ds_read_b128 v[38:41], v3 offset:50128
    ds_read_b128 v[42:45], v3 offset:50144
    ds_read_b128 v[46:49], v3 offset:50160
    ds_read_b64 v[50:51], v4 offset:50112
    buffer_load_dwordx4 v230, s[12:15], s61 offen offset:2048 lds
    v_pk_mul_f32 v[186:187], v[16:17], v[104:105]
    v_pk_fma_f32 v[186:187], v[18:19], v[106:107], v[186:187]
    v_pk_fma_f32 v[186:187], v[20:21], v[108:109], v[186:187]
    v_pk_fma_f32 v[186:187], v[22:23], v[110:111], v[186:187]
    v_pk_fma_f32 v[186:187], v[24:25], v[112:113], v[186:187]
    v_pk_fma_f32 v[186:187], v[26:27], v[114:115], v[186:187]
    v_pk_fma_f32 v[186:187], v[28:29], v[116:117], v[186:187]
    v_pk_fma_f32 v[186:187], v[30:31], v[118:119], v[186:187]
    v_pk_fma_f32 v[186:187], v[32:33], v[120:121], v[186:187]
    v_add_f32 v186, v186, v187
    v_fmac_f32 v186, v184, v80
    v_mul_f32 v163, v186, v81
    s_waitcnt lgkmcnt(11)
    ds_read_b128 v[52:55], v3 offset:49536
    ds_read_b128 v[56:59], v3 offset:49552
    ds_read_b128 v[60:63], v3 offset:49568
    ds_read_b128 v[64:67], v3 offset:49584
    ds_read_b64 v[68:69], v4 offset:49536
    buffer_load_dwordx4 v231, s[12:15], s61 offen offset:3072 lds
    v_pk_mul_f32 v[186:187], v[16:17], v[122:123]
    v_pk_fma_f32 v[186:187], v[18:19], v[124:125], v[186:187]
    v_pk_fma_f32 v[186:187], v[20:21], v[126:127], v[186:187]
    v_pk_fma_f32 v[186:187], v[22:23], v[128:129], v[186:187]
    v_pk_fma_f32 v[186:187], v[24:25], v[130:131], v[186:187]
    v_pk_fma_f32 v[186:187], v[26:27], v[132:133], v[186:187]
    v_pk_fma_f32 v[186:187], v[28:29], v[134:135], v[186:187]
    v_pk_fma_f32 v[186:187], v[30:31], v[136:137], v[186:187]
    v_pk_fma_f32 v[186:187], v[32:33], v[138:139], v[186:187]
    v_add_f32 v186, v186, v187
    v_fmac_f32 v186, v184, v82
    v_mul_f32 v164, v186, v83
    s_waitcnt lgkmcnt(10)
    ds_read_b128 v[86:89], v3 offset:48960
    ds_read_b128 v[90:93], v3 offset:48976
    ds_read_b128 v[94:97], v3 offset:48992
    ds_read_b128 v[98:101], v3 offset:49008
    ds_read_b64 v[102:103], v4 offset:48960
    s_add_u32 m0, s54, 13312
    s_nop 0
    buffer_load_dwordx4 v232, s[12:15], s61 offen offset:0 lds
    v_pk_mul_f32 v[186:187], v[16:17], v[140:141]
    v_pk_fma_f32 v[186:187], v[18:19], v[142:143], v[186:187]
    v_pk_fma_f32 v[186:187], v[20:21], v[144:145], v[186:187]
    v_pk_fma_f32 v[186:187], v[22:23], v[146:147], v[186:187]
    v_pk_fma_f32 v[186:187], v[24:25], v[148:149], v[186:187]
    v_pk_fma_f32 v[186:187], v[26:27], v[150:151], v[186:187]
    v_pk_fma_f32 v[186:187], v[28:29], v[152:153], v[186:187]
    v_pk_fma_f32 v[186:187], v[30:31], v[154:155], v[186:187]
    v_pk_fma_f32 v[186:187], v[32:33], v[156:157], v[186:187]
    v_add_f32 v186, v186, v187
    v_fmac_f32 v186, v184, v84
    v_mul_f32 v165, v186, v85
    ds_read_b128 v[104:107], v3 offset:48384
    ds_read_b128 v[108:111], v3 offset:48400
    ds_read_b128 v[112:115], v3 offset:48416
    ds_read_b128 v[116:119], v3 offset:48432
    ds_read_b64 v[120:121], v4 offset:48384
    buffer_load_dwordx4 v233, s[12:15], s61 offen offset:1024 lds
    s_cmp_eq_u32 s47, 0
    s_cbranch_scc0 L_nomask
    v_mov_b32 v184, 0xceabfb8f
    s_mov_b32 vcc_lo, 0x30003
    s_mov_b32 vcc_hi, 0x30003
    v_cndmask_b32 v159, v159, v184, vcc
    s_mov_b32 vcc_lo, 0xf000f
    s_mov_b32 vcc_hi, 0xf000f
    v_cndmask_b32 v160, v160, v184, vcc
    s_mov_b32 vcc_lo, 0x3f003f
    s_mov_b32 vcc_hi, 0x3f003f
    v_cndmask_b32 v161, v161, v184, vcc
    s_mov_b32 vcc_lo, 0xff00ff
    s_mov_b32 vcc_hi, 0xff00ff
    v_cndmask_b32 v162, v162, v184, vcc
    s_mov_b32 vcc_lo, 0x3ff03ff
    s_mov_b32 vcc_hi, 0x3ff03ff
    v_cndmask_b32 v163, v163, v184, vcc
    s_mov_b32 vcc_lo, 0xfff0fff
    s_mov_b32 vcc_hi, 0xfff0fff
    v_cndmask_b32 v164, v164, v184, vcc
    s_mov_b32 vcc_lo, 0x3fff3fff
    s_mov_b32 vcc_hi, 0x3fff3fff
    v_cndmask_b32 v165, v165, v184, vcc
L_nomask:
    v_max3_f32 v184, v158, v159, v160
    v_max3_f32 v185, v161, v162, v163
    v_max3_f32 v184, v184, v164, v165
    v_max_f32 v184, v184, v185
    v_sub_f32 v158, v158, v184
    v_sub_f32 v159, v159, v184
    v_sub_f32 v160, v160, v184
    v_sub_f32 v161, v161, v184
    v_sub_f32 v162, v162, v184
    v_sub_f32 v163, v163, v184
    v_sub_f32 v164, v164, v184
    v_sub_f32 v165, v165, v184
    v_exp_f32 v158, v158
    v_exp_f32 v159, v159
    v_exp_f32 v160, v160
    v_exp_f32 v161, v161
    v_exp_f32 v162, v162
    v_exp_f32 v163, v163
    v_exp_f32 v164, v164
    v_exp_f32 v165, v165
    ds_read_b128 v[122:125], v3 offset:47808
    ds_read_b128 v[126:129], v3 offset:47824
    ds_read_b128 v[130:133], v3 offset:47840
    ds_read_b128 v[134:137], v3 offset:47856
    ds_read_b64 v[138:139], v4 offset:47808
    buffer_load_dwordx4 v234, s[12:15], s61 offen offset:2048 lds
    v_pk_add_f32 v[184:185], v[158:159], v[160:161]
    v_pk_add_f32 v[186:187], v[162:163], v[164:165]
    v_pk_add_f32 v[184:185], v[184:185], v[186:187]
    v_add_f32 v184, v184, v185
    v_rcp_f32 v184, v184
    v_mul_f32 v158, v158, v71
    v_mul_f32 v159, v159, v73
    v_mul_f32 v160, v160, v75
    v_mul_f32 v161, v161, v77
    v_mul_f32 v162, v162, v79
    v_mul_f32 v163, v163, v81
    v_mul_f32 v164, v164, v83
    v_mul_f32 v165, v165, v85
    ds_read_b128 v[140:143], v3 offset:47232
    ds_read_b128 v[144:147], v3 offset:47248
    ds_read_b128 v[148:151], v3 offset:47264
    ds_read_b128 v[152:155], v3 offset:47280
    ds_read_b64 v[156:157], v4 offset:47232
    buffer_load_dwordx4 v235, s[12:15], s61 offen offset:3072 lds
    v_mul_f32 v186, v158, v70
    v_fmac_f32 v186, v159, v72
    v_fmac_f32 v186, v160, v74
    v_fmac_f32 v186, v161, v76
    v_fmac_f32 v186, v162, v78
    v_fmac_f32 v186, v163, v80
    v_fmac_f32_e64 v186, v164, v82
    v_fmac_f32 v186, v165, v84
    s_waitcnt lgkmcnt(15)
    v_pk_mul_f32 v[166:167], v[34:35], v[158:159] op_sel:[0,0] op_sel_hi:[1,0]
    v_pk_mul_f32 v[168:169], v[36:37], v[158:159] op_sel:[0,0] op_sel_hi:[1,0]
    v_pk_mul_f32 v[170:171], v[38:39], v[158:159] op_sel:[0,0] op_sel_hi:[1,0]
    v_pk_mul_f32 v[172:173], v[40:41], v[158:159] op_sel:[0,0] op_sel_hi:[1,0]
    v_pk_mul_f32 v[174:175], v[42:43], v[158:159] op_sel:[0,0] op_sel_hi:[1,0]
    v_pk_mul_f32 v[176:177], v[44:45], v[158:159] op_sel:[0,0] op_sel_hi:[1,0]
    v_pk_mul_f32 v[178:179], v[46:47], v[158:159] op_sel:[0,0] op_sel_hi:[1,0]
    v_pk_mul_f32 v[180:181], v[48:49], v[158:159] op_sel:[0,0] op_sel_hi:[1,0]
    v_pk_mul_f32 v[182:183], v[50:51], v[158:159] op_sel:[0,0] op_sel_hi:[1,0]
    ds_read_b128 v[16:19], v3 offset:46656
    ds_read_b128 v[20:23], v3 offset:46672
    ds_read_b128 v[24:27], v3 offset:46688
    ds_read_b128 v[28:31], v3 offset:46704
    ds_read_b64 v[32:33], v4 offset:46656
    s_add_u32 m0, s54, 17408
    s_nop 0
    buffer_load_dwordx4 v236, s[12:15], s61 offen offset:0 lds
    v_pk_fma_f32 v[166:167], v[52:53], v[158:159], v[166:167] op_sel:[0,1,0] op_sel_hi:[1,1,1]
    v_pk_fma_f32 v[168:169], v[54:55], v[158:159], v[168:169] op_sel:[0,1,0] op_sel_hi:[1,1,1]
    v_pk_fma_f32 v[170:171], v[56:57], v[158:159], v[170:171] op_sel:[0,1,0] op_sel_hi:[1,1,1]
    v_pk_fma_f32 v[172:173], v[58:59], v[158:159], v[172:173] op_sel:[0,1,0] op_sel_hi:[1,1,1]
    v_pk_fma_f32 v[174:175], v[60:61], v[158:159], v[174:175] op_sel:[0,1,0] op_sel_hi:[1,1,1]
    v_pk_fma_f32 v[176:177], v[62:63], v[158:159], v[176:177] op_sel:[0,1,0] op_sel_hi:[1,1,1]
    v_pk_fma_f32 v[178:179], v[64:65], v[158:159], v[178:179] op_sel:[0,1,0] op_sel_hi:[1,1,1]
    v_pk_fma_f32 v[180:181], v[66:67], v[158:159], v[180:181] op_sel:[0,1,0] op_sel_hi:[1,1,1]
    v_pk_fma_f32 v[182:183], v[68:69], v[158:159], v[182:183] op_sel:[0,1,0] op_sel_hi:[1,1,1]
    v_pk_fma_f32 v[166:167], v[86:87], v[160:161], v[166:167] op_sel:[0,0,0] op_sel_hi:[1,0,1]
    v_pk_fma_f32 v[168:169], v[88:89], v[160:161], v[168:169] op_sel:[0,0,0] op_sel_hi:[1,0,1]
    v_pk_fma_f32 v[170:171], v[90:91], v[160:161], v[170:171] op_sel:[0,0,0] op_sel_hi:[1,0,1]
    v_pk_fma_f32 v[172:173], v[92:93], v[160:161], v[172:173] op_sel:[0,0,0] op_sel_hi:[1,0,1]
    v_pk_fma_f32 v[174:175], v[94:95], v[160:161], v[174:175] op_sel:[0,0,0] op_sel_hi:[1,0,1]
    v_pk_fma_f32 v[176:177], v[96:97], v[160:161], v[176:177] op_sel:[0,0,0] op_sel_hi:[1,0,1]
    v_pk_fma_f32 v[178:179], v[98:99], v[160:161], v[178:179] op_sel:[0,0,0] op_sel_hi:[1,0,1]
    v_pk_fma_f32 v[180:181], v[100:101], v[160:161], v[180:181] op_sel:[0,0,0] op_sel_hi:[1,0,1]
    v_pk_fma_f32 v[182:183], v[102:103], v[160:161], v[182:183] op_sel:[0,0,0] op_sel_hi:[1,0,1]
    s_waitcnt lgkmcnt(15)
    ds_read_b128 v[34:37], v3 offset:46080
    ds_read_b128 v[38:41], v3 offset:46096
    ds_read_b128 v[42:45], v3 offset:46112
    ds_read_b128 v[46:49], v3 offset:46128
    ds_read_b64 v[50:51], v4 offset:46080
    s_add_u32 m0, s56, 73728
    s_nop 0
    buffer_load_dwordx4 v237, s[12:15], s55 offen lds
    v_pk_fma_f32 v[166:167], v[104:105], v[160:161], v[166:167] op_sel:[0,1,0] op_sel_hi:[1,1,1]
    v_pk_fma_f32 v[168:169], v[106:107], v[160:161], v[168:169] op_sel:[0,1,0] op_sel_hi:[1,1,1]
    v_pk_fma_f32 v[170:171], v[108:109], v[160:161], v[170:171] op_sel:[0,1,0] op_sel_hi:[1,1,1]
    v_pk_fma_f32 v[172:173], v[110:111], v[160:161], v[172:173] op_sel:[0,1,0] op_sel_hi:[1,1,1]
    v_pk_fma_f32 v[174:175], v[112:113], v[160:161], v[174:175] op_sel:[0,1,0] op_sel_hi:[1,1,1]
    v_pk_fma_f32 v[176:177], v[114:115], v[160:161], v[176:177] op_sel:[0,1,0] op_sel_hi:[1,1,1]
    v_pk_fma_f32 v[178:179], v[116:117], v[160:161], v[178:179] op_sel:[0,1,0] op_sel_hi:[1,1,1]
    v_pk_fma_f32 v[180:181], v[118:119], v[160:161], v[180:181] op_sel:[0,1,0] op_sel_hi:[1,1,1]
    v_pk_fma_f32 v[182:183], v[120:121], v[160:161], v[182:183] op_sel:[0,1,0] op_sel_hi:[1,1,1]
    s_waitcnt lgkmcnt(15)
    v_pk_fma_f32 v[166:167], v[122:123], v[162:163], v[166:167] op_sel:[0,0,0] op_sel_hi:[1,0,1]
    v_pk_fma_f32 v[168:169], v[124:125], v[162:163], v[168:169] op_sel:[0,0,0] op_sel_hi:[1,0,1]
    v_pk_fma_f32 v[170:171], v[126:127], v[162:163], v[170:171] op_sel:[0,0,0] op_sel_hi:[1,0,1]
    v_pk_fma_f32 v[172:173], v[128:129], v[162:163], v[172:173] op_sel:[0,0,0] op_sel_hi:[1,0,1]
    v_pk_fma_f32 v[174:175], v[130:131], v[162:163], v[174:175] op_sel:[0,0,0] op_sel_hi:[1,0,1]
    v_pk_fma_f32 v[176:177], v[132:133], v[162:163], v[176:177] op_sel:[0,0,0] op_sel_hi:[1,0,1]
    v_pk_fma_f32 v[178:179], v[134:135], v[162:163], v[178:179] op_sel:[0,0,0] op_sel_hi:[1,0,1]
    v_pk_fma_f32 v[180:181], v[136:137], v[162:163], v[180:181] op_sel:[0,0,0] op_sel_hi:[1,0,1]
    v_pk_fma_f32 v[182:183], v[138:139], v[162:163], v[182:183] op_sel:[0,0,0] op_sel_hi:[1,0,1]
    s_waitcnt lgkmcnt(10)
    ds_read_b128 v[52:55], v5 offset:46080
    ds_read_b128 v[56:59], v5 offset:46096
    ds_read_b128 v[60:63], v5 offset:46112
    ds_read_b128 v[64:67], v5 offset:46128
    ds_read_b64 v[68:69], v6 offset:46080
    s_add_u32 m0, s56, 77824
    s_nop 0
    buffer_load_dwordx4 v238, s[12:15], s55 offen lds
    v_pk_fma_f32 v[166:167], v[140:141], v[162:163], v[166:167] op_sel:[0,1,0] op_sel_hi:[1,1,1]
    v_pk_fma_f32 v[168:169], v[142:143], v[162:163], v[168:169] op_sel:[0,1,0] op_sel_hi:[1,1,1]
    v_pk_fma_f32 v[170:171], v[144:145], v[162:163], v[170:171] op_sel:[0,1,0] op_sel_hi:[1,1,1]
    v_pk_fma_f32 v[172:173], v[146:147], v[162:163], v[172:173] op_sel:[0,1,0] op_sel_hi:[1,1,1]
    v_pk_fma_f32 v[174:175], v[148:149], v[162:163], v[174:175] op_sel:[0,1,0] op_sel_hi:[1,1,1]
    v_pk_fma_f32 v[176:177], v[150:151], v[162:163], v[176:177] op_sel:[0,1,0] op_sel_hi:[1,1,1]
    v_pk_fma_f32 v[178:179], v[152:153], v[162:163], v[178:179] op_sel:[0,1,0] op_sel_hi:[1,1,1]
    v_pk_fma_f32 v[180:181], v[154:155], v[162:163], v[180:181] op_sel:[0,1,0] op_sel_hi:[1,1,1]
    v_pk_fma_f32 v[182:183], v[156:157], v[162:163], v[182:183] op_sel:[0,1,0] op_sel_hi:[1,1,1]
    s_waitcnt lgkmcnt(10)
    v_pk_fma_f32 v[166:167], v[16:17], v[164:165], v[166:167] op_sel:[0,0,0] op_sel_hi:[1,0,1]
    v_pk_fma_f32 v[168:169], v[18:19], v[164:165], v[168:169] op_sel:[0,0,0] op_sel_hi:[1,0,1]
    v_pk_fma_f32 v[170:171], v[20:21], v[164:165], v[170:171] op_sel:[0,0,0] op_sel_hi:[1,0,1]
    v_pk_fma_f32 v[172:173], v[22:23], v[164:165], v[172:173] op_sel:[0,0,0] op_sel_hi:[1,0,1]
    v_pk_fma_f32 v[174:175], v[24:25], v[164:165], v[174:175] op_sel:[0,0,0] op_sel_hi:[1,0,1]
    v_pk_fma_f32 v[176:177], v[26:27], v[164:165], v[176:177] op_sel:[0,0,0] op_sel_hi:[1,0,1]
    v_pk_fma_f32 v[178:179], v[28:29], v[164:165], v[178:179] op_sel:[0,0,0] op_sel_hi:[1,0,1]
    v_pk_fma_f32 v[180:181], v[30:31], v[164:165], v[180:181] op_sel:[0,0,0] op_sel_hi:[1,0,1]
    v_pk_fma_f32 v[182:183], v[32:33], v[164:165], v[182:183] op_sel:[0,0,0] op_sel_hi:[1,0,1]
    s_waitcnt lgkmcnt(5)
    v_pk_fma_f32 v[166:167], v[34:35], v[164:165], v[166:167] op_sel:[0,1,0] op_sel_hi:[1,1,1]
    v_pk_fma_f32 v[168:169], v[36:37], v[164:165], v[168:169] op_sel:[0,1,0] op_sel_hi:[1,1,1]
    v_pk_fma_f32 v[170:171], v[38:39], v[164:165], v[170:171] op_sel:[0,1,0] op_sel_hi:[1,1,1]
    v_pk_fma_f32 v[172:173], v[40:41], v[164:165], v[172:173] op_sel:[0,1,0] op_sel_hi:[1,1,1]
    v_pk_fma_f32 v[174:175], v[42:43], v[164:165], v[174:175] op_sel:[0,1,0] op_sel_hi:[1,1,1]
    v_pk_fma_f32 v[176:177], v[44:45], v[164:165], v[176:177] op_sel:[0,1,0] op_sel_hi:[1,1,1]
    v_pk_fma_f32 v[178:179], v[46:47], v[164:165], v[178:179] op_sel:[0,1,0] op_sel_hi:[1,1,1]
    v_pk_fma_f32 v[180:181], v[48:49], v[164:165], v[180:181] op_sel:[0,1,0] op_sel_hi:[1,1,1]
    v_pk_fma_f32 v[182:183], v[50:51], v[164:165], v[182:183] op_sel:[0,1,0] op_sel_hi:[1,1,1]
    s_waitcnt lgkmcnt(0)
    v_pk_fma_f32 v[166:167], v[52:53], v[186:187], v[166:167] op_sel:[0,0,0] op_sel_hi:[1,0,1]
    v_pk_fma_f32 v[168:169], v[54:55], v[186:187], v[168:169] op_sel:[0,0,0] op_sel_hi:[1,0,1]
    v_pk_fma_f32 v[170:171], v[56:57], v[186:187], v[170:171] op_sel:[0,0,0] op_sel_hi:[1,0,1]
    v_pk_fma_f32 v[172:173], v[58:59], v[186:187], v[172:173] op_sel:[0,0,0] op_sel_hi:[1,0,1]
    v_pk_fma_f32 v[174:175], v[60:61], v[186:187], v[174:175] op_sel:[0,0,0] op_sel_hi:[1,0,1]
    v_pk_fma_f32 v[176:177], v[62:63], v[186:187], v[176:177] op_sel:[0,0,0] op_sel_hi:[1,0,1]
    v_pk_fma_f32 v[178:179], v[64:65], v[186:187], v[178:179] op_sel:[0,0,0] op_sel_hi:[1,0,1]
    v_pk_fma_f32 v[180:181], v[66:67], v[186:187], v[180:181] op_sel:[0,0,0] op_sel_hi:[1,0,1]
    v_pk_fma_f32 v[182:183], v[68:69], v[186:187], v[182:183] op_sel:[0,0,0] op_sel_hi:[1,0,1]
    v_pk_mul_f32 v[166:167], v[166:167], v[184:185] op_sel:[0,0] op_sel_hi:[1,0]
    v_pk_mul_f32 v[168:169], v[168:169], v[184:185] op_sel:[0,0] op_sel_hi:[1,0]
    v_pk_mul_f32 v[170:171], v[170:171], v[184:185] op_sel:[0,0] op_sel_hi:[1,0]
    v_pk_mul_f32 v[172:173], v[172:173], v[184:185] op_sel:[0,0] op_sel_hi:[1,0]
    v_pk_mul_f32 v[174:175], v[174:175], v[184:185] op_sel:[0,0] op_sel_hi:[1,0]
    v_pk_mul_f32 v[176:177], v[176:177], v[184:185] op_sel:[0,0] op_sel_hi:[1,0]
    v_pk_mul_f32 v[178:179], v[178:179], v[184:185] op_sel:[0,0] op_sel_hi:[1,0]
    v_pk_mul_f32 v[180:181], v[180:181], v[184:185] op_sel:[0,0] op_sel_hi:[1,0]
    v_pk_mul_f32 v[182:183], v[182:183], v[184:185] op_sel:[0,0] op_sel_hi:[1,0]
    v_cvt_pk_bf16_f32 v16, v166, v167
    v_cvt_pk_bf16_f32 v17, v168, v169
    v_cvt_pk_bf16_f32 v18, v170, v171
    v_cvt_pk_bf16_f32 v19, v172, v173
    v_cvt_pk_bf16_f32 v20, v174, v175
    v_cvt_pk_bf16_f32 v21, v176, v177
    v_cvt_pk_bf16_f32 v22, v178, v179
    v_cvt_pk_bf16_f32 v23, v180, v181
    v_cvt_pk_bf16_f32 v24, v182, v183
    s_mul_i32 s57, s47, 18432
    s_add_u32 s57, s57, 1048576
    s_lshl_b32 s49, s45, 11
    s_add_u32 s49, s49, s57
    s_lshl_b32 s50, s45, 8
    s_add_u32 s50, s50, s57
    s_add_u32 s50, s50, 16384
    buffer_store_dwordx4 v[16:19], v2, s[24:27], s49 offen sc1
    buffer_store_dwordx4 v[20:23], v2, s[24:27], s49 offen offset:1024 sc1
    buffer_store_dword v24, v8, s[24:27], s50 offen sc1
    v_and_b32 v10, 15, v1
    v_bfe_u32 v12, v1, 4, 1
    v_lshrrev_b32_e64 v13, 5, v1
    v_mul_u32_u24 v14, 1152, v10
    v_lshl_add_u32 v15, v12, 5, v14
    v_lshl_add_u32 v15, v13, 4, v15
    v_lshl_add_u32 v14, v12, 3, v14
    s_mul_i32 s52, s47, 18432
    s_add_u32 s52, s52, s55
    buffer_load_dwordx4 v[240:243], v15, s[4:7], s52 offen offset:0
    buffer_load_dwordx4 v[244:247], v15, s[4:7], s52 offen offset:64
    buffer_load_dwordx2 v[248:249], v14, s[4:7], s52 offen offset:128
    s_cmp_lt_u32 s10, 81
    s_cbranch_scc1 L_perm
    s_mov_b32 s66, 1073741824
    s_mov_b32 s74, 1073741824
    s_mov_b32 s75, 1073741824
    s_branch L_noperm
L_perm:
    s_waitcnt vmcnt(26)
    v_perm_b32 v120, v194, v190, s76
    v_perm_b32 v121, v202, v198, s76
    v_perm_b32 v122, v210, v206, s76
    v_perm_b32 v123, v218, v214, s76
    v_perm_b32 v124, v194, v190, s77
    v_perm_b32 v125, v202, v198, s77
    v_perm_b32 v126, v210, v206, s77
    v_perm_b32 v127, v218, v214, s77
    v_mfma_f32_16x16x32_bf16 v[32:35], a[96:99], v[120:123], 0
    v_perm_b32 v128, v195, v191, s76
    v_perm_b32 v129, v203, v199, s76
    v_perm_b32 v130, v211, v207, s76
    v_perm_b32 v131, v219, v215, s76
    v_mfma_f32_16x16x32_bf16 v[32:35], a[100:103], v[124:127], v[32:35]
    v_perm_b32 v132, v195, v191, s77
    v_perm_b32 v133, v203, v199, s77
    v_perm_b32 v134, v211, v207, s77
    v_perm_b32 v135, v219, v215, s77
    v_mfma_f32_16x16x32_bf16 v[32:35], a[104:107], v[128:131], v[32:35]
    v_perm_b32 v136, v196, v192, s76
    v_perm_b32 v137, v204, v200, s76
    v_perm_b32 v138, v212, v208, s76
    v_perm_b32 v139, v220, v216, s76
    v_mfma_f32_16x16x32_bf16 v[32:35], a[108:111], v[132:135], v[32:35]
    v_perm_b32 v140, v196, v192, s77
    v_perm_b32 v141, v204, v200, s77
    v_perm_b32 v142, v212, v208, s77
    v_perm_b32 v143, v220, v216, s77
    v_mfma_f32_16x16x32_bf16 v[32:35], a[112:115], v[136:139], v[32:35]
    v_perm_b32 v144, v197, v193, s76
    v_perm_b32 v145, v205, v201, s76
    v_perm_b32 v146, v213, v209, s76
    v_perm_b32 v147, v221, v217, s76
    v_mfma_f32_16x16x32_bf16 v[32:35], a[116:119], v[140:143], v[32:35]
    v_perm_b32 v148, v197, v193, s77
    v_perm_b32 v149, v205, v201, s77
    v_perm_b32 v150, v213, v209, s77
    v_perm_b32 v151, v221, v217, s77
    v_mfma_f32_16x16x32_bf16 v[32:35], a[120:123], v[144:147], v[32:35]
    s_mul_i32 s49, s8, 10
    s_add_u32 s50, s49, s9
    v_mfma_f32_16x16x32_bf16 v[32:35], a[124:127], v[148:151], v[32:35]
    s_lshl_b32 s74, s50, 7
    s_mul_i32 s49, s45, 12288
    s_add_u32 s49, s49, 7340032
    s_add_u32 s74, s74, s49
    s_cmp_eq_u32 s9, 0
    s_cselect_b32 s75, s74, 1073741824
    s_lshl_b32 s66, s10, 11
    s_add_u32 s66, s66, s78
    v_add_f32_dpp v36, v32, v32 row_ror:8 row_mask:0xf bank_mask:0xf
    v_add_f32_dpp v37, v33, v33 row_ror:8 row_mask:0xf bank_mask:0xf
    v_cndmask_b32 v36, v36, v37, s[80:81]
    v_cvt_pk_bf16_f32 v223, v36, v36
L_noperm:
    v_lshlrev_b32 v14, 4, v10
    v_lshl_or_b32 v4, v12, 9, v14
    v_lshl_or_b32 v4, v13, 8, v4
    v_lshl_or_b32 v5, v12, 3, v14
    v_lshlrev_b32_e64 v10, 2, v10
    v_lshl_or_b32 v6, v13, 6, v10
    s_mul_i32 s58, s47, 19456
    s_add_u32 s58, s58, 4194304
    s_mul_i32 s52, s45, 2304
    s_add_u32 s52, s52, s58
    s_lshl_b32 s53, s45, 7
    s_add_u32 s53, s53, s58
    s_add_u32 s53, s53, 18432
    v_mov_b32 v7, 0x3f803f80
    v_and_b32 v8, 31, v1
    v_lshlrev_b32 v8, 13, v8
    s_lshl_b32 s54, s45, 7
    s_add_u32 s54, s54, 2560
    s_lshl_b32 s49, s44, 11
    s_add_u32 s49, s49, s46
    s_lshl_b32 s49, s49, 2
    s_add_u32 s55, s49, s54
    v_mov_b32 v15, 1
    s_cmp_eq_u32 s46, 3
    s_cselect_b32 s54, s54, 1073741824
    s_mov_b32 s60, 0
    v_add_u32 v3, 41472, v9
    s_waitcnt vmcnt(6)
    s_barrier
    ds_read_b64_tr_b16 a[0:1], v9 offset:0
    ds_read_b64_tr_b16 a[2:3], v9 offset:144
    ds_read_b64_tr_b16 a[4:5], v9 offset:32
    ds_read_b64_tr_b16 a[6:7], v9 offset:176
    ds_read_b64_tr_b16 a[8:9], v9 offset:64
    ds_read_b64_tr_b16 a[10:11], v9 offset:208
    ds_read_b64_tr_b16 a[12:13], v9 offset:96
    ds_read_b64_tr_b16 a[14:15], v9 offset:240
    ds_read_b64_tr_b16 a[16:17], v9 offset:128
    ds_read_b64_tr_b16 a[18:19], v9 offset:272
    ds_read_b64_tr_b16 a[20:21], v9 offset:4608
    ds_read_b64_tr_b16 a[22:23], v9 offset:4752
    ds_read_b64_tr_b16 a[24:25], v9 offset:4640
    ds_read_b64_tr_b16 a[26:27], v9 offset:4784
    ds_read_b64_tr_b16 a[28:29], v9 offset:4672
    ds_read_b64_tr_b16 a[30:31], v9 offset:4816
    ds_read_b64_tr_b16 a[32:33], v9 offset:4704
    ds_read_b64_tr_b16 a[34:35], v9 offset:4848
    ds_read_b64_tr_b16 a[36:37], v9 offset:4736
    ds_read_b64_tr_b16 a[38:39], v9 offset:4880
    s_waitcnt vmcnt(3)
    v_mov_b32 v11, 1
    buffer_atomic_add v11, v254, s[24:27], s48 offen offset:0 sc0 sc1
    buffer_store_dwordx4 v[120:123], v0, s[24:27], s66 offen offset:0 sc1
    buffer_store_dwordx4 v[124:127], v0, s[24:27], s66 offen offset:128 sc1
    s_add_u32 s66, s66, 331776
    buffer_store_dwordx4 v[128:131], v0, s[24:27], s66 offen offset:0 sc1
    buffer_store_dwordx4 v[132:135], v0, s[24:27], s66 offen offset:128 sc1
    s_add_u32 s66, s66, 331776
    buffer_store_dwordx4 v[136:139], v0, s[24:27], s66 offen offset:0 sc1
    buffer_store_dwordx4 v[140:143], v0, s[24:27], s66 offen offset:128 sc1
    s_add_u32 s66, s66, 331776
    buffer_store_dwordx4 v[144:147], v0, s[24:27], s66 offen offset:0 sc1
    buffer_store_dwordx4 v[148:151], v0, s[24:27], s66 offen offset:128 sc1
    buffer_store_short v223, v225, s[24:27], s74 offen sc1
    buffer_store_short v222, v225, s[24:27], s75 offen offset:1152 sc1
    s_cmp_lt_u32 s11, 81
    s_cbranch_scc0 L_noperm2
    v_accvgpr_read_b32 v40, a128
    v_accvgpr_read_b32 v41, a129
    v_accvgpr_read_b32 v42, a130
    v_accvgpr_read_b32 v43, a131
    v_accvgpr_read_b32 v44, a132
    v_accvgpr_read_b32 v45, a133
    v_accvgpr_read_b32 v46, a134
    v_accvgpr_read_b32 v47, a135
    v_accvgpr_read_b32 v48, a136
    v_accvgpr_read_b32 v49, a137
    v_accvgpr_read_b32 v50, a138
    v_accvgpr_read_b32 v51, a139
    v_accvgpr_read_b32 v52, a140
    v_accvgpr_read_b32 v53, a141
    v_accvgpr_read_b32 v54, a142
    v_accvgpr_read_b32 v55, a143
    v_accvgpr_read_b32 v56, a144
    v_accvgpr_read_b32 v57, a145
    v_accvgpr_read_b32 v58, a146
    v_accvgpr_read_b32 v59, a147
    v_accvgpr_read_b32 v60, a148
    v_accvgpr_read_b32 v61, a149
    v_accvgpr_read_b32 v62, a150
    v_accvgpr_read_b32 v63, a151
    v_accvgpr_read_b32 v64, a152
    v_accvgpr_read_b32 v65, a153
    v_accvgpr_read_b32 v66, a154
    v_accvgpr_read_b32 v67, a155
    v_accvgpr_read_b32 v68, a156
    v_accvgpr_read_b32 v69, a157
    v_accvgpr_read_b32 v70, a158
    v_accvgpr_read_b32 v71, a159
    v_perm_b32 v152, v44, v40, s76
    v_perm_b32 v153, v52, v48, s76
    v_perm_b32 v154, v60, v56, s76
    v_perm_b32 v155, v68, v64, s76
    v_perm_b32 v156, v44, v40, s77
    v_perm_b32 v157, v52, v48, s77
    v_perm_b32 v158, v60, v56, s77
    v_perm_b32 v159, v68, v64, s77
    v_perm_b32 v160, v45, v41, s76
    v_perm_b32 v161, v53, v49, s76
    v_perm_b32 v162, v61, v57, s76
    v_perm_b32 v163, v69, v65, s76
    v_perm_b32 v164, v45, v41, s77
    v_perm_b32 v165, v53, v49, s77
    v_perm_b32 v166, v61, v57, s77
    v_perm_b32 v167, v69, v65, s77
    v_perm_b32 v168, v46, v42, s76
    v_perm_b32 v169, v54, v50, s76
    v_perm_b32 v170, v62, v58, s76
    v_perm_b32 v171, v70, v66, s76
    v_perm_b32 v172, v46, v42, s77
    v_perm_b32 v173, v54, v50, s77
    v_perm_b32 v174, v62, v58, s77
    v_perm_b32 v175, v70, v66, s77
    v_perm_b32 v176, v47, v43, s76
    v_perm_b32 v177, v55, v51, s76
    v_perm_b32 v178, v63, v59, s76
    v_perm_b32 v179, v71, v67, s76
    v_perm_b32 v180, v47, v43, s77
    v_perm_b32 v181, v55, v51, s77
    v_perm_b32 v182, v63, v59, s77
L_pg3:
    s_cbranch_execz L_pg7
    v_perm_b32 v183, v71, v67, s77
L_noperm2:
    ds_read_b64_tr_b16 a[40:41], v9 offset:9216
    ds_read_b64_tr_b16 a[42:43], v9 offset:9360
    ds_read_b64_tr_b16 a[44:45], v9 offset:9248
    ds_read_b64_tr_b16 a[46:47], v9 offset:9392
    ds_read_b64_tr_b16 a[48:49], v9 offset:9280
    ds_read_b64_tr_b16 a[50:51], v9 offset:9424
    ds_read_b64_tr_b16 a[52:53], v9 offset:9312
    ds_read_b64_tr_b16 a[54:55], v9 offset:9456
    ds_read_b64_tr_b16 a[56:57], v9 offset:9344
    ds_read_b64_tr_b16 a[58:59], v9 offset:9488
    s_waitcnt vmcnt(10)
    v_readfirstlane_b32 s50, v11
    s_cmp_ge_u32 s50, 7
    s_cbranch_scc0 chk_2
    s_call_b64 s[84:85], L_oload
    s_branch chk_1
chk_2:
    v_mov_b32_e64 v11, 0
    buffer_atomic_add v11, v254, s[24:27], s48 offen offset:0 sc0 sc1
chk_1:
    v_permlane16_swap_b32 v240, v242
    v_permlane16_swap_b32 v241, v243
    v_permlane16_swap_b32 v244, v246
    v_permlane16_swap_b32 v245, v247
    v_lshlrev_b32_e64 v208, 16, v248
    v_and_b32 v209, 0xffff0000, v248
    v_lshlrev_b32_e64 v210, 16, v249
    v_and_b32 v211, 0xffff0000, v249
    v_lshlrev_b32_e64 v192, 16, v240
    v_and_b32 v193, 0xffff0000, v240
    v_lshlrev_b32_e64 v194, 16, v241
    v_and_b32 v195, 0xffff0000, v241
    v_lshlrev_b32_e64 v196, 16, v242
    v_and_b32 v197, 0xffff0000, v242
    v_lshlrev_b32_e64 v198, 16, v243
    v_and_b32 v199, 0xffff0000, v243
    v_lshlrev_b32_e64 v200, 16, v244
    v_and_b32 v201, 0xffff0000, v244
    v_lshlrev_b32_e64 v202, 16, v245
    v_and_b32 v203, 0xffff0000, v245
    v_lshlrev_b32_e64 v204, 16, v246
    v_and_b32 v205, 0xffff0000, v246
    v_lshlrev_b32_e64 v206, 16, v247
    v_and_b32 v207, 0xffff0000, v247
    ds_read_b64_tr_b16 a[60:61], v9 offset:13824
    ds_read_b64_tr_b16 a[62:63], v9 offset:13968
    ds_read_b64_tr_b16 a[64:65], v9 offset:13856
    ds_read_b64_tr_b16 a[66:67], v9 offset:14000
    ds_read_b64_tr_b16 a[68:69], v9 offset:13888
    ds_read_b64_tr_b16 a[70:71], v9 offset:14032
    ds_read_b64_tr_b16 a[72:73], v9 offset:13920
    ds_read_b64_tr_b16 a[74:75], v9 offset:14064
    ds_read_b64_tr_b16 a[76:77], v9 offset:13952
    ds_read_b64_tr_b16 a[78:79], v9 offset:14096
    ds_read_b64_tr_b16 a[80:81], v9 offset:18432
    ds_read_b64_tr_b16 a[82:83], v9 offset:18576
    ds_read_b64_tr_b16 a[84:85], v9 offset:18464
    ds_read_b64_tr_b16 a[86:87], v9 offset:18608
    ds_read_b64_tr_b16 a[88:89], v9 offset:18496
    ds_read_b64_tr_b16 a[90:91], v9 offset:18640
    ds_read_b64_tr_b16 a[92:93], v9 offset:18528
    ds_read_b64_tr_b16 a[94:95], v9 offset:18672
    ds_read_b64_tr_b16 a[96:97], v9 offset:18560
    ds_read_b64_tr_b16 a[98:99], v9 offset:18704
    ds_read_b64_tr_b16 a[100:101], v9 offset:23040
    ds_read_b64_tr_b16 a[102:103], v9 offset:23184
    ds_read_b64_tr_b16 a[104:105], v9 offset:23072
    ds_read_b64_tr_b16 a[106:107], v9 offset:23216
    ds_read_b64_tr_b16 a[108:109], v9 offset:23104
    ds_read_b64_tr_b16 a[110:111], v9 offset:23248
    ds_read_b64_tr_b16 a[112:113], v9 offset:23136
    ds_read_b64_tr_b16 a[114:115], v9 offset:23280
    ds_read_b64_tr_b16 a[116:117], v9 offset:23168
    ds_read_b64_tr_b16 a[118:119], v9 offset:23312
    ds_read_b64_tr_b16 a[120:121], v9 offset:27648
    ds_read_b64_tr_b16 a[122:123], v9 offset:27792
    ds_read_b64_tr_b16 a[124:125], v9 offset:27680
    ds_read_b64_tr_b16 a[126:127], v9 offset:27824
    ds_read_b64_tr_b16 a[128:129], v9 offset:27712
    ds_read_b64_tr_b16 a[130:131], v9 offset:27856
    ds_read_b64_tr_b16 a[132:133], v9 offset:27744
    ds_read_b64_tr_b16 a[134:135], v9 offset:27888
    ds_read_b64_tr_b16 a[136:137], v9 offset:27776
    ds_read_b64_tr_b16 a[138:139], v9 offset:27920
    ds_read_b64_tr_b16 a[140:141], v9 offset:32256
    ds_read_b64_tr_b16 a[142:143], v9 offset:32400
    ds_read_b64_tr_b16 a[144:145], v9 offset:32288
    ds_read_b64_tr_b16 a[146:147], v9 offset:32432
    ds_read_b64_tr_b16 a[148:149], v9 offset:32320
    ds_read_b64_tr_b16 a[150:151], v9 offset:32464
    ds_read_b64_tr_b16 a[152:153], v9 offset:32352
    ds_read_b64_tr_b16 a[154:155], v9 offset:32496
    ds_read_b64_tr_b16 a[156:157], v9 offset:32384
    ds_read_b64_tr_b16 a[158:159], v9 offset:32528
    s_cmp_eq_u32 s60, 1
    s_cbranch_scc0 L_sfw
    s_waitcnt vmcnt(9)
    buffer_store_dword v15, v254, s[24:27], s55 offen sc1
    s_branch chk_3
L_sfw:
    s_waitcnt vmcnt(0)
    buffer_store_dword v15, v254, s[24:27], s55 offen sc1
    v_readfirstlane_b32 s50, v11
    s_cmp_ge_u32 s50, 8
    s_cbranch_scc0 chk_4
    s_call_b64 s[84:85], L_oload
    s_branch chk_3
chk_4:
    v_mov_b32_e64 v11, 0
    buffer_atomic_add v11, v254, s[24:27], s48 offen offset:0 sc0 sc1
chk_3:
    ds_read_b64_tr_b16 a[160:161], v9 offset:36864
    ds_read_b64_tr_b16 a[162:163], v9 offset:37008
    ds_read_b64_tr_b16 a[164:165], v9 offset:36896
    ds_read_b64_tr_b16 a[166:167], v9 offset:37040
    ds_read_b64_tr_b16 a[168:169], v9 offset:36928
    ds_read_b64_tr_b16 a[170:171], v9 offset:37072
    ds_read_b64_tr_b16 a[172:173], v9 offset:36960
    ds_read_b64_tr_b16 a[174:175], v9 offset:37104
    ds_read_b64_tr_b16 a[176:177], v9 offset:36992
    ds_read_b64_tr_b16 a[178:179], v9 offset:37136
    ds_read_b64_tr_b16 a[180:181], v3 offset:0
    ds_read_b64_tr_b16 a[182:183], v3 offset:144
    ds_read_b64_tr_b16 a[184:185], v3 offset:32
    ds_read_b64_tr_b16 a[186:187], v3 offset:176
    ds_read_b64_tr_b16 a[188:189], v3 offset:64
    ds_read_b64_tr_b16 a[190:191], v3 offset:208
    ds_read_b64_tr_b16 a[192:193], v3 offset:96
    ds_read_b64_tr_b16 a[194:195], v3 offset:240
    ds_read_b64_tr_b16 a[196:197], v3 offset:128
    ds_read_b64_tr_b16 a[198:199], v3 offset:272
    ds_read_b64_tr_b16 a[200:201], v3 offset:4608
    ds_read_b64_tr_b16 a[202:203], v3 offset:4752
    ds_read_b64_tr_b16 a[204:205], v3 offset:4640
    ds_read_b64_tr_b16 a[206:207], v3 offset:4784
    ds_read_b64_tr_b16 a[208:209], v3 offset:4672
    ds_read_b64_tr_b16 a[210:211], v3 offset:4816
    ds_read_b64_tr_b16 a[212:213], v3 offset:4704
    ds_read_b64_tr_b16 a[214:215], v3 offset:4848
    ds_read_b64_tr_b16 a[216:217], v3 offset:4736
    ds_read_b64_tr_b16 a[218:219], v3 offset:4880
    ds_read_b64_tr_b16 a[220:221], v3 offset:9216
    ds_read_b64_tr_b16 a[222:223], v3 offset:9360
    ds_read_b64_tr_b16 a[224:225], v3 offset:9248
    ds_read_b64_tr_b16 a[226:227], v3 offset:9392
    ds_read_b64_tr_b16 a[228:229], v3 offset:9280
    ds_read_b64_tr_b16 a[230:231], v3 offset:9424
    ds_read_b64_tr_b16 a[232:233], v3 offset:9312
    ds_read_b64_tr_b16 a[234:235], v3 offset:9456
    ds_read_b64_tr_b16 a[236:237], v3 offset:9344
    ds_read_b64_tr_b16 a[238:239], v3 offset:9488
    ds_read_b64_tr_b16 a[240:241], v3 offset:13824
    ds_read_b64_tr_b16 a[242:243], v3 offset:13968
    ds_read_b64_tr_b16 a[244:245], v3 offset:13856
    ds_read_b64_tr_b16 a[246:247], v3 offset:14000
    ds_read_b64_tr_b16 a[248:249], v3 offset:13888
    ds_read_b64_tr_b16 a[250:251], v3 offset:14032
    ds_read_b64_tr_b16 a[252:253], v3 offset:13920
    ds_read_b64_tr_b16 a[254:255], v3 offset:14064
    ds_read_b64_tr_b16 v[16:17], v3 offset:13952
    ds_read_b64_tr_b16 v[18:19], v3 offset:14096
    s_cmp_eq_u32 s60, 1
    s_cbranch_scc1 chk_5
    s_waitcnt vmcnt(0)
    v_readfirstlane_b32 s50, v11
    s_cmp_ge_u32 s50, 8
    s_cbranch_scc0 chk_6
    s_call_b64 s[84:85], L_oload
    s_branch chk_5
chk_6:
    v_mov_b32_e64 v11, 0
    buffer_atomic_add v11, v254, s[24:27], s48 offen offset:0 sc0 sc1
chk_5:
    ds_read_b64_tr_b16 v[20:21], v3 offset:18432
    ds_read_b64_tr_b16 v[22:23], v3 offset:18576
    ds_read_b64_tr_b16 v[24:25], v3 offset:18464
    ds_read_b64_tr_b16 v[26:27], v3 offset:18608
    ds_read_b64_tr_b16 v[28:29], v3 offset:18496
    ds_read_b64_tr_b16 v[30:31], v3 offset:18640
    ds_read_b64_tr_b16 v[32:33], v3 offset:18528
    ds_read_b64_tr_b16 v[34:35], v3 offset:18672
    ds_read_b64_tr_b16 v[36:37], v3 offset:18560
    ds_read_b64_tr_b16 v[38:39], v3 offset:18704
    ds_read_b64_tr_b16 v[40:41], v3 offset:23040
    ds_read_b64_tr_b16 v[42:43], v3 offset:23184
    ds_read_b64_tr_b16 v[44:45], v3 offset:23072
    ds_read_b64_tr_b16 v[46:47], v3 offset:23216
    ds_read_b64_tr_b16 v[48:49], v3 offset:23104
    ds_read_b64_tr_b16 v[50:51], v3 offset:23248
    ds_read_b64_tr_b16 v[52:53], v3 offset:23136
    ds_read_b64_tr_b16 v[54:55], v3 offset:23280
    ds_read_b64_tr_b16 v[56:57], v3 offset:23168
    ds_read_b64_tr_b16 v[58:59], v3 offset:23312
    ds_read_b64_tr_b16 v[60:61], v3 offset:27648
    ds_read_b64_tr_b16 v[62:63], v3 offset:27792
    ds_read_b64_tr_b16 v[64:65], v3 offset:27680
    ds_read_b64_tr_b16 v[66:67], v3 offset:27824
    ds_read_b64_tr_b16 v[68:69], v3 offset:27712
    ds_read_b64_tr_b16 v[70:71], v3 offset:27856
    ds_read_b64_tr_b16 v[72:73], v3 offset:27744
    ds_read_b64_tr_b16 v[74:75], v3 offset:27888
    ds_read_b64_tr_b16 v[76:77], v3 offset:27776
    ds_read_b64_tr_b16 v[78:79], v3 offset:27920
    ds_read_b64_tr_b16 v[80:81], v3 offset:32256
    ds_read_b64_tr_b16 v[82:83], v3 offset:32400
    ds_read_b64_tr_b16 v[84:85], v3 offset:32288
    ds_read_b64_tr_b16 v[86:87], v3 offset:32432
    ds_read_b64_tr_b16 v[88:89], v3 offset:32320
    ds_read_b64_tr_b16 v[90:91], v3 offset:32464
    ds_read_b64_tr_b16 v[92:93], v3 offset:32352
    ds_read_b64_tr_b16 v[94:95], v3 offset:32496
    ds_read_b64_tr_b16 v[96:97], v3 offset:32384
    ds_read_b64_tr_b16 v[98:99], v3 offset:32528
    ds_read_b64_tr_b16 v[100:101], v3 offset:36864
    ds_read_b64_tr_b16 v[102:103], v3 offset:37008
    ds_read_b64_tr_b16 v[104:105], v3 offset:36896
    ds_read_b64_tr_b16 v[106:107], v3 offset:37040
    ds_read_b64_tr_b16 v[108:109], v3 offset:36928
    ds_read_b64_tr_b16 v[110:111], v3 offset:37072
    ds_read_b64_tr_b16 v[112:113], v3 offset:36960
    ds_read_b64_tr_b16 v[114:115], v3 offset:37104
    ds_read_b64_tr_b16 v[116:117], v3 offset:36992
    ds_read_b64_tr_b16 v[118:119], v3 offset:37136
    s_cmp_eq_u32 s60, 1
    s_cbranch_scc1 L_ogo
    s_waitcnt vmcnt(0)
    v_readfirstlane_b32 s50, v11
    s_mov_b32 s49, 0
    s_cmp_ge_u32 s50, 8
    s_cbranch_scc1 spout_8
spin_7:
    v_mov_b32 v11, 0
    buffer_atomic_add v11, v254, s[24:27], s48 offen offset:0 sc0 sc1
    s_add_u32 s49, s49, 1
    s_waitcnt vmcnt(0)
    v_readfirstlane_b32 s50, v11
    s_cmp_ge_u32 s49, 262144
    s_cbranch_scc1 spout_8
    s_cmp_ge_u32 s50, 8
    s_cbranch_scc0 spin_7
spout_8:
    s_call_b64 s[84:85], L_oload
    s_branch L_ogo
L_oload:
    buffer_load_dwordx4 v[120:123], v2, s[24:27], s57 offen offset:0 sc1
    buffer_load_dwordx4 v[124:127], v2, s[24:27], s57 offen offset:1024 sc1
    buffer_load_dwordx4 v[128:131], v2, s[24:27], s57 offen offset:2048 sc1
    buffer_load_dwordx4 v[132:135], v2, s[24:27], s57 offen offset:3072 sc1
    s_add_u32 s57, s57, 4096
    buffer_load_dwordx4 v[136:139], v2, s[24:27], s57 offen offset:0 sc1
    buffer_load_dwordx4 v[140:143], v2, s[24:27], s57 offen offset:1024 sc1
    buffer_load_dwordx4 v[144:147], v2, s[24:27], s57 offen offset:2048 sc1
    buffer_load_dwordx4 v[148:151], v2, s[24:27], s57 offen offset:3072 sc1
    s_add_u32 s57, s57, 4096
    buffer_load_dwordx4 v[184:187], v2, s[24:27], s57 offen offset:0 sc1
    s_mov_b32 s60, 1
    s_setpc_b64 s[84:85]
L_ogo:
    s_waitcnt vmcnt(8) lgkmcnt(15)
    v_mfma_f32_16x16x32_bf16 v[192:195], a[0:3], v[120:123], v[192:195]
    buffer_load_dwordx4 v[188:191], v2, s[24:27], s57 offen offset:1024 sc1
    v_mfma_f32_16x16x32_bf16 v[196:199], a[4:7], v[120:123], v[196:199]
    v_add_u32 v228, 86016, v2
    v_add_u32 v229, 124928, v2
    v_mfma_f32_16x16x32_bf16 v[200:203], a[8:11], v[120:123], v[200:203]
    v_add_u32 v230, 40960, v2
    s_lshr_b32 s49, s46, 1
    v_mfma_f32_16x16x32_bf16 v[204:207], a[12:15], v[120:123], v[204:207]
    s_lshl_b32 s49, s49, 12
    s_and_b32 s50, s46, 1
    v_mfma_f32_16x16x32_bf16 v[208:211], a[16:19], v[120:123], v[208:211]
    s_lshl_b32 s50, s50, 3
    s_waitcnt vmcnt(8)
    v_mfma_f32_16x16x32_bf16 v[192:195], a[20:23], v[124:127], v[192:195]
    buffer_load_dwordx4 v[120:123], v2, s[24:27], s57 offen offset:2048 sc1
    v_mfma_f32_16x16x32_bf16 v[196:199], a[24:27], v[124:127], v[196:199]
    s_add_u32 s49, s49, s50
    v_add_u32 v231, s49, v2
    v_mfma_f32_16x16x32_bf16 v[200:203], a[28:31], v[124:127], v[200:203]
    v_add_u32 v232, s49, v230
    v_lshrrev_b32 v222, 2, v1
    v_mfma_f32_16x16x32_bf16 v[204:207], a[32:35], v[124:127], v[204:207]
    v_and_b32 v223, 9, v222
    v_and_b32 v224, 3, v222
    v_mfma_f32_16x16x32_bf16 v[208:211], a[36:39], v[124:127], v[208:211]
    s_mov_b32 s66, 0
    s_waitcnt vmcnt(8)
    v_mfma_f32_16x16x32_bf16 v[192:195], a[40:43], v[128:131], v[192:195]
    buffer_load_dwordx4 v[124:127], v2, s[24:27], s57 offen offset:3072 sc1
    s_add_u32 s57, s57, 4096
    v_mfma_f32_16x16x32_bf16 v[196:199], a[44:47], v[128:131], v[196:199]
    s_mov_b32 s67, 0xffff
    v_cndmask_b32 v222, v222, v223, s[66:67]
    v_mfma_f32_16x16x32_bf16 v[200:203], a[48:51], v[128:131], v[200:203]
    s_mov_b32 s67, 0xffff0000
    v_cndmask_b32 v222, v222, v224, s[66:67]
    v_mfma_f32_16x16x32_bf16 v[204:207], a[52:55], v[128:131], v[204:207]
    v_and_b32 v223, 3, v1
    v_lshlrev_b32 v223, 3, v223
    v_mfma_f32_16x16x32_bf16 v[208:211], a[56:59], v[128:131], v[208:211]
    v_lshl_or_b32 v222, v222, 7, v223
    s_waitcnt vmcnt(8)
    v_mfma_f32_16x16x32_bf16 v[192:195], a[60:63], v[132:135], v[192:195]
    buffer_load_dwordx4 v[128:131], v2, s[24:27], s57 offen offset:0 sc1
    v_mfma_f32_16x16x32_bf16 v[196:199], a[64:67], v[132:135], v[196:199]
    s_lshl_b32 s49, s46, 5
    s_add_u32 s49, s49, 73728
    v_mfma_f32_16x16x32_bf16 v[200:203], a[68:71], v[132:135], v[200:203]
    v_add_u32 v233, s49, v222
    v_lshrrev_b32 v222, 4, v1
    v_mfma_f32_16x16x32_bf16 v[204:207], a[72:75], v[132:135], v[204:207]
    v_mul_u32_u24 v222, 19456, v222
    v_and_b32_e64 v223, 15, v1
    v_mfma_f32_16x16x32_bf16 v[208:211], a[76:79], v[132:135], v[208:211]
    v_lshl_add_u32 v222, v223, 2, v222
    s_waitcnt vmcnt(8)
    v_mfma_f32_16x16x32_bf16 v[192:195], a[80:83], v[136:139], v[192:195]
    buffer_load_dwordx4 v[132:135], v2, s[24:27], s57 offen offset:1024 sc1
    v_mfma_f32_16x16x32_bf16 v[196:199], a[84:87], v[136:139], v[196:199]
    v_add_u32 v234, 104448, v222
    s_mul_i32 s76, s47, 163840
    v_mfma_f32_16x16x32_bf16 v[200:203], a[88:91], v[136:139], v[200:203]
    s_add_u32 s76, s76, 20971520
    s_add_u32 s77, s76, 16384
    v_mfma_f32_16x16x32_bf16 v[204:207], a[92:95], v[136:139], v[204:207]
    s_mul_i32 s56, s45, 20480
    s_add_u32 s56, s56, s76
    v_mfma_f32_16x16x32_bf16 v[208:211], a[96:99], v[136:139], v[208:211]
    s_mul_i32 s59, s46, 331776
    s_waitcnt vmcnt(8)
    v_mfma_f32_16x16x32_bf16 v[192:195], a[100:103], v[140:143], v[192:195]
    buffer_load_dwordx4 v[136:139], v2, s[24:27], s57 offen offset:2048 sc1
    v_mfma_f32_16x16x32_bf16 v[196:199], a[104:107], v[140:143], v[196:199]
    s_add_u32 s59, s59, s78
    s_mul_i32 s78, s46, 19456
    v_mfma_f32_16x16x32_bf16 v[200:203], a[108:111], v[140:143], v[200:203]
    s_add_u32 s78, s78, 86016
    s_mul_i32 s49, s46, 3072
    v_mfma_f32_16x16x32_bf16 v[204:207], a[112:115], v[140:143], v[204:207]
    s_add_u32 m0, s49, 73728
    s_mul_i32 s79, s45, 12288
    v_mfma_f32_16x16x32_bf16 v[208:211], a[116:119], v[140:143], v[208:211]
    s_add_u32 s79, s79, s49
    s_waitcnt vmcnt(8)
    v_mfma_f32_16x16x32_bf16 v[192:195], a[120:123], v[144:147], v[192:195]
    buffer_load_dwordx4 v[140:143], v2, s[24:27], s57 offen offset:3072 sc1
    s_add_u32 s57, s57, 4096
    v_mfma_f32_16x16x32_bf16 v[196:199], a[124:127], v[144:147], v[196:199]
    s_add_u32 s79, s79, 7340032
    v_lshrrev_b32_e64 v222, 4, v1
    v_mfma_f32_16x16x32_bf16 v[200:203], a[128:131], v[144:147], v[200:203]
    v_and_b32 v223, 3, v1
    v_lshlrev_b32 v223, 4, v223
    v_mfma_f32_16x16x32_bf16 v[204:207], a[132:135], v[144:147], v[204:207]
    v_lshl_or_b32 v222, v222, 6, v223
    v_mov_b32_e64 v235, 1073741824
    v_mfma_f32_16x16x32_bf16 v[208:211], a[136:139], v[144:147], v[208:211]
    s_mul_i32 s49, s46, 2304
    s_waitcnt vmcnt(8)
    v_mfma_f32_16x16x32_bf16 v[192:195], a[140:143], v[148:151], v[192:195]
    buffer_load_dwordx4 v[144:147], v2, s[24:27], s57 offen offset:0 sc1
    v_mfma_f32_16x16x32_bf16 v[196:199], a[144:147], v[148:151], v[196:199]
    s_add_u32 s49, s49, 73728
    v_add_u32 v236, s49, v2
    v_mfma_f32_16x16x32_bf16 v[200:203], a[148:151], v[148:151], v[200:203]
    v_add_u32_e64 v225, s49, v222
    v_add_u32 v226, 82944, v2
    v_mfma_f32_16x16x32_bf16 v[204:207], a[152:155], v[148:151], v[204:207]
    v_bfe_u32 v223, v1, 2, 2
    v_add_u32_e64 v223, 0, v223
    v_mfma_f32_16x16x32_bf16 v[208:211], a[156:159], v[148:151], v[208:211]
    v_sub_u32 v224, s45, v223
    s_waitcnt vmcnt(8)
    v_mfma_f32_16x16x32_bf16 v[192:195], a[160:163], v[184:187], v[192:195]
    buffer_load_dwordx4 v[148:151], v2, s[24:27], s57 offen offset:1024 sc1
    v_mfma_f32_16x16x32_bf16 v[196:199], a[164:167], v[184:187], v[196:199]
    v_and_b32 v224, 7, v224
    v_cmp_eq_u32 vcc, 0, v224
    v_mfma_f32_16x16x32_bf16 v[200:203], a[168:171], v[184:187], v[200:203]
    v_mul_u32_u24 v223, 20480, v223
    v_add_u32_e64 v223, v223, v222
    v_mfma_f32_16x16x32_bf16 v[204:207], a[172:175], v[184:187], v[204:207]
    v_cndmask_b32 v223, v223, v235, vcc
    v_cndmask_b32 v241, v226, v225, vcc
    v_mfma_f32_16x16x32_bf16 v[208:211], a[176:179], v[184:187], v[208:211]
    v_lshl_add_u32 v237, v224, 11, v223
    s_waitcnt vmcnt(8)
    v_mfma_f32_16x16x32_bf16 v[192:195], a[180:183], v[188:191], v[192:195]
    v_lshl_add_u32 v239, v224, 9, v223
    v_bfe_u32 v223, v1, 2, 2
    v_mfma_f32_16x16x32_bf16 v[196:199], a[184:187], v[188:191], v[196:199]
    v_add_u32 v223, 4, v223
    v_sub_u32_e64 v224, s45, v223
    v_mfma_f32_16x16x32_bf16 v[200:203], a[188:191], v[188:191], v[200:203]
    v_and_b32 v224, 7, v224
    v_cmp_eq_u32 vcc, 0, v224
    v_mfma_f32_16x16x32_bf16 v[204:207], a[192:195], v[188:191], v[204:207]
    v_mul_u32_u24 v223, 20480, v223
    v_add_u32_e64 v223, v223, v222
    v_mfma_f32_16x16x32_bf16 v[208:211], a[196:199], v[188:191], v[208:211]
    v_cndmask_b32 v223, v223, v235, vcc
    s_waitcnt vmcnt(7)
    v_mfma_f32_16x16x32_bf16 v[192:195], a[200:203], v[120:123], v[192:195]
    buffer_load_dwordx4 v[12:15], v8, s[24:27], s54 offen sc1
    v_mfma_f32_16x16x32_bf16 v[196:199], a[204:207], v[120:123], v[196:199]
    v_cndmask_b32 v242, v226, v225, vcc
    v_lshl_add_u32 v238, v224, 11, v223
    v_mfma_f32_16x16x32_bf16 v[200:203], a[208:211], v[120:123], v[200:203]
    v_lshl_add_u32 v240, v224, 9, v223
    v_mfma_f32_16x16x32_bf16 v[204:207], a[212:215], v[120:123], v[204:207]
    v_mfma_f32_16x16x32_bf16 v[208:211], a[216:219], v[120:123], v[208:211]
    s_waitcnt vmcnt(7)
    v_mfma_f32_16x16x32_bf16 v[192:195], a[220:223], v[124:127], v[192:195]
    v_mfma_f32_16x16x32_bf16 v[196:199], a[224:227], v[124:127], v[196:199]
    v_mfma_f32_16x16x32_bf16 v[200:203], a[228:231], v[124:127], v[200:203]
    v_mfma_f32_16x16x32_bf16 v[204:207], a[232:235], v[124:127], v[204:207]
    v_mfma_f32_16x16x32_bf16 v[208:211], a[236:239], v[124:127], v[208:211]
    s_waitcnt vmcnt(6)
    v_mfma_f32_16x16x32_bf16 v[192:195], a[240:243], v[128:131], v[192:195]
    v_mfma_f32_16x16x32_bf16 v[196:199], a[244:247], v[128:131], v[196:199]
    v_mfma_f32_16x16x32_bf16 v[200:203], a[248:251], v[128:131], v[200:203]
    v_mfma_f32_16x16x32_bf16 v[204:207], a[252:255], v[128:131], v[204:207]
    v_mfma_f32_16x16x32_bf16 v[208:211], v[16:19], v[128:131], v[208:211]
    s_waitcnt vmcnt(5)
    v_mfma_f32_16x16x32_bf16 v[192:195], v[20:23], v[132:135], v[192:195]
    v_mfma_f32_16x16x32_bf16 v[196:199], v[24:27], v[132:135], v[196:199]
    v_mfma_f32_16x16x32_bf16 v[200:203], v[28:31], v[132:135], v[200:203]
    v_mfma_f32_16x16x32_bf16 v[204:207], v[32:35], v[132:135], v[204:207]
    v_mfma_f32_16x16x32_bf16 v[208:211], v[36:39], v[132:135], v[208:211]
    s_waitcnt vmcnt(4)
    v_mfma_f32_16x16x32_bf16 v[192:195], v[40:43], v[136:139], v[192:195]
    v_mfma_f32_16x16x32_bf16 v[196:199], v[44:47], v[136:139], v[196:199]
    v_mfma_f32_16x16x32_bf16 v[200:203], v[48:51], v[136:139], v[200:203]
    v_mfma_f32_16x16x32_bf16 v[204:207], v[52:55], v[136:139], v[204:207]
    v_mfma_f32_16x16x32_bf16 v[208:211], v[56:59], v[136:139], v[208:211]
    s_waitcnt vmcnt(3)
    v_mfma_f32_16x16x32_bf16 v[192:195], v[60:63], v[140:143], v[192:195]
    v_mfma_f32_16x16x32_bf16 v[196:199], v[64:67], v[140:143], v[196:199]
    v_mfma_f32_16x16x32_bf16 v[200:203], v[68:71], v[140:143], v[200:203]
    v_mfma_f32_16x16x32_bf16 v[204:207], v[72:75], v[140:143], v[204:207]
    v_mfma_f32_16x16x32_bf16 v[208:211], v[76:79], v[140:143], v[208:211]
    s_waitcnt vmcnt(2) lgkmcnt(10)
    v_mfma_f32_16x16x32_bf16 v[192:195], v[80:83], v[144:147], v[192:195]
    v_mfma_f32_16x16x32_bf16 v[196:199], v[84:87], v[144:147], v[196:199]
    v_mfma_f32_16x16x32_bf16 v[200:203], v[88:91], v[144:147], v[200:203]
    v_mfma_f32_16x16x32_bf16 v[204:207], v[92:95], v[144:147], v[204:207]
    v_mfma_f32_16x16x32_bf16 v[208:211], v[96:99], v[144:147], v[208:211]
    s_waitcnt vmcnt(1) lgkmcnt(0)
    v_mfma_f32_16x16x32_bf16 v[192:195], v[100:103], v[148:151], v[192:195]
    v_mfma_f32_16x16x32_bf16 v[196:199], v[104:107], v[148:151], v[196:199]
    v_mfma_f32_16x16x32_bf16 v[200:203], v[108:111], v[148:151], v[200:203]
    v_mfma_f32_16x16x32_bf16 v[204:207], v[112:115], v[148:151], v[204:207]
    v_mfma_f32_16x16x32_bf16 v[208:211], v[116:119], v[148:151], v[208:211]
    s_mov_b32 s49, 0
    s_cmp_eq_u32 s46, 3
    s_cbranch_scc0 L_sfok
    s_waitcnt vmcnt(0)
L_sf:
    v_min3_u32 v12, v12, v13, v14
    v_min_u32_e64 v12, v12, v15
    v_cmp_gt_u32 vcc, 1, v12
    s_cbranch_vccz L_sfok
    buffer_load_dwordx4 v[12:15], v8, s[24:27], s54 offen sc1
    s_add_u32 s49, s49, 1
    s_cmp_lt_u32 s49, 262144
    s_waitcnt vmcnt(0)
    s_cbranch_scc1 L_sf
L_sfok:
    s_nop 0
    v_cvt_pk_bf16_f32 v212, v192, v193
    v_cvt_pk_bf16_f32 v213, v194, v195
    v_cvt_pk_bf16_f32 v214, v196, v197
    v_cvt_pk_bf16_f32 v215, v198, v199
    v_cvt_pk_bf16_f32 v216, v200, v201
    v_cvt_pk_bf16_f32 v217, v202, v203
    v_cvt_pk_bf16_f32 v218, v204, v205
    v_cvt_pk_bf16_f32 v219, v206, v207
    v_cvt_pk_bf16_f32 v220, v208, v209
    v_cvt_pk_bf16_f32 v221, v210, v211
    v_permlane16_swap_b32 v212, v214
    v_permlane16_swap_b32 v213, v215
    v_permlane16_swap_b32 v216, v218
    v_permlane16_swap_b32 v217, v219
    buffer_store_dwordx4 v[212:215], v4, s[24:27], s52 offen offset:0 sc1
    buffer_store_dwordx4 v[216:219], v4, s[24:27], s52 offen offset:1024 sc1
    v_mov_b32_e64 v10, 0
    v_mov_b32 v11, 0
    s_mov_b32 exec_hi, 0
    buffer_store_dwordx2 v[220:221], v5, s[24:27], s52 offen offset:2048 sc1
    v_dot2c_f32_bf16 v10, v220, v7
    v_dot2c_f32_bf16 v11, v220, v220
    v_dot2c_f32_bf16 v10, v221, v7
    v_dot2c_f32_bf16 v11, v221, v221
    s_mov_b32 exec_hi, -1
    v_dot2c_f32_bf16 v10, v212, v7
    v_dot2c_f32_bf16 v11, v212, v212
    v_dot2c_f32_bf16 v10, v213, v7
    v_dot2c_f32_bf16 v11, v213, v213
    v_dot2c_f32_bf16 v10, v214, v7
    v_dot2c_f32_bf16 v11, v214, v214
    v_dot2c_f32_bf16 v10, v215, v7
    v_dot2c_f32_bf16 v11, v215, v215
    v_dot2c_f32_bf16 v10, v216, v7
    v_dot2c_f32_bf16 v11, v216, v216
    v_dot2c_f32_bf16 v10, v217, v7
    v_dot2c_f32_bf16 v11, v217, v217
    v_dot2c_f32_bf16 v10, v218, v7
    v_dot2c_f32_bf16 v11, v218, v218
    v_dot2c_f32_bf16 v10, v219, v7
    v_dot2c_f32_bf16 v11, v219, v219
    s_nop 2
    v_permlane32_swap_b32 v10, v11
    s_nop 0
    v_add_f32 v10, v10, v11
    v_mov_b32 v11, v10
    s_nop 1
    v_permlane16_swap_b32 v10, v11
    s_nop 0
    v_add_f32 v10, v10, v11
    buffer_store_dword v10, v6, s[24:27], s53 offen sc1
    s_barrier
L_p3:
    s_add_u32 s61, s59, 0
    buffer_load_dwordx4 v[48:51], v2, s[24:27], s61 offen offset:0
    buffer_load_dwordx4 v[52:55], v2, s[24:27], s61 offen offset:1024
    s_add_u32 s61, s59, 18432
    buffer_load_dwordx4 v[56:59], v2, s[24:27], s61 offen offset:0
    buffer_load_dwordx4 v[60:63], v2, s[24:27], s61 offen offset:1024
    s_add_u32 s61, s59, 2048
    buffer_load_dwordx4 v[64:67], v2, s[24:27], s61 offen offset:0
    buffer_load_dwordx4 v[68:71], v2, s[24:27], s61 offen offset:1024
    s_waitcnt vmcnt(6)
    v_mov_b32 v11, 1
    buffer_atomic_add v11, v254, s[24:27], s48 offen offset:512 sc0 sc1
    v_mov_b32_e64 v13, 1
    buffer_load_dwordx4 v2, s[24:27], s79 offen offset:0 lds
    buffer_load_dwordx4 v2, s[24:27], s79 offen offset:1024 lds
    buffer_load_dwordx4 v2, s[24:27], s79 offen offset:2048 lds
    s_add_u32 s61, s59, 20480
    buffer_load_dwordx4 v[72:75], v2, s[24:27], s61 offen offset:0
    buffer_load_dwordx4 v[76:79], v2, s[24:27], s61 offen offset:1024
    s_add_u32 s61, s59, 4096
    buffer_load_dwordx4 v[80:83], v2, s[24:27], s61 offen offset:0
    buffer_load_dwordx4 v[84:87], v2, s[24:27], s61 offen offset:1024
    s_waitcnt vmcnt(7)
    v_readfirstlane_b32 s60, v11
    s_cmp_ge_u32 s60, 7
    s_cbranch_scc1 L_f2a
    v_mov_b32_e64 v11, 0
    buffer_atomic_add v11, v254, s[24:27], s48 offen offset:512 sc0 sc1
L_f2a:
    s_add_u32 s61, s59, 22528
    buffer_load_dwordx4 v[88:91], v2, s[24:27], s61 offen offset:0
    buffer_load_dwordx4 v[92:95], v2, s[24:27], s61 offen offset:1024
    s_add_u32 s61, s59, 6144
    buffer_load_dwordx4 v[96:99], v2, s[24:27], s61 offen offset:0
    buffer_load_dwordx4 v[100:103], v2, s[24:27], s61 offen offset:1024
    s_add_u32 s61, s59, 24576
    buffer_load_dwordx4 v[104:107], v2, s[24:27], s61 offen offset:0
    buffer_load_dwordx4 v[108:111], v2, s[24:27], s61 offen offset:1024
    s_add_u32 s61, s59, 8192
    buffer_load_dwordx4 v[112:115], v2, s[24:27], s61 offen offset:0
    buffer_load_dwordx4 v[116:119], v2, s[24:27], s61 offen offset:1024
    s_cmp_ge_u32 s60, 7
    s_cbranch_scc1 L_f2b
    s_waitcnt vmcnt(8)
    v_readfirstlane_b32 s50, v11
    s_mov_b32 s49, 0
    s_cmp_ge_u32 s50, 8
    s_cbranch_scc1 spout_10
spin_9:
    v_mov_b32 v11, 0
    buffer_atomic_add v11, v254, s[24:27], s48 offen offset:512 sc0 sc1
    s_add_u32 s49, s49, 1
    s_waitcnt vmcnt(0)
    v_readfirstlane_b32 s50, v11
    s_cmp_ge_u32 s49, 262144
    s_cbranch_scc1 spout_10
    s_cmp_ge_u32 s50, 8
    s_cbranch_scc0 spin_9
spout_10:
L_f2b:
    s_add_u32 m0, s78, 16384
    s_add_u32 s50, s58, 16384
    buffer_load_dwordx4 v2, s[24:27], s50 offen offset:2048 sc1 lds
    s_add_u32 m0, s78, 0
    s_add_u32 s50, s58, 0
    buffer_load_dwordx4 v2, s[24:27], s50 offen offset:0 sc1 lds
    buffer_load_dwordx4 v2, s[24:27], s50 offen offset:1024 sc1 lds
    buffer_load_dwordx4 v2, s[24:27], s50 offen offset:2048 sc1 lds
    buffer_load_dwordx4 v2, s[24:27], s50 offen offset:3072 sc1 lds
    s_add_u32 m0, s78, 4096
    s_add_u32 s50, s58, 4096
    buffer_load_dwordx4 v2, s[24:27], s50 offen offset:0 sc1 lds
    buffer_load_dwordx4 v2, s[24:27], s50 offen offset:1024 sc1 lds
    buffer_load_dwordx4 v2, s[24:27], s50 offen offset:2048 sc1 lds
    buffer_load_dwordx4 v2, s[24:27], s50 offen offset:3072 sc1 lds
    s_waitcnt vmcnt(4)
    s_barrier
    ds_read_b128 a[0:3], v228 offset:0
    ds_read_b128 a[16:19], v228 offset:1024
    ds_read_b128 a[4:7], v228 offset:19456
    ds_read_b128 a[20:23], v228 offset:20480
    ds_read_b128 a[8:11], v229 offset:0
    ds_read_b128 a[24:27], v229 offset:1024
    ds_read_b128 a[12:15], v229 offset:19456
    ds_read_b128 a[28:31], v229 offset:20480
    s_add_u32 m0, s78, 8192
    s_add_u32 s50, s58, 8192
    buffer_load_dwordx4 v2, s[24:27], s50 offen offset:0 sc1 lds
    buffer_load_dwordx4 v2, s[24:27], s50 offen offset:1024 sc1 lds
    buffer_load_dwordx4 v2, s[24:27], s50 offen offset:2048 sc1 lds
L_pg4:
    s_cbranch_execz L_pg8
    s_waitcnt lgkmcnt(7)
    v_mfma_f32_16x16x32_bf16 v[120:123], v[48:51], a[0:3], 0
    s_waitcnt lgkmcnt(6)
    buffer_load_dwordx4 v2, s[24:27], s50 offen offset:3072 sc1 lds
    ds_read2_b32 v[206:207], v234 offset0:0 offset1:16
    v_mfma_f32_16x16x32_bf16 v[120:123], v[52:55], a[16:19], v[120:123]
    s_waitcnt lgkmcnt(6)
    ds_read2_b32 v[208:209], v234 offset0:32 offset1:48
    v_mfma_f32_16x16x32_bf16 v[124:127], v[48:51], a[4:7], 0
    s_waitcnt lgkmcnt(6)
    s_add_u32 m0, s78, 12288
    s_add_u32 s50, s58, 12288
    buffer_load_dwordx4 v2, s[24:27], s50 offen offset:0 sc1 lds
    ds_read2_b32 v[210:211], v234 offset0:64 offset1:80
    v_mfma_f32_16x16x32_bf16 v[124:127], v[52:55], a[20:23], v[124:127]
    s_waitcnt lgkmcnt(6)
    ds_read2_b32 v[212:213], v234 offset0:96 offset1:112
    v_mfma_f32_16x16x32_bf16 v[128:131], v[48:51], a[8:11], 0
    s_waitcnt lgkmcnt(6)
    buffer_load_dwordx4 v2, s[24:27], s50 offen offset:1024 sc1 lds
    ds_read2_b32 v[214:215], v234 offset0:128 offset1:144
    v_mfma_f32_16x16x32_bf16 v[128:131], v[52:55], a[24:27], v[128:131]
    s_waitcnt lgkmcnt(6)
    ds_read_b128 a[32:35], v228 offset:2048
    v_mfma_f32_16x16x32_bf16 v[132:135], v[48:51], a[12:15], 0
    s_waitcnt lgkmcnt(6)
    buffer_load_dwordx4 v2, s[24:27], s50 offen offset:2048 sc1 lds
    ds_read_b128 a[48:51], v228 offset:3072
    v_mfma_f32_16x16x32_bf16 v[132:135], v[52:55], a[28:31], v[132:135]
    ds_read_b128 a[36:39], v228 offset:21504
    v_mfma_f32_16x16x32_bf16 v[136:139], v[56:59], a[0:3], 0
    buffer_load_dwordx4 v2, s[24:27], s50 offen offset:3072 sc1 lds
    ds_read_b128 a[52:55], v228 offset:22528
    v_mfma_f32_16x16x32_bf16 v[136:139], v[60:63], a[16:19], v[136:139]
    ds_read_b128 a[40:43], v229 offset:2048
    v_mfma_f32_16x16x32_bf16 v[140:143], v[56:59], a[4:7], 0
    ds_read_b128 a[56:59], v229 offset:3072
    v_mfma_f32_16x16x32_bf16 v[140:143], v[60:63], a[20:23], v[140:143]
    ds_read_b128 a[44:47], v229 offset:21504
    v_mfma_f32_16x16x32_bf16 v[144:147], v[56:59], a[8:11], 0
    ds_read_b128 a[60:63], v229 offset:22528
    v_mfma_f32_16x16x32_bf16 v[144:147], v[60:63], a[24:27], v[144:147]
    ds_read2_b32 v[216:217], v234 offset0:160 offset1:176
    v_mfma_f32_16x16x32_bf16 v[148:151], v[56:59], a[12:15], 0
    ds_read2_b32 v[218:219], v234 offset0:192 offset1:208
    v_mfma_f32_16x16x32_bf16 v[148:151], v[60:63], a[28:31], v[148:151]
    s_waitcnt lgkmcnt(9)
    ds_read2_b32 v[220:221], v234 offset0:224 offset1:240
    v_mfma_f32_16x16x32_bf16 v[120:123], v[64:67], a[32:35], v[120:123]
    s_waitcnt lgkmcnt(9)
    v_mfma_f32_16x16x32_bf16 v[120:123], v[68:71], a[48:51], v[120:123]
    s_waitcnt lgkmcnt(8)
    v_mfma_f32_16x16x32_bf16 v[124:127], v[64:67], a[36:39], v[124:127]
    s_waitcnt lgkmcnt(7)
    v_mfma_f32_16x16x32_bf16 v[124:127], v[68:71], a[52:55], v[124:127]
    s_waitcnt lgkmcnt(6)
    v_mfma_f32_16x16x32_bf16 v[128:131], v[64:67], a[40:43], v[128:131]
    s_waitcnt lgkmcnt(5)
    v_mfma_f32_16x16x32_bf16 v[128:131], v[68:71], a[56:59], v[128:131]
    s_waitcnt lgkmcnt(4)
    v_mfma_f32_16x16x32_bf16 v[132:135], v[64:67], a[44:47], v[132:135]
    s_waitcnt lgkmcnt(3)
    v_mfma_f32_16x16x32_bf16 v[132:135], v[68:71], a[60:63], v[132:135]
    v_mfma_f32_16x16x32_bf16 v[136:139], v[72:75], a[32:35], v[136:139]
    v_mfma_f32_16x16x32_bf16 v[136:139], v[76:79], a[48:51], v[136:139]
    s_add_u32 s61, s59, 26624
    buffer_load_dwordx4 v[48:51], v2, s[24:27], s61 offen offset:0
    v_mfma_f32_16x16x32_bf16 v[140:143], v[72:75], a[36:39], v[140:143]
    s_waitcnt vmcnt(9)
    s_barrier
    s_add_u32 m0, s78, 16384
    s_add_u32 s50, s58, 16384
    buffer_load_dwordx4 v2, s[24:27], s50 offen offset:0 sc1 lds
    ds_read_b128 a[64:67], v228 offset:4096
    ds_read_b128 a[80:83], v228 offset:5120
    v_mfma_f32_16x16x32_bf16 v[140:143], v[76:79], a[52:55], v[140:143]
    ds_read_b128 a[68:71], v228 offset:23552
    ds_read_b128 a[84:87], v228 offset:24576
    v_mfma_f32_16x16x32_bf16 v[144:147], v[72:75], a[40:43], v[144:147]
    buffer_load_dwordx4 v2, s[24:27], s50 offen offset:1024 sc1 lds
    ds_read_b128 a[72:75], v229 offset:4096
    ds_read_b128 a[88:91], v229 offset:5120
    v_mfma_f32_16x16x32_bf16 v[144:147], v[76:79], a[56:59], v[144:147]
    buffer_load_dwordx4 v[52:55], v2, s[24:27], s61 offen offset:1024
    ds_read_b128 a[76:79], v229 offset:23552
    ds_read_b128 a[92:95], v229 offset:24576
    v_mfma_f32_16x16x32_bf16 v[148:151], v[72:75], a[44:47], v[148:151]
    v_mfma_f32_16x16x32_bf16 v[148:151], v[76:79], a[60:63], v[148:151]
    s_waitcnt lgkmcnt(7)
    v_mfma_f32_16x16x32_bf16 v[120:123], v[80:83], a[64:67], v[120:123]
    s_waitcnt lgkmcnt(6)
    v_add_f32 v206, v206, v214
    v_add_f32_e64 v207, v207, v215
    v_mfma_f32_16x16x32_bf16 v[120:123], v[84:87], a[80:83], v[120:123]
    s_waitcnt lgkmcnt(5)
    s_add_u32 s61, s59, 10240
    buffer_load_dwordx4 v[56:59], v2, s[24:27], s61 offen offset:0
    v_mfma_f32_16x16x32_bf16 v[124:127], v[80:83], a[68:71], v[124:127]
    s_waitcnt lgkmcnt(4)
    v_add_f32 v208, v208, v216
    v_add_f32 v209, v209, v217
    v_mfma_f32_16x16x32_bf16 v[124:127], v[84:87], a[84:87], v[124:127]
    s_waitcnt lgkmcnt(3)
    v_add_f32 v210, v210, v218
    v_add_f32_e64 v211, v211, v219
    v_mfma_f32_16x16x32_bf16 v[128:131], v[80:83], a[72:75], v[128:131]
    s_waitcnt lgkmcnt(2)
    v_add_f32 v212, v212, v220
    v_add_f32_e64 v213, v213, v221
    v_mfma_f32_16x16x32_bf16 v[128:131], v[84:87], a[88:91], v[128:131]
    s_waitcnt lgkmcnt(1)
    buffer_load_dwordx4 v[60:63], v2, s[24:27], s61 offen offset:1024
    ds_read_b128 a[96:99], v228 offset:6144
    v_mfma_f32_16x16x32_bf16 v[132:135], v[80:83], a[76:79], v[132:135]
    s_waitcnt lgkmcnt(1)
    ds_read_b128 a[112:115], v228 offset:7168
    v_add_f32_e64 v206, v206, v210
    v_mfma_f32_16x16x32_bf16 v[132:135], v[84:87], a[92:95], v[132:135]
    ds_read_b128 a[100:103], v228 offset:25600
    v_add_f32_e64 v207, v207, v211
    v_mfma_f32_16x16x32_bf16 v[136:139], v[88:91], a[64:67], v[136:139]
    ds_read_b128 a[116:119], v228 offset:26624
    v_add_f32_e64 v208, v208, v212
    v_mfma_f32_16x16x32_bf16 v[136:139], v[92:95], a[80:83], v[136:139]
    s_add_u32 s61, s59, 28672
    buffer_load_dwordx4 v[64:67], v2, s[24:27], s61 offen offset:0
    ds_read_b128 a[104:107], v229 offset:6144
    v_mfma_f32_16x16x32_bf16 v[140:143], v[88:91], a[68:71], v[140:143]
    ds_read_b128 a[120:123], v229 offset:7168
    v_mfma_f32_16x16x32_bf16 v[140:143], v[92:95], a[84:87], v[140:143]
    ds_read_b128 a[108:111], v229 offset:25600
    v_mfma_f32_16x16x32_bf16 v[144:147], v[88:91], a[72:75], v[144:147]
    ds_read_b128 a[124:127], v229 offset:26624
    v_add_f32_e64 v209, v209, v213
    v_mfma_f32_16x16x32_bf16 v[144:147], v[92:95], a[88:91], v[144:147]
    buffer_load_dwordx4 v[68:71], v2, s[24:27], s61 offen offset:1024
    v_mfma_f32_16x16x32_bf16 v[148:151], v[88:91], a[76:79], v[148:151]
    v_add_f32_e64 v206, v206, v208
    v_mfma_f32_16x16x32_bf16 v[148:151], v[92:95], a[92:95], v[148:151]
    s_waitcnt lgkmcnt(7)
    v_add_f32 v207, v207, v209
    v_mul_f32 v210, 0xbae38e39, v206
    v_mfma_f32_16x16x32_bf16 v[120:123], v[96:99], a[96:99], v[120:123]
    s_waitcnt lgkmcnt(6)
    v_mul_f32 v214, 0x3ae38e39, v207
    v_fma_f32 v214, -v210, v210, v214
    v_mfma_f32_16x16x32_bf16 v[120:123], v[100:103], a[112:115], v[120:123]
    s_waitcnt lgkmcnt(5)
    s_add_u32 s61, s59, 12288
    buffer_load_dwordx4 v[72:75], v2, s[24:27], s61 offen offset:0
    v_mfma_f32_16x16x32_bf16 v[124:127], v[96:99], a[100:103], v[124:127]
    s_waitcnt lgkmcnt(4)
    v_max_f32 v214, 0, v214
    v_mfma_f32_16x16x32_bf16 v[124:127], v[100:103], a[116:119], v[124:127]
    s_waitcnt lgkmcnt(3)
    v_add_f32 v214, 0x3727c5ac, v214
    v_mov_b32 v212, v210
    v_mfma_f32_16x16x32_bf16 v[128:131], v[96:99], a[104:107], v[128:131]
    s_waitcnt lgkmcnt(2)
    v_mov_b32 v216, v214
    s_mov_b32 s66, -1
    v_mfma_f32_16x16x32_bf16 v[128:131], v[100:103], a[120:123], v[128:131]
    s_waitcnt lgkmcnt(1)
    buffer_load_dwordx4 v[76:79], v2, s[24:27], s61 offen offset:1024
    v_mfma_f32_16x16x32_bf16 v[132:135], v[96:99], a[108:111], v[132:135]
    s_waitcnt lgkmcnt(0)
    s_mov_b32 s67, 0
    v_mfma_f32_16x16x32_bf16 v[132:135], v[100:103], a[124:127], v[132:135]
    v_permlane32_swap_b32 v210, v212
    v_mfma_f32_16x16x32_bf16 v[136:139], v[104:107], a[96:99], v[136:139]
    v_permlane32_swap_b32 v214, v216
    v_mfma_f32_16x16x32_bf16 v[136:139], v[108:111], a[112:115], v[136:139]
    s_add_u32 s61, s59, 30720
    buffer_load_dwordx4 v[80:83], v2, s[24:27], s61 offen offset:0
    v_mfma_f32_16x16x32_bf16 v[140:143], v[104:107], a[100:103], v[140:143]
    s_waitcnt vmcnt(15)
    s_barrier
    ds_read_b128 a[128:131], v228 offset:8192
    ds_read_b128 a[144:147], v228 offset:9216
    v_mfma_f32_16x16x32_bf16 v[140:143], v[108:111], a[116:119], v[140:143]
    ds_read_b128 a[132:135], v228 offset:27648
    ds_read_b128 a[148:151], v228 offset:28672
    v_mfma_f32_16x16x32_bf16 v[144:147], v[104:107], a[104:107], v[144:147]
    ds_read_b128 a[136:139], v229 offset:8192
    ds_read_b128 a[152:155], v229 offset:9216
    v_mfma_f32_16x16x32_bf16 v[144:147], v[108:111], a[120:123], v[144:147]
    buffer_load_dwordx4 v[84:87], v2, s[24:27], s61 offen offset:1024
    ds_read_b128 a[140:143], v229 offset:27648
    ds_read_b128 a[156:159], v229 offset:28672
    v_mfma_f32_16x16x32_bf16 v[148:151], v[104:107], a[108:111], v[148:151]
    v_mfma_f32_16x16x32_bf16 v[148:151], v[108:111], a[124:127], v[148:151]
    s_waitcnt lgkmcnt(7)
    v_mfma_f32_16x16x32_bf16 v[120:123], v[112:115], a[128:131], v[120:123]
    s_waitcnt lgkmcnt(6)
    v_mov_b32_e64 v211, v210
    v_mfma_f32_16x16x32_bf16 v[120:123], v[116:119], a[144:147], v[120:123]
    s_waitcnt lgkmcnt(5)
    s_add_u32 s61, s59, 14336
    buffer_load_dwordx4 v[88:91], v2, s[24:27], s61 offen offset:0
    v_mfma_f32_16x16x32_bf16 v[124:127], v[112:115], a[132:135], v[124:127]
    s_waitcnt lgkmcnt(4)
    v_mov_b32_e64 v213, v212
    v_mfma_f32_16x16x32_bf16 v[124:127], v[116:119], a[148:151], v[124:127]
    s_waitcnt lgkmcnt(3)
    v_mov_b32 v215, v214
    v_mov_b32_e64 v217, v216
    v_mfma_f32_16x16x32_bf16 v[128:131], v[112:115], a[136:139], v[128:131]
    s_waitcnt lgkmcnt(2)
    s_mov_b32 vcc_lo, 0
    s_mov_b32 vcc_hi, 0xffff
    v_mfma_f32_16x16x32_bf16 v[128:131], v[116:119], a[152:155], v[128:131]
    s_waitcnt lgkmcnt(1)
    buffer_load_dwordx4 v[92:95], v2, s[24:27], s61 offen offset:1024
    ds_read_b128 a[160:163], v228 offset:10240
    v_mfma_f32_16x16x32_bf16 v[132:135], v[112:115], a[140:143], v[132:135]
    s_waitcnt lgkmcnt(1)
    ds_read_b128 a[176:179], v228 offset:11264
    v_mfma_f32_16x16x32_bf16 v[132:135], v[116:119], a[156:159], v[132:135]
    s_waitcnt vmcnt(10)
    ds_read_b128 a[164:167], v228 offset:29696
    v_mfma_f32_16x16x32_bf16 v[136:139], v[48:51], a[128:131], v[136:139]
    ds_read_b128 a[180:183], v228 offset:30720
    v_mfma_f32_16x16x32_bf16 v[136:139], v[52:55], a[144:147], v[136:139]
    s_add_u32 s61, s59, 32768
    buffer_load_dwordx4 v[96:99], v2, s[24:27], s61 offen offset:0
    ds_read_b128 a[168:171], v229 offset:10240
    v_mfma_f32_16x16x32_bf16 v[140:143], v[48:51], a[132:135], v[140:143]
    ds_read_b128 a[184:187], v229 offset:11264
    v_mfma_f32_16x16x32_bf16 v[140:143], v[52:55], a[148:151], v[140:143]
    ds_read_b128 a[172:175], v229 offset:29696
    v_mfma_f32_16x16x32_bf16 v[144:147], v[48:51], a[136:139], v[144:147]
    ds_read_b128 a[188:191], v229 offset:30720
    v_mfma_f32_16x16x32_bf16 v[144:147], v[52:55], a[152:155], v[144:147]
    buffer_load_dwordx4 v[100:103], v2, s[24:27], s61 offen offset:1024
    v_mfma_f32_16x16x32_bf16 v[148:151], v[48:51], a[140:143], v[148:151]
    v_permlane16_swap_b32 v210, v211
    v_mfma_f32_16x16x32_bf16 v[148:151], v[52:55], a[156:159], v[148:151]
    s_waitcnt vmcnt(10) lgkmcnt(7)
    v_permlane16_swap_b32 v212, v213
    v_mfma_f32_16x16x32_bf16 v[120:123], v[56:59], a[160:163], v[120:123]
    s_waitcnt lgkmcnt(6)
    v_permlane16_swap_b32 v214, v215
    v_mfma_f32_16x16x32_bf16 v[120:123], v[60:63], a[176:179], v[120:123]
    s_waitcnt lgkmcnt(5)
    s_add_u32 s61, s59, 16384
    buffer_load_dwordx4 v[104:107], v2, s[24:27], s61 offen offset:0
    v_mfma_f32_16x16x32_bf16 v[124:127], v[56:59], a[164:167], v[124:127]
    s_waitcnt lgkmcnt(4)
    v_permlane16_swap_b32 v216, v217
    v_mfma_f32_16x16x32_bf16 v[124:127], v[60:63], a[180:183], v[124:127]
    s_waitcnt lgkmcnt(3)
    v_rsq_f32_e64 v206, v214
    v_mfma_f32_16x16x32_bf16 v[128:131], v[56:59], a[168:171], v[128:131]
    s_waitcnt lgkmcnt(2)
    v_cvt_pk_bf16_f32 v208, v210, v210
    v_mul_f32 v196, v214, v206
    v_mfma_f32_16x16x32_bf16 v[128:131], v[60:63], a[184:187], v[128:131]
    s_waitcnt lgkmcnt(1)
    buffer_load_dwordx4 v[108:111], v2, s[24:27], s61 offen offset:1024
    v_mfma_f32_16x16x32_bf16 v[132:135], v[56:59], a[172:175], v[132:135]
    s_waitcnt lgkmcnt(0)
    v_mul_f32 v194, 0xc0135761, v206
    v_mul_f32_e64 v207, v206, v206
    v_mfma_f32_16x16x32_bf16 v[132:135], v[60:63], a[188:191], v[132:135]
    s_waitcnt vmcnt(10)
    v_mul_f32 v195, 0x3d372713, v194
    v_cvt_pk_bf16_f32 v209, v210, v196
    v_mfma_f32_16x16x32_bf16 v[136:139], v[64:67], a[160:163], v[136:139]
    v_cndmask_b32 v187, 0, v208, s[66:67]
    v_mfma_f32_16x16x32_bf16 v[136:139], v[68:71], a[176:179], v[136:139]
    s_add_u32 s61, s59, 34816
    buffer_load_dwordx4 v[112:115], v2, s[24:27], s61 offen offset:0
    v_mfma_f32_16x16x32_bf16 v[140:143], v[64:67], a[164:167], v[140:143]
    s_barrier
    ds_read_b128 a[192:195], v228 offset:12288
    ds_read_b128 a[208:211], v228 offset:13312
    v_mfma_f32_16x16x32_bf16 v[140:143], v[68:71], a[180:183], v[140:143]
    ds_read_b128 a[196:199], v228 offset:31744
    ds_read_b128 a[212:215], v228 offset:32768
    v_mfma_f32_16x16x32_bf16 v[144:147], v[64:67], a[168:171], v[144:147]
    ds_read_b128 a[200:203], v229 offset:12288
    ds_read_b128 a[216:219], v229 offset:13312
    v_mfma_f32_16x16x32_bf16 v[144:147], v[68:71], a[184:187], v[144:147]
    buffer_load_dwordx4 v[116:119], v2, s[24:27], s61 offen offset:1024
    ds_read_b128 a[204:207], v229 offset:31744
    ds_read_b128 a[220:223], v229 offset:32768
    v_mfma_f32_16x16x32_bf16 v[148:151], v[64:67], a[172:175], v[148:151]
    v_mfma_f32_16x16x32_bf16 v[148:151], v[68:71], a[188:191], v[148:151]
    s_waitcnt vmcnt(10) lgkmcnt(7)
    v_mfma_f32_16x16x32_bf16 v[120:123], v[72:75], a[192:195], v[120:123]
    s_waitcnt lgkmcnt(6)
    v_mul_f32_e64 v195, v195, v207
    v_mfma_f32_16x16x32_bf16 v[120:123], v[76:79], a[208:211], v[120:123]
    s_waitcnt lgkmcnt(5)
    buffer_load_dwordx4 v[48:51], v2, s[24:27], s61 offen offset:2048
    v_mfma_f32_16x16x32_bf16 v[124:127], v[72:75], a[196:199], v[124:127]
    s_waitcnt lgkmcnt(4)
    v_cndmask_b32 v186, v187, v209, vcc
    v_mfma_f32_16x16x32_bf16 v[124:127], v[76:79], a[212:215], v[124:127]
    s_waitcnt lgkmcnt(3)
    v_rsq_f32_e64 v206, v215
    v_mfma_f32_16x16x32_bf16 v[128:131], v[72:75], a[200:203], v[128:131]
    s_waitcnt lgkmcnt(2)
    v_cvt_pk_bf16_f32 v208, v211, v211
    v_mul_f32 v199, v215, v206
    v_mfma_f32_16x16x32_bf16 v[128:131], v[76:79], a[216:219], v[128:131]
    s_waitcnt lgkmcnt(1)
    buffer_load_dwordx4 v[52:55], v2, s[24:27], s61 offen offset:3072
    ds_read_b128 a[224:227], v228 offset:14336
    v_mfma_f32_16x16x32_bf16 v[132:135], v[72:75], a[204:207], v[132:135]
    s_waitcnt lgkmcnt(1)
    ds_read_b128 a[240:243], v228 offset:15360
    v_mfma_f32_16x16x32_bf16 v[132:135], v[76:79], a[220:223], v[132:135]
    s_waitcnt vmcnt(10)
    ds_read_b128 a[228:231], v228 offset:33792
    v_mfma_f32_16x16x32_bf16 v[136:139], v[80:83], a[192:195], v[136:139]
    ds_read_b128 a[244:247], v228 offset:34816
    v_mul_f32 v197, 0xc0135761, v206
    v_mfma_f32_16x16x32_bf16 v[136:139], v[84:87], a[208:211], v[136:139]
    s_add_u32 s61, s59, 38912
    buffer_load_dwordx4 v[56:59], v2, s[24:27], s61 offen offset:0
    ds_read_b128 a[232:235], v229 offset:14336
    v_mfma_f32_16x16x32_bf16 v[140:143], v[80:83], a[196:199], v[140:143]
    ds_read_b128 a[248:251], v229 offset:15360
    v_mfma_f32_16x16x32_bf16 v[140:143], v[84:87], a[212:215], v[140:143]
    ds_read_b128 a[236:239], v229 offset:33792
    v_mfma_f32_16x16x32_bf16 v[144:147], v[80:83], a[200:203], v[144:147]
    ds_read_b128 a[252:255], v229 offset:34816
    v_mul_f32 v207, v206, v206
    v_mfma_f32_16x16x32_bf16 v[144:147], v[84:87], a[216:219], v[144:147]
    buffer_load_dwordx4 v[60:63], v2, s[24:27], s61 offen offset:1024
    v_mfma_f32_16x16x32_bf16 v[148:151], v[80:83], a[204:207], v[148:151]
    v_mul_f32 v198, 0x3d372713, v197
    v_cvt_pk_bf16_f32 v209, v211, v199
    v_mfma_f32_16x16x32_bf16 v[148:151], v[84:87], a[220:223], v[148:151]
    s_waitcnt vmcnt(10) lgkmcnt(7)
    v_cndmask_b32 v189, 0, v208, s[66:67]
    v_mul_f32 v198, v198, v207
    v_mfma_f32_16x16x32_bf16 v[120:123], v[88:91], a[224:227], v[120:123]
    s_waitcnt lgkmcnt(6)
    v_cndmask_b32 v188, v189, v209, vcc
    v_mfma_f32_16x16x32_bf16 v[120:123], v[92:95], a[240:243], v[120:123]
    s_waitcnt lgkmcnt(5)
    buffer_load_dwordx4 v[64:67], v2, s[24:27], s61 offen offset:2048
    v_mfma_f32_16x16x32_bf16 v[124:127], v[88:91], a[228:231], v[124:127]
    s_waitcnt lgkmcnt(4)
    v_rsq_f32_e64 v206, v216
    v_mfma_f32_16x16x32_bf16 v[124:127], v[92:95], a[244:247], v[124:127]
    s_waitcnt lgkmcnt(3)
    v_cvt_pk_bf16_f32 v208, v212, v212
    v_mul_f32 v202, v216, v206
    v_mfma_f32_16x16x32_bf16 v[128:131], v[88:91], a[232:235], v[128:131]
    s_waitcnt lgkmcnt(2)
    v_mul_f32 v200, 0xc0135761, v206
    v_mul_f32 v207, v206, v206
    v_mfma_f32_16x16x32_bf16 v[128:131], v[92:95], a[248:251], v[128:131]
    s_waitcnt lgkmcnt(1)
    buffer_load_dwordx4 v[68:71], v2, s[24:27], s61 offen offset:3072
    v_mfma_f32_16x16x32_bf16 v[132:135], v[88:91], a[236:239], v[132:135]
    s_waitcnt lgkmcnt(0)
    v_mul_f32 v201, 0x3d372713, v200
    v_mfma_f32_16x16x32_bf16 v[132:135], v[92:95], a[252:255], v[132:135]
    s_waitcnt vmcnt(10)
    v_cvt_pk_bf16_f32 v209, v212, v202
    v_cndmask_b32 v191, 0, v208, s[66:67]
    v_mfma_f32_16x16x32_bf16 v[136:139], v[96:99], a[224:227], v[136:139]
    v_mul_f32 v201, v201, v207
    v_cndmask_b32 v190, v191, v209, vcc
    v_mfma_f32_16x16x32_bf16 v[136:139], v[100:103], a[240:243], v[136:139]
    s_add_u32 s61, s59, 43008
    buffer_load_dwordx4 v[72:75], v2, s[24:27], s61 offen offset:0
    v_mfma_f32_16x16x32_bf16 v[140:143], v[96:99], a[228:231], v[140:143]
    s_barrier
    ds_read_b128 v[16:19], v228 offset:16384
    ds_read_b128 v[32:35], v228 offset:17408
    v_mfma_f32_16x16x32_bf16 v[140:143], v[100:103], a[244:247], v[140:143]
    ds_read_b128 v[20:23], v228 offset:35840
    ds_read_b128 v[36:39], v228 offset:36864
    v_mfma_f32_16x16x32_bf16 v[144:147], v[96:99], a[232:235], v[144:147]
    ds_read_b128 v[24:27], v229 offset:16384
    ds_read_b128 v[40:43], v229 offset:17408
    v_mfma_f32_16x16x32_bf16 v[144:147], v[100:103], a[248:251], v[144:147]
    buffer_load_dwordx4 v[76:79], v2, s[24:27], s61 offen offset:1024
    ds_read_b128 v[28:31], v229 offset:35840
    ds_read_b128 v[44:47], v229 offset:36864
    v_mfma_f32_16x16x32_bf16 v[148:151], v[96:99], a[236:239], v[148:151]
    v_mfma_f32_16x16x32_bf16 v[148:151], v[100:103], a[252:255], v[148:151]
    s_waitcnt vmcnt(10) lgkmcnt(7)
    v_mfma_f32_16x16x32_bf16 v[120:123], v[104:107], v[16:19], v[120:123]
    s_waitcnt lgkmcnt(6)
    v_mfma_f32_16x16x32_bf16 v[120:123], v[108:111], v[32:35], v[120:123]
    s_waitcnt lgkmcnt(5)
    buffer_load_dwordx4 v[80:83], v2, s[24:27], s61 offen offset:2048
    v_mfma_f32_16x16x32_bf16 v[124:127], v[104:107], v[20:23], v[124:127]
    s_waitcnt lgkmcnt(4)
    v_rsq_f32_e64 v206, v217
    v_mfma_f32_16x16x32_bf16 v[124:127], v[108:111], v[36:39], v[124:127]
    s_waitcnt lgkmcnt(3)
    v_cvt_pk_bf16_f32 v208, v213, v213
    v_mfma_f32_16x16x32_bf16 v[128:131], v[104:107], v[24:27], v[128:131]
    s_waitcnt lgkmcnt(2)
    v_mul_f32_e64 v205, v217, v206
    v_mul_f32 v203, 0xc0135761, v206
    v_mfma_f32_16x16x32_bf16 v[128:131], v[108:111], v[40:43], v[128:131]
    s_waitcnt lgkmcnt(1)
    buffer_load_dwordx4 v[84:87], v2, s[24:27], s61 offen offset:3072
    ds_read_b64_tr_b16 v[184:185], v233 offset:0
    v_mfma_f32_16x16x32_bf16 v[132:135], v[104:107], v[28:31], v[132:135]
    s_waitcnt lgkmcnt(1)
    v_mul_f32_e64 v207, v206, v206
    v_mfma_f32_16x16x32_bf16 v[132:135], v[108:111], v[44:47], v[132:135]
    s_waitcnt vmcnt(10)
    ds_read_b64_tr_b16 v[222:223], v233 offset:1280
    v_mul_f32 v204, 0x3d372713, v203
    v_mfma_f32_16x16x32_bf16 v[136:139], v[112:115], v[16:19], v[136:139]
    v_cvt_pk_bf16_f32 v209, v213, v205
    v_mfma_f32_16x16x32_bf16 v[136:139], v[116:119], v[32:35], v[136:139]
    s_add_u32 s61, s59, 47104
    buffer_load_dwordx4 v[88:91], v2, s[24:27], s61 offen offset:0
    v_mfma_f32_16x16x32_bf16 v[140:143], v[112:115], v[20:23], v[140:143]
    v_cndmask_b32 v193, 0, v208, s[66:67]
    v_mul_f32 v204, v204, v207
    v_mfma_f32_16x16x32_bf16 v[140:143], v[116:119], v[36:39], v[140:143]
    v_cndmask_b32 v192, v193, v209, vcc
    v_mfma_f32_16x16x32_bf16 v[144:147], v[112:115], v[24:27], v[144:147]
    v_mfma_f32_16x16x32_bf16 v[144:147], v[116:119], v[40:43], v[144:147]
    buffer_load_dwordx4 v[92:95], v2, s[24:27], s61 offen offset:1024
    v_mfma_f32_16x16x32_bf16 v[148:151], v[112:115], v[28:31], v[148:151]
    v_mfma_f32_16x16x32_bf16 v[148:151], v[116:119], v[44:47], v[148:151]
    s_waitcnt lgkmcnt(0)
    v_mfma_f32_16x16x16_bf16 v[120:123], v[184:185], v[186:187], v[120:123]
    v_mfma_f32_16x16x16_bf16 v[124:127], v[184:185], v[188:189], v[124:127]
    buffer_load_dwordx4 v[96:99], v2, s[24:27], s61 offen offset:2048
    v_mfma_f32_16x16x16_bf16 v[128:131], v[184:185], v[190:191], v[128:131]
    v_mfma_f32_16x16x16_bf16 v[132:135], v[184:185], v[192:193], v[132:135]
    v_mfma_f32_16x16x16_bf16 v[136:139], v[222:223], v[186:187], v[136:139]
    v_mfma_f32_16x16x16_bf16 v[140:143], v[222:223], v[188:189], v[140:143]
    buffer_load_dwordx4 v[100:103], v2, s[24:27], s61 offen offset:3072
    v_mfma_f32_16x16x16_bf16 v[144:147], v[222:223], v[190:191], v[144:147]
    v_mfma_f32_16x16x16_bf16 v[148:151], v[222:223], v[192:193], v[148:151]
    s_waitcnt vmcnt(12)
    v_mfma_f32_16x16x32_bf16 v[214:217], v[48:51], a[0:3], 0
    v_mul_f32 v222, v120, v120
    v_mul_f32_e64 v223, v121, v121
    v_mfma_f32_16x16x32_bf16 v[214:217], v[52:55], a[16:19], v[214:217]
    v_fma_f32 v222, v222, v195, v194
    v_fma_f32 v223, v223, v195, v194
    v_mul_f32 v222, v120, v222
    v_mul_f32 v223, v121, v223
    v_mfma_f32_16x16x32_bf16 v[218:221], v[48:51], a[4:7], 0
    v_exp_f32_e64 v222, v222
    v_mfma_f32_16x16x32_bf16 v[218:221], v[52:55], a[20:23], v[218:221]
    buffer_store_dwordx4 v[152:155], v0, s[24:27], s64 offen offset:0 sc1
    v_mfma_f32_16x16x32_bf16 v[244:247], v[48:51], a[8:11], 0
    v_exp_f32_e64 v223, v223
    v_mfma_f32_16x16x32_bf16 v[244:247], v[52:55], a[24:27], v[244:247]
    v_fma_f32 v222, v222, v196, v196
    v_fma_f32 v223, v223, v196, v196
    v_rcp_f32_e64 v222, v222
    v_mfma_f32_16x16x32_bf16 v[248:251], v[48:51], a[12:15], 0
    v_rcp_f32_e64 v223, v223
    v_mfma_f32_16x16x32_bf16 v[248:251], v[52:55], a[28:31], v[248:251]
    s_waitcnt vmcnt(11)
    v_mul_f32 v222, v120, v222
    v_mul_f32_e64 v223, v121, v223
    v_cvt_pk_bf16_f32 v206, v222, v223
    v_mfma_f32_16x16x32_bf16 v[214:217], v[56:59], a[32:35], v[214:217]
    v_mul_f32 v224, v122, v122
    v_mul_f32 v225, v123, v123
    v_mfma_f32_16x16x32_bf16 v[214:217], v[60:63], a[48:51], v[214:217]
    s_add_u32 s61, s59, 51200
    buffer_load_dwordx4 v[104:107], v2, s[24:27], s61 offen offset:0
    v_fma_f32 v224, v224, v195, v194
    v_fma_f32 v225, v225, v195, v194
    v_mfma_f32_16x16x32_bf16 v[218:221], v[56:59], a[36:39], v[218:221]
    v_mul_f32 v224, v122, v224
    v_mul_f32 v225, v123, v225
    v_mfma_f32_16x16x32_bf16 v[218:221], v[60:63], a[52:55], v[218:221]
    v_exp_f32_e64 v224, v224
    v_mfma_f32_16x16x32_bf16 v[244:247], v[56:59], a[40:43], v[244:247]
    v_exp_f32_e64 v225, v225
    v_mfma_f32_16x16x32_bf16 v[244:247], v[60:63], a[56:59], v[244:247]
    buffer_load_dwordx4 v[108:111], v2, s[24:27], s61 offen offset:1024
    v_fma_f32 v224, v224, v196, v196
    v_fma_f32 v225, v225, v196, v196
    v_mfma_f32_16x16x32_bf16 v[248:251], v[56:59], a[44:47], v[248:251]
    v_rcp_f32_e64 v224, v224
    v_mfma_f32_16x16x32_bf16 v[248:251], v[60:63], a[60:63], v[248:251]
    s_waitcnt vmcnt(11)
    v_rcp_f32 v225, v225
    v_mfma_f32_16x16x32_bf16 v[214:217], v[64:67], a[64:67], v[214:217]
    v_mul_f32 v224, v122, v224
    v_mul_f32 v225, v123, v225
    v_mfma_f32_16x16x32_bf16 v[214:217], v[68:71], a[80:83], v[214:217]
    buffer_load_dwordx4 v[112:115], v2, s[24:27], s61 offen offset:2048
    v_cvt_pk_bf16_f32 v207, v224, v225
    v_mul_f32 v222, v124, v124
    v_mul_f32 v223, v125, v125
    v_mfma_f32_16x16x32_bf16 v[218:221], v[64:67], a[68:71], v[218:221]
    v_fma_f32 v222, v222, v198, v197
    v_fma_f32 v223, v223, v198, v197
    v_mfma_f32_16x16x32_bf16 v[218:221], v[68:71], a[84:87], v[218:221]
    ds_write_b64 v231, v[206:207] offset:0
    buffer_store_dwordx4 v[156:159], v0, s[24:27], s64 offen offset:128 sc1
    s_add_u32 s64, s64, 331776
    v_mfma_f32_16x16x32_bf16 v[244:247], v[64:67], a[72:75], v[244:247]
    v_mul_f32 v222, v124, v222
    v_mul_f32 v223, v125, v223
    v_mfma_f32_16x16x32_bf16 v[244:247], v[68:71], a[88:91], v[244:247]
    buffer_load_dwordx4 v[116:119], v2, s[24:27], s61 offen offset:3072
    v_mfma_f32_16x16x32_bf16 v[248:251], v[64:67], a[76:79], v[248:251]
    v_exp_f32_e64 v222, v222
    v_mfma_f32_16x16x32_bf16 v[248:251], v[68:71], a[92:95], v[248:251]
    s_waitcnt vmcnt(12)
    v_exp_f32 v223, v223
    v_fma_f32 v222, v222, v199, v199
    v_fma_f32 v223, v223, v199, v199
    v_mfma_f32_16x16x32_bf16 v[214:217], v[72:75], a[96:99], v[214:217]
    v_rcp_f32_e64 v222, v222
    v_mfma_f32_16x16x32_bf16 v[214:217], v[76:79], a[112:115], v[214:217]
    s_add_u32 s61, s59, 55296
    buffer_load_dwordx4 v[48:51], v2, s[24:27], s61 offen offset:0
    v_mfma_f32_16x16x32_bf16 v[218:221], v[72:75], a[100:103], v[218:221]
    v_rcp_f32_e64 v223, v223
    v_mfma_f32_16x16x32_bf16 v[218:221], v[76:79], a[116:119], v[218:221]
    v_mul_f32 v222, v124, v222
    v_mul_f32 v223, v125, v223
    v_cvt_pk_bf16_f32 v208, v222, v223
    v_mul_f32 v224, v126, v126
    v_mul_f32 v225, v127, v127
    v_mfma_f32_16x16x32_bf16 v[244:247], v[72:75], a[104:107], v[244:247]
    v_fma_f32 v224, v224, v198, v197
    v_fma_f32 v225, v225, v198, v197
    v_mfma_f32_16x16x32_bf16 v[244:247], v[76:79], a[120:123], v[244:247]
    buffer_load_dwordx4 v[52:55], v2, s[24:27], s61 offen offset:1024
    v_mfma_f32_16x16x32_bf16 v[248:251], v[72:75], a[108:111], v[248:251]
    v_mul_f32 v224, v126, v224
    v_mul_f32 v225, v127, v225
    v_mfma_f32_16x16x32_bf16 v[248:251], v[76:79], a[124:127], v[248:251]
    s_waitcnt vmcnt(12)
    v_exp_f32 v224, v224
    v_exp_f32_e64 v225, v225
    v_mfma_f32_16x16x32_bf16 v[214:217], v[80:83], a[128:131], v[214:217]
    v_fma_f32 v224, v224, v199, v199
    v_fma_f32 v225, v225, v199, v199
    v_mfma_f32_16x16x32_bf16 v[214:217], v[84:87], a[144:147], v[214:217]
    buffer_load_dwordx4 v[56:59], v2, s[24:27], s61 offen offset:2048
    v_mfma_f32_16x16x32_bf16 v[218:221], v[80:83], a[132:135], v[218:221]
    v_rcp_f32_e64 v224, v224
    v_mfma_f32_16x16x32_bf16 v[218:221], v[84:87], a[148:151], v[218:221]
    buffer_store_dwordx4 v[160:163], v0, s[24:27], s64 offen offset:0 sc1
    v_rcp_f32_e64 v225, v225
    v_mfma_f32_16x16x32_bf16 v[244:247], v[80:83], a[136:139], v[244:247]
    v_mul_f32 v224, v126, v224
    v_mul_f32 v225, v127, v225
    v_mfma_f32_16x16x32_bf16 v[244:247], v[84:87], a[152:155], v[244:247]
    buffer_load_dwordx4 v[60:63], v2, s[24:27], s61 offen offset:3072
    v_cvt_pk_bf16_f32 v209, v224, v225
    v_mfma_f32_16x16x32_bf16 v[248:251], v[80:83], a[140:143], v[248:251]
    v_mul_f32 v222, v128, v128
    v_mul_f32 v223, v129, v129
    v_mfma_f32_16x16x32_bf16 v[248:251], v[84:87], a[156:159], v[248:251]
    s_waitcnt vmcnt(13)
    ds_write_b64 v231, v[208:209] offset:1024
    v_fma_f32 v222, v222, v201, v200
    v_fma_f32 v223, v223, v201, v200
    v_mfma_f32_16x16x32_bf16 v[214:217], v[88:91], a[160:163], v[214:217]
    v_mul_f32 v222, v128, v222
    v_mul_f32_e64 v223, v129, v223
    v_mfma_f32_16x16x32_bf16 v[214:217], v[92:95], a[176:179], v[214:217]
    s_add_u32 s61, s59, 59392
    buffer_load_dwordx4 v[64:67], v2, s[24:27], s61 offen offset:0
    v_exp_f32_e64 v222, v222
    v_mfma_f32_16x16x32_bf16 v[218:221], v[88:91], a[164:167], v[218:221]
    v_exp_f32_e64 v223, v223
    v_mfma_f32_16x16x32_bf16 v[218:221], v[92:95], a[180:183], v[218:221]
    v_fma_f32 v222, v222, v202, v202
    v_fma_f32 v223, v223, v202, v202
    v_mfma_f32_16x16x32_bf16 v[244:247], v[88:91], a[168:171], v[244:247]
    v_rcp_f32_e64 v222, v222
    v_mfma_f32_16x16x32_bf16 v[244:247], v[92:95], a[184:187], v[244:247]
    buffer_load_dwordx4 v[68:71], v2, s[24:27], s61 offen offset:1024
    v_rcp_f32_e64 v223, v223
    v_mfma_f32_16x16x32_bf16 v[248:251], v[88:91], a[172:175], v[248:251]
    v_mul_f32 v222, v128, v222
    v_mul_f32 v223, v129, v223
    v_mfma_f32_16x16x32_bf16 v[248:251], v[92:95], a[188:191], v[248:251]
L_pg5:
    s_cbranch_execz L_pg9
    s_waitcnt vmcnt(13)
    v_cvt_pk_bf16_f32 v210, v222, v223
    v_mul_f32 v224, v130, v130
    v_mul_f32 v225, v131, v131
    v_mfma_f32_16x16x32_bf16 v[214:217], v[96:99], a[192:195], v[214:217]
    v_fma_f32 v224, v224, v201, v200
    v_fma_f32 v225, v225, v201, v200
    v_mfma_f32_16x16x32_bf16 v[214:217], v[100:103], a[208:211], v[214:217]
    buffer_load_dwordx4 v[72:75], v2, s[24:27], s61 offen offset:2048
    v_mul_f32 v224, v130, v224
    v_mul_f32 v225, v131, v225
    v_mfma_f32_16x16x32_bf16 v[218:221], v[96:99], a[196:199], v[218:221]
    v_exp_f32_e64 v224, v224
    v_mfma_f32_16x16x32_bf16 v[218:221], v[100:103], a[212:215], v[218:221]
    buffer_store_dwordx4 v[164:167], v0, s[24:27], s64 offen offset:128 sc1
    s_add_u32 s64, s64, 331776
    v_mfma_f32_16x16x32_bf16 v[244:247], v[96:99], a[200:203], v[244:247]
    v_exp_f32_e64 v225, v225
    v_mfma_f32_16x16x32_bf16 v[244:247], v[100:103], a[216:219], v[244:247]
    buffer_load_dwordx4 v[76:79], v2, s[24:27], s61 offen offset:3072
    v_fma_f32 v224, v224, v202, v202
    v_fma_f32 v225, v225, v202, v202
    v_mfma_f32_16x16x32_bf16 v[248:251], v[96:99], a[204:207], v[248:251]
    v_rcp_f32_e64 v224, v224
    v_mfma_f32_16x16x32_bf16 v[248:251], v[100:103], a[220:223], v[248:251]
    s_waitcnt vmcnt(13)
    v_rcp_f32 v225, v225
    v_mfma_f32_16x16x32_bf16 v[214:217], v[104:107], a[224:227], v[214:217]
    v_mul_f32 v224, v130, v224
    v_mul_f32 v225, v131, v225
    v_mfma_f32_16x16x32_bf16 v[214:217], v[108:111], a[240:243], v[214:217]
    s_add_u32 s61, s59, 63488
    buffer_load_dwordx4 v[80:83], v2, s[24:27], s61 offen offset:0
    v_cvt_pk_bf16_f32 v211, v224, v225
    v_mfma_f32_16x16x32_bf16 v[218:221], v[104:107], a[228:231], v[218:221]
    v_mul_f32 v222, v132, v132
    v_mul_f32 v223, v133, v133
    v_mfma_f32_16x16x32_bf16 v[218:221], v[108:111], a[244:247], v[218:221]
    ds_write_b64 v231, v[210:211] offset:2048
    ds_read_b64_tr_b16 v[184:185], v233 offset:2560
    v_fma_f32 v222, v222, v204, v203
    v_fma_f32 v223, v223, v204, v203
    v_mfma_f32_16x16x32_bf16 v[244:247], v[104:107], a[232:235], v[244:247]
    v_mul_f32 v222, v132, v222
    v_mul_f32 v223, v133, v223
    v_mfma_f32_16x16x32_bf16 v[244:247], v[108:111], a[248:251], v[244:247]
    buffer_load_dwordx4 v[84:87], v2, s[24:27], s61 offen offset:1024
    v_exp_f32_e64 v222, v222
    v_mfma_f32_16x16x32_bf16 v[248:251], v[104:107], a[236:239], v[248:251]
    v_exp_f32_e64 v223, v223
    v_mfma_f32_16x16x32_bf16 v[248:251], v[108:111], a[252:255], v[248:251]
    s_waitcnt vmcnt(12)
    v_fma_f32 v222, v222, v205, v205
    v_fma_f32 v223, v223, v205, v205
    v_mfma_f32_16x16x32_bf16 v[214:217], v[112:115], v[16:19], v[214:217]
    v_rcp_f32 v222, v222
    v_mfma_f32_16x16x32_bf16 v[214:217], v[116:119], v[32:35], v[214:217]
    buffer_load_dwordx4 v[88:91], v2, s[24:27], s61 offen offset:2048
    v_rcp_f32_e64 v223, v223
    v_mfma_f32_16x16x32_bf16 v[218:221], v[112:115], v[20:23], v[218:221]
    v_mul_f32 v222, v132, v222
    v_mul_f32 v223, v133, v223
    v_mfma_f32_16x16x32_bf16 v[218:221], v[116:119], v[36:39], v[218:221]
    v_cvt_pk_bf16_f32 v212, v222, v223
    v_mul_f32 v224, v134, v134
    v_mul_f32 v225, v135, v135
    v_mfma_f32_16x16x32_bf16 v[244:247], v[112:115], v[24:27], v[244:247]
    v_fma_f32 v224, v224, v204, v203
    v_fma_f32 v225, v225, v204, v203
    v_mfma_f32_16x16x32_bf16 v[244:247], v[116:119], v[40:43], v[244:247]
    buffer_load_dwordx4 v[92:95], v2, s[24:27], s61 offen offset:3072
    v_mfma_f32_16x16x32_bf16 v[248:251], v[112:115], v[28:31], v[248:251]
    v_mul_f32 v224, v134, v224
    v_mul_f32 v225, v135, v225
    v_mfma_f32_16x16x32_bf16 v[248:251], v[116:119], v[44:47], v[248:251]
    s_waitcnt lgkmcnt(0)
    v_exp_f32 v224, v224
    v_exp_f32_e64 v225, v225
    v_mfma_f32_16x16x16_bf16 v[214:217], v[184:185], v[186:187], v[214:217]
    v_fma_f32 v224, v224, v205, v205
    v_fma_f32 v225, v225, v205, v205
    v_mfma_f32_16x16x16_bf16 v[218:221], v[184:185], v[188:189], v[218:221]
    v_rcp_f32 v224, v224
    v_rcp_f32 v225, v225
    v_mfma_f32_16x16x16_bf16 v[244:247], v[184:185], v[190:191], v[244:247]
    v_mul_f32 v224, v134, v224
    v_mul_f32 v225, v135, v225
    v_mfma_f32_16x16x16_bf16 v[248:251], v[184:185], v[192:193], v[248:251]
    s_waitcnt vmcnt(12)
    v_cvt_pk_bf16_f32 v213, v224, v225
    v_mfma_f32_16x16x32_bf16 v[120:123], v[48:51], a[0:3], 0
    v_mul_f32 v222, v136, v136
    v_mul_f32_e64 v223, v137, v137
    v_mfma_f32_16x16x32_bf16 v[120:123], v[52:55], a[16:19], v[120:123]
    ds_write_b64 v231, v[212:213] offset:3072
    s_add_u32 s61, s59, 67584
    buffer_load_dwordx4 v[96:99], v2, s[24:27], s61 offen offset:0
    v_mfma_f32_16x16x32_bf16 v[124:127], v[48:51], a[4:7], 0
    v_fma_f32 v222, v222, v195, v194
    v_fma_f32 v223, v223, v195, v194
    v_mfma_f32_16x16x32_bf16 v[124:127], v[52:55], a[20:23], v[124:127]
    buffer_store_dwordx4 v[168:171], v0, s[24:27], s64 offen offset:0 sc1
    v_mul_f32 v222, v136, v222
    v_mul_f32 v223, v137, v223
    v_mfma_f32_16x16x32_bf16 v[128:131], v[48:51], a[8:11], 0
    v_exp_f32_e64 v222, v222
    v_mfma_f32_16x16x32_bf16 v[128:131], v[52:55], a[24:27], v[128:131]
    buffer_load_dwordx4 v[100:103], v2, s[24:27], s61 offen offset:1024
    v_exp_f32_e64 v223, v223
    v_mfma_f32_16x16x32_bf16 v[132:135], v[48:51], a[12:15], 0
    v_fma_f32 v222, v222, v196, v196
    v_fma_f32 v223, v223, v196, v196
    v_mfma_f32_16x16x32_bf16 v[132:135], v[52:55], a[28:31], v[132:135]
    s_waitcnt vmcnt(12)
    v_rcp_f32 v222, v222
    v_mfma_f32_16x16x32_bf16 v[120:123], v[56:59], a[32:35], v[120:123]
    v_rcp_f32_e64 v223, v223
    v_mfma_f32_16x16x32_bf16 v[120:123], v[60:63], a[48:51], v[120:123]
    buffer_load_dwordx4 v[104:107], v2, s[24:27], s61 offen offset:2048
    v_mul_f32 v222, v136, v222
    v_mul_f32 v223, v137, v223
    v_mfma_f32_16x16x32_bf16 v[124:127], v[56:59], a[36:39], v[124:127]
    v_mul_f32 v224, v138, v138
    v_mul_f32 v225, v139, v139
    v_mfma_f32_16x16x32_bf16 v[124:127], v[60:63], a[52:55], v[124:127]
    v_cvt_pk_bf16_f32 v206, v222, v223
    v_fma_f32 v224, v224, v195, v194
    v_fma_f32 v225, v225, v195, v194
    v_mfma_f32_16x16x32_bf16 v[128:131], v[56:59], a[40:43], v[128:131]
    v_mul_f32 v224, v138, v224
    v_mul_f32 v225, v139, v225
    v_mfma_f32_16x16x32_bf16 v[128:131], v[60:63], a[56:59], v[128:131]
    buffer_load_dwordx4 v[108:111], v2, s[24:27], s61 offen offset:3072
    v_exp_f32_e64 v224, v224
    v_mfma_f32_16x16x32_bf16 v[132:135], v[56:59], a[44:47], v[132:135]
    v_exp_f32_e64 v225, v225
    v_mfma_f32_16x16x32_bf16 v[132:135], v[60:63], a[60:63], v[132:135]
    s_waitcnt vmcnt(12)
    v_fma_f32 v224, v224, v196, v196
    v_fma_f32 v225, v225, v196, v196
    v_mfma_f32_16x16x32_bf16 v[120:123], v[64:67], a[64:67], v[120:123]
    v_rcp_f32 v224, v224
    v_mfma_f32_16x16x32_bf16 v[120:123], v[68:71], a[80:83], v[120:123]
    s_add_u32 s61, s59, 71680
    buffer_load_dwordx4 v[112:115], v2, s[24:27], s61 offen offset:0
    v_rcp_f32_e64 v225, v225
    v_mfma_f32_16x16x32_bf16 v[124:127], v[64:67], a[68:71], v[124:127]
    v_mul_f32 v224, v138, v224
    v_mul_f32 v225, v139, v225
    v_mfma_f32_16x16x32_bf16 v[124:127], v[68:71], a[84:87], v[124:127]
    buffer_store_dwordx4 v[172:175], v0, s[24:27], s64 offen offset:128 sc1
    s_add_u32 s64, s64, 331776
    v_cvt_pk_bf16_f32 v207, v224, v225
    v_mfma_f32_16x16x32_bf16 v[128:131], v[64:67], a[72:75], v[128:131]
    v_mul_f32 v222, v140, v140
    v_mul_f32 v223, v141, v141
    v_mfma_f32_16x16x32_bf16 v[128:131], v[68:71], a[88:91], v[128:131]
    ds_write_b64 v231, v[206:207] offset:8192
    buffer_load_dwordx4 v[116:119], v2, s[24:27], s61 offen offset:1024
    v_mfma_f32_16x16x32_bf16 v[132:135], v[64:67], a[76:79], v[132:135]
    v_fma_f32 v222, v222, v198, v197
    v_fma_f32 v223, v223, v198, v197
    v_mfma_f32_16x16x32_bf16 v[132:135], v[68:71], a[92:95], v[132:135]
    s_waitcnt vmcnt(12)
    v_mul_f32 v222, v140, v222
    v_mul_f32 v223, v141, v223
    v_exp_f32 v222, v222
    v_mfma_f32_16x16x32_bf16 v[120:123], v[72:75], a[96:99], v[120:123]
    v_exp_f32_e64 v223, v223
    v_mfma_f32_16x16x32_bf16 v[120:123], v[76:79], a[112:115], v[120:123]
    buffer_load_dwordx4 v[48:51], v2, s[24:27], s61 offen offset:2048
    v_fma_f32 v222, v222, v199, v199
    v_fma_f32 v223, v223, v199, v199
    v_mfma_f32_16x16x32_bf16 v[124:127], v[72:75], a[100:103], v[124:127]
    v_rcp_f32_e64 v222, v222
    v_mfma_f32_16x16x32_bf16 v[124:127], v[76:79], a[116:119], v[124:127]
    v_rcp_f32_e64 v223, v223
    v_mfma_f32_16x16x32_bf16 v[128:131], v[72:75], a[104:107], v[128:131]
    v_mul_f32 v222, v140, v222
    v_mul_f32 v223, v141, v223
    v_mfma_f32_16x16x32_bf16 v[128:131], v[76:79], a[120:123], v[128:131]
    buffer_load_dwordx4 v[52:55], v2, s[24:27], s61 offen offset:3072
    v_cvt_pk_bf16_f32 v208, v222, v223
    v_mfma_f32_16x16x32_bf16 v[132:135], v[72:75], a[108:111], v[132:135]
    v_mul_f32 v224, v142, v142
    v_mul_f32 v225, v143, v143
    v_mfma_f32_16x16x32_bf16 v[132:135], v[76:79], a[124:127], v[132:135]
    s_waitcnt vmcnt(12)
    v_fma_f32 v224, v224, v198, v197
    v_fma_f32 v225, v225, v198, v197
    v_mul_f32 v224, v142, v224
    v_mul_f32_e64 v225, v143, v225
    v_mfma_f32_16x16x32_bf16 v[120:123], v[80:83], a[128:131], v[120:123]
    v_exp_f32_e64 v224, v224
    v_mfma_f32_16x16x32_bf16 v[120:123], v[84:87], a[144:147], v[120:123]
    s_add_u32 s61, s59, 75776
    buffer_load_dwordx4 v[56:59], v2, s[24:27], s61 offen offset:0
    v_exp_f32_e64 v225, v225
    v_mfma_f32_16x16x32_bf16 v[124:127], v[80:83], a[132:135], v[124:127]
    v_fma_f32 v224, v224, v199, v199
    v_fma_f32 v225, v225, v199, v199
    v_mfma_f32_16x16x32_bf16 v[124:127], v[84:87], a[148:151], v[124:127]
    buffer_store_dwordx4 v[176:179], v0, s[24:27], s64 offen offset:0 sc1
    v_mfma_f32_16x16x32_bf16 v[128:131], v[80:83], a[136:139], v[128:131]
    v_rcp_f32_e64 v224, v224
    v_mfma_f32_16x16x32_bf16 v[128:131], v[84:87], a[152:155], v[128:131]
    buffer_load_dwordx4 v[60:63], v2, s[24:27], s61 offen offset:1024
    v_rcp_f32_e64 v225, v225
    v_mfma_f32_16x16x32_bf16 v[132:135], v[80:83], a[140:143], v[132:135]
    v_mul_f32 v224, v142, v224
    v_mul_f32 v225, v143, v225
    v_mfma_f32_16x16x32_bf16 v[132:135], v[84:87], a[156:159], v[132:135]
    s_waitcnt vmcnt(13)
    v_cvt_pk_bf16_f32 v209, v224, v225
    v_mul_f32 v222, v144, v144
    v_mul_f32_e64 v223, v145, v145
    v_mfma_f32_16x16x32_bf16 v[120:123], v[88:91], a[160:163], v[120:123]
    v_fma_f32 v222, v222, v201, v200
    v_fma_f32 v223, v223, v201, v200
    v_mfma_f32_16x16x32_bf16 v[120:123], v[92:95], a[176:179], v[120:123]
    ds_write_b64 v231, v[208:209] offset:9216
    buffer_load_dwordx4 v[64:67], v2, s[24:27], s61 offen offset:2048
    v_mfma_f32_16x16x32_bf16 v[124:127], v[88:91], a[164:167], v[124:127]
    v_mul_f32 v222, v144, v222
    v_mul_f32 v223, v145, v223
    v_mfma_f32_16x16x32_bf16 v[124:127], v[92:95], a[180:183], v[124:127]
    v_exp_f32 v222, v222
    v_exp_f32 v223, v223
    v_mfma_f32_16x16x32_bf16 v[128:131], v[88:91], a[168:171], v[128:131]
    v_fma_f32 v222, v222, v202, v202
    v_fma_f32 v223, v223, v202, v202
    v_mfma_f32_16x16x32_bf16 v[128:131], v[92:95], a[184:187], v[128:131]
    buffer_load_dwordx4 v[68:71], v2, s[24:27], s61 offen offset:3072
    v_rcp_f32_e64 v222, v222
    v_mfma_f32_16x16x32_bf16 v[132:135], v[88:91], a[172:175], v[132:135]
    v_rcp_f32_e64 v223, v223
    v_mfma_f32_16x16x32_bf16 v[132:135], v[92:95], a[188:191], v[132:135]
    s_waitcnt vmcnt(12)
    v_mul_f32 v222, v144, v222
    v_mul_f32_e64 v223, v145, v223
    v_mfma_f32_16x16x32_bf16 v[120:123], v[96:99], a[192:195], v[120:123]
    v_mul_f32 v224, v146, v146
    v_mul_f32 v225, v147, v147
    v_mfma_f32_16x16x32_bf16 v[120:123], v[100:103], a[208:211], v[120:123]
    s_add_u32 s61, s59, 79872
    buffer_load_dwordx4 v[72:75], v2, s[24:27], s61 offen offset:0
    v_cvt_pk_bf16_f32 v210, v222, v223
    v_mfma_f32_16x16x32_bf16 v[124:127], v[96:99], a[196:199], v[124:127]
    v_fma_f32 v224, v224, v201, v200
    v_fma_f32 v225, v225, v201, v200
    v_mfma_f32_16x16x32_bf16 v[124:127], v[100:103], a[212:215], v[124:127]
    buffer_store_dwordx4 v[180:183], v0, s[24:27], s64 offen offset:128 sc1
    v_mul_f32 v224, v146, v224
    v_mul_f32 v225, v147, v225
    v_mfma_f32_16x16x32_bf16 v[128:131], v[96:99], a[200:203], v[128:131]
    v_exp_f32_e64 v224, v224
    v_mfma_f32_16x16x32_bf16 v[128:131], v[100:103], a[216:219], v[128:131]
    buffer_load_dwordx4 v[76:79], v2, s[24:27], s61 offen offset:1024
    v_exp_f32_e64 v225, v225
    v_mfma_f32_16x16x32_bf16 v[132:135], v[96:99], a[204:207], v[132:135]
    v_fma_f32 v224, v224, v202, v202
    v_fma_f32 v225, v225, v202, v202
    v_mfma_f32_16x16x32_bf16 v[132:135], v[100:103], a[220:223], v[132:135]
    s_waitcnt vmcnt(13)
    v_rcp_f32 v224, v224
    v_mfma_f32_16x16x32_bf16 v[120:123], v[104:107], a[224:227], v[120:123]
    v_rcp_f32_e64 v225, v225
    v_mfma_f32_16x16x32_bf16 v[120:123], v[108:111], a[240:243], v[120:123]
    buffer_load_dwordx4 v[80:83], v2, s[24:27], s61 offen offset:2048
    v_mul_f32 v224, v146, v224
    v_mul_f32 v225, v147, v225
    v_mfma_f32_16x16x32_bf16 v[124:127], v[104:107], a[228:231], v[124:127]
    v_cvt_pk_bf16_f32 v211, v224, v225
    v_mfma_f32_16x16x32_bf16 v[124:127], v[108:111], a[244:247], v[124:127]
    ds_write_b64 v231, v[210:211] offset:10240
    ds_read_b64_tr_b16 v[184:185], v233 offset:3840
    v_mul_f32 v222, v148, v148
    v_mul_f32 v223, v149, v149
    v_mfma_f32_16x16x32_bf16 v[128:131], v[104:107], a[232:235], v[128:131]
    v_fma_f32 v222, v222, v204, v203
    v_fma_f32 v223, v223, v204, v203
    v_mfma_f32_16x16x32_bf16 v[128:131], v[108:111], a[248:251], v[128:131]
    buffer_load_dwordx4 v[84:87], v2, s[24:27], s61 offen offset:3072
    v_mul_f32 v222, v148, v222
    v_mul_f32 v223, v149, v223
    v_mfma_f32_16x16x32_bf16 v[132:135], v[104:107], a[236:239], v[132:135]
    v_exp_f32_e64 v222, v222
    v_mfma_f32_16x16x32_bf16 v[132:135], v[108:111], a[252:255], v[132:135]
    s_waitcnt vmcnt(12)
    v_exp_f32 v223, v223
    v_mfma_f32_16x16x32_bf16 v[120:123], v[112:115], v[16:19], v[120:123]
    v_fma_f32 v222, v222, v205, v205
    v_fma_f32 v223, v223, v205, v205
    v_mfma_f32_16x16x32_bf16 v[120:123], v[116:119], v[32:35], v[120:123]
    s_add_u32 s61, s59, 83968
    buffer_load_dwordx4 v[88:91], v2, s[24:27], s61 offen offset:0
    v_rcp_f32_e64 v222, v222
    v_mfma_f32_16x16x32_bf16 v[124:127], v[112:115], v[20:23], v[124:127]
    v_rcp_f32_e64 v223, v223
    v_mfma_f32_16x16x32_bf16 v[124:127], v[116:119], v[36:39], v[124:127]
    v_mul_f32 v222, v148, v222
    v_mul_f32 v223, v149, v223
    v_cvt_pk_bf16_f32 v212, v222, v223
    v_mfma_f32_16x16x32_bf16 v[128:131], v[112:115], v[24:27], v[128:131]
    v_mul_f32 v224, v150, v150
    v_mul_f32 v225, v151, v151
    v_mfma_f32_16x16x32_bf16 v[128:131], v[116:119], v[40:43], v[128:131]
    buffer_load_dwordx4 v[92:95], v2, s[24:27], s61 offen offset:1024
    v_fma_f32 v224, v224, v204, v203
    v_fma_f32 v225, v225, v204, v203
    v_mfma_f32_16x16x32_bf16 v[132:135], v[112:115], v[28:31], v[132:135]
    v_mul_f32 v224, v150, v224
    v_mul_f32 v225, v151, v225
    v_mfma_f32_16x16x32_bf16 v[132:135], v[116:119], v[44:47], v[132:135]
    s_waitcnt lgkmcnt(0)
    v_exp_f32 v224, v224
    v_mfma_f32_16x16x16_bf16 v[120:123], v[184:185], v[186:187], v[120:123]
    v_exp_f32_e64 v225, v225
    v_fma_f32 v224, v224, v205, v205
    v_fma_f32 v225, v225, v205, v205
    v_mfma_f32_16x16x16_bf16 v[124:127], v[184:185], v[188:189], v[124:127]
    v_rcp_f32_e64 v224, v224
    v_mfma_f32_16x16x16_bf16 v[128:131], v[184:185], v[190:191], v[128:131]
    v_rcp_f32_e64 v225, v225
    v_mfma_f32_16x16x16_bf16 v[132:135], v[184:185], v[192:193], v[132:135]
    s_waitcnt vmcnt(12)
    v_mul_f32 v224, v150, v224
    v_mul_f32_e64 v225, v151, v225
    v_cvt_pk_bf16_f32 v213, v224, v225
    v_mfma_f32_16x16x32_bf16 v[136:139], v[48:51], a[0:3], 0
    v_mul_f32 v222, v214, v214
    v_mul_f32 v223, v215, v215
    v_mfma_f32_16x16x32_bf16 v[136:139], v[52:55], a[16:19], v[136:139]
    ds_write_b64 v231, v[212:213] offset:11264
    buffer_load_dwordx4 v[96:99], v2, s[24:27], s61 offen offset:2048
    v_mfma_f32_16x16x32_bf16 v[140:143], v[48:51], a[4:7], 0
    v_fma_f32 v222, v222, v195, v194
    v_fma_f32 v223, v223, v195, v194
    v_mfma_f32_16x16x32_bf16 v[140:143], v[52:55], a[20:23], v[140:143]
    v_mul_f32 v222, v214, v222
    v_mul_f32 v223, v215, v223
    v_exp_f32_e64 v222, v222
    v_mfma_f32_16x16x32_bf16 v[144:147], v[48:51], a[8:11], 0
    v_exp_f32_e64 v223, v223
    v_mfma_f32_16x16x32_bf16 v[144:147], v[52:55], a[24:27], v[144:147]
    buffer_load_dwordx4 v[100:103], v2, s[24:27], s61 offen offset:3072
    v_fma_f32 v222, v222, v196, v196
    v_fma_f32 v223, v223, v196, v196
    v_mfma_f32_16x16x32_bf16 v[148:151], v[48:51], a[12:15], 0
    v_rcp_f32_e64 v222, v222
    v_mfma_f32_16x16x32_bf16 v[148:151], v[52:55], a[28:31], v[148:151]
    s_waitcnt vmcnt(11)
    v_rcp_f32 v223, v223
    v_mfma_f32_16x16x32_bf16 v[136:139], v[56:59], a[32:35], v[136:139]
    v_mul_f32 v222, v214, v222
    v_mul_f32 v223, v215, v223
    v_mfma_f32_16x16x32_bf16 v[136:139], v[60:63], a[48:51], v[136:139]
    s_add_u32 s61, s59, 88064
    buffer_load_dwordx4 v[104:107], v2, s[24:27], s61 offen offset:0
    v_cvt_pk_bf16_f32 v206, v222, v223
    v_mfma_f32_16x16x32_bf16 v[140:143], v[56:59], a[36:39], v[140:143]
    v_mul_f32 v224, v216, v216
    v_mul_f32 v225, v217, v217
    v_mfma_f32_16x16x32_bf16 v[140:143], v[60:63], a[52:55], v[140:143]
    v_fma_f32 v224, v224, v195, v194
    v_fma_f32 v225, v225, v195, v194
    v_mul_f32 v224, v216, v224
    v_mul_f32 v225, v217, v225
    v_mfma_f32_16x16x32_bf16 v[144:147], v[56:59], a[40:43], v[144:147]
    v_exp_f32_e64 v224, v224
    v_mfma_f32_16x16x32_bf16 v[144:147], v[60:63], a[56:59], v[144:147]
    buffer_load_dwordx4 v[108:111], v2, s[24:27], s61 offen offset:1024
    v_exp_f32_e64 v225, v225
    v_mfma_f32_16x16x32_bf16 v[148:151], v[56:59], a[44:47], v[148:151]
    v_fma_f32 v224, v224, v196, v196
    v_fma_f32 v225, v225, v196, v196
    v_mfma_f32_16x16x32_bf16 v[148:151], v[60:63], a[60:63], v[148:151]
    s_waitcnt vmcnt(11)
    v_rcp_f32 v224, v224
    v_mfma_f32_16x16x32_bf16 v[136:139], v[64:67], a[64:67], v[136:139]
    v_rcp_f32_e64 v225, v225
    v_mfma_f32_16x16x32_bf16 v[136:139], v[68:71], a[80:83], v[136:139]
    buffer_load_dwordx4 v[112:115], v2, s[24:27], s61 offen offset:2048
    v_mul_f32 v224, v216, v224
    v_mul_f32 v225, v217, v225
    v_mfma_f32_16x16x32_bf16 v[140:143], v[64:67], a[68:71], v[140:143]
    v_cvt_pk_bf16_f32 v207, v224, v225
    v_mfma_f32_16x16x32_bf16 v[140:143], v[68:71], a[84:87], v[140:143]
    ds_write_b64 v231, v[206:207] offset:16384
    v_mul_f32 v222, v218, v218
    v_mul_f32 v223, v219, v219
    v_mfma_f32_16x16x32_bf16 v[144:147], v[64:67], a[72:75], v[144:147]
    v_fma_f32 v222, v222, v198, v197
    v_fma_f32 v223, v223, v198, v197
    v_mfma_f32_16x16x32_bf16 v[144:147], v[68:71], a[88:91], v[144:147]
    buffer_load_dwordx4 v[116:119], v2, s[24:27], s61 offen offset:3072
    v_mul_f32 v222, v218, v222
    v_mul_f32 v223, v219, v223
    v_mfma_f32_16x16x32_bf16 v[148:151], v[64:67], a[76:79], v[148:151]
    v_exp_f32_e64 v222, v222
    v_mfma_f32_16x16x32_bf16 v[148:151], v[68:71], a[92:95], v[148:151]
    s_waitcnt vmcnt(10)
    v_exp_f32 v223, v223
    v_fma_f32 v222, v222, v199, v199
    v_fma_f32 v223, v223, v199, v199
    v_mfma_f32_16x16x32_bf16 v[136:139], v[72:75], a[96:99], v[136:139]
    v_rcp_f32_e64 v222, v222
    v_mfma_f32_16x16x32_bf16 v[136:139], v[76:79], a[112:115], v[136:139]
    s_add_u32 s61, s59, 92160
    buffer_load_dwordx4 v[48:51], v2, s[24:27], s61 offen offset:0
    v_mfma_f32_16x16x32_bf16 v[140:143], v[72:75], a[100:103], v[140:143]
    v_rcp_f32_e64 v223, v223
    v_mfma_f32_16x16x32_bf16 v[140:143], v[76:79], a[116:119], v[140:143]
    v_mul_f32 v222, v218, v222
    v_mul_f32 v223, v219, v223
    v_cvt_pk_bf16_f32 v208, v222, v223
    v_mfma_f32_16x16x32_bf16 v[144:147], v[72:75], a[104:107], v[144:147]
    v_mul_f32 v224, v220, v220
    v_mul_f32 v225, v221, v221
    v_mfma_f32_16x16x32_bf16 v[144:147], v[76:79], a[120:123], v[144:147]
    buffer_load_dwordx4 v[52:55], v2, s[24:27], s61 offen offset:1024
    v_fma_f32 v224, v224, v198, v197
    v_fma_f32 v225, v225, v198, v197
    v_mfma_f32_16x16x32_bf16 v[148:151], v[72:75], a[108:111], v[148:151]
    v_mul_f32 v224, v220, v224
    v_mul_f32 v225, v221, v225
    v_mfma_f32_16x16x32_bf16 v[148:151], v[76:79], a[124:127], v[148:151]
    s_waitcnt vmcnt(10)
    v_exp_f32 v224, v224
    v_exp_f32_e64 v225, v225
    v_mfma_f32_16x16x32_bf16 v[136:139], v[80:83], a[128:131], v[136:139]
    v_fma_f32 v224, v224, v199, v199
    v_fma_f32 v225, v225, v199, v199
    v_mfma_f32_16x16x32_bf16 v[136:139], v[84:87], a[144:147], v[136:139]
    buffer_load_dwordx4 v[56:59], v2, s[24:27], s61 offen offset:2048
    v_mfma_f32_16x16x32_bf16 v[140:143], v[80:83], a[132:135], v[140:143]
    v_rcp_f32_e64 v224, v224
    v_mfma_f32_16x16x32_bf16 v[140:143], v[84:87], a[148:151], v[140:143]
    buffer_load_dwordx4 v[60:63], v2, s[24:27], s61 offen offset:3072
    v_rcp_f32_e64 v225, v225
    v_mfma_f32_16x16x32_bf16 v[144:147], v[80:83], a[136:139], v[144:147]
    v_mul_f32 v224, v220, v224
    v_mul_f32 v225, v221, v225
    v_mfma_f32_16x16x32_bf16 v[144:147], v[84:87], a[152:155], v[144:147]
    s_add_u32 s61, s59, 96256
    buffer_load_dwordx4 v[64:67], v2, s[24:27], s61 offen offset:0
    v_cvt_pk_bf16_f32 v209, v224, v225
    v_mfma_f32_16x16x32_bf16 v[148:151], v[80:83], a[140:143], v[148:151]
    v_mul_f32 v222, v244, v244
    v_mul_f32 v223, v245, v245
    v_mfma_f32_16x16x32_bf16 v[148:151], v[84:87], a[156:159], v[148:151]
    s_waitcnt vmcnt(11)
    ds_write_b64 v231, v[208:209] offset:17408
    v_fma_f32 v222, v222, v201, v200
    v_fma_f32 v223, v223, v201, v200
    v_mfma_f32_16x16x32_bf16 v[136:139], v[88:91], a[160:163], v[136:139]
    v_mul_f32 v222, v244, v222
    v_mul_f32_e64 v223, v245, v223
    v_mfma_f32_16x16x32_bf16 v[136:139], v[92:95], a[176:179], v[136:139]
    buffer_load_dwordx4 v[68:71], v2, s[24:27], s61 offen offset:1024
    v_exp_f32_e64 v222, v222
    v_mfma_f32_16x16x32_bf16 v[140:143], v[88:91], a[164:167], v[140:143]
    v_exp_f32_e64 v223, v223
    v_mfma_f32_16x16x32_bf16 v[140:143], v[92:95], a[180:183], v[140:143]
    v_fma_f32 v222, v222, v202, v202
    v_fma_f32 v223, v223, v202, v202
    v_mfma_f32_16x16x32_bf16 v[144:147], v[88:91], a[168:171], v[144:147]
    v_rcp_f32_e64 v222, v222
    v_mfma_f32_16x16x32_bf16 v[144:147], v[92:95], a[184:187], v[144:147]
    buffer_load_dwordx4 v[72:75], v2, s[24:27], s61 offen offset:2048
    v_rcp_f32_e64 v223, v223
    v_mfma_f32_16x16x32_bf16 v[148:151], v[88:91], a[172:175], v[148:151]
    v_mul_f32 v222, v244, v222
    v_mul_f32 v223, v245, v223
    v_mfma_f32_16x16x32_bf16 v[148:151], v[92:95], a[188:191], v[148:151]
    s_waitcnt vmcnt(11)
    v_cvt_pk_bf16_f32 v210, v222, v223
    v_mul_f32 v224, v246, v246
    v_mul_f32_e64 v225, v247, v247
    v_mfma_f32_16x16x32_bf16 v[136:139], v[96:99], a[192:195], v[136:139]
    v_fma_f32 v224, v224, v201, v200
    v_fma_f32 v225, v225, v201, v200
    v_mfma_f32_16x16x32_bf16 v[136:139], v[100:103], a[208:211], v[136:139]
    buffer_load_dwordx4 v[76:79], v2, s[24:27], s61 offen offset:3072
    v_mul_f32 v224, v246, v224
    v_mul_f32 v225, v247, v225
    v_mfma_f32_16x16x32_bf16 v[140:143], v[96:99], a[196:199], v[140:143]
    v_exp_f32_e64 v224, v224
    v_mfma_f32_16x16x32_bf16 v[140:143], v[100:103], a[212:215], v[140:143]
    v_exp_f32_e64 v225, v225
    v_mfma_f32_16x16x32_bf16 v[144:147], v[96:99], a[200:203], v[144:147]
    v_fma_f32 v224, v224, v202, v202
    v_fma_f32 v225, v225, v202, v202
    v_mfma_f32_16x16x32_bf16 v[144:147], v[100:103], a[216:219], v[144:147]
    s_add_u32 s61, s59, 100352
    buffer_load_dwordx4 v[80:83], v2, s[24:27], s61 offen offset:0
    v_rcp_f32_e64 v224, v224
    v_mfma_f32_16x16x32_bf16 v[148:151], v[96:99], a[204:207], v[148:151]
    v_rcp_f32_e64 v225, v225
    v_mfma_f32_16x16x32_bf16 v[148:151], v[100:103], a[220:223], v[148:151]
    s_waitcnt vmcnt(11)
    v_mul_f32 v224, v246, v224
    v_mul_f32_e64 v225, v247, v225
    v_cvt_pk_bf16_f32 v211, v224, v225
    v_mfma_f32_16x16x32_bf16 v[136:139], v[104:107], a[224:227], v[136:139]
    v_mul_f32 v222, v248, v248
    v_mul_f32 v223, v249, v249
    v_mfma_f32_16x16x32_bf16 v[136:139], v[108:111], a[240:243], v[136:139]
    ds_write_b64 v231, v[210:211] offset:18432
    buffer_load_dwordx4 v[84:87], v2, s[24:27], s61 offen offset:1024
    v_mfma_f32_16x16x32_bf16 v[140:143], v[104:107], a[228:231], v[140:143]
    v_fma_f32 v222, v222, v204, v203
    v_fma_f32 v223, v223, v204, v203
    v_mfma_f32_16x16x32_bf16 v[140:143], v[108:111], a[244:247], v[140:143]
    ds_read_b64_tr_b16 v[184:185], v233 offset:5120
    v_mul_f32 v222, v248, v222
    v_mul_f32 v223, v249, v223
    v_mfma_f32_16x16x32_bf16 v[144:147], v[104:107], a[232:235], v[144:147]
    v_exp_f32_e64 v222, v222
    v_mfma_f32_16x16x32_bf16 v[144:147], v[108:111], a[248:251], v[144:147]
    buffer_load_dwordx4 v[88:91], v2, s[24:27], s61 offen offset:2048
    v_exp_f32_e64 v223, v223
    v_mfma_f32_16x16x32_bf16 v[148:151], v[104:107], a[236:239], v[148:151]
    v_fma_f32 v222, v222, v205, v205
    v_fma_f32 v223, v223, v205, v205
    v_mfma_f32_16x16x32_bf16 v[148:151], v[108:111], a[252:255], v[148:151]
    s_waitcnt vmcnt(11)
    v_rcp_f32 v222, v222
    v_rcp_f32_e64 v223, v223
    v_mfma_f32_16x16x32_bf16 v[136:139], v[112:115], v[16:19], v[136:139]
    v_mul_f32 v222, v248, v222
    v_mul_f32 v223, v249, v223
    v_mfma_f32_16x16x32_bf16 v[136:139], v[116:119], v[32:35], v[136:139]
    buffer_load_dwordx4 v[92:95], v2, s[24:27], s61 offen offset:3072
    v_mfma_f32_16x16x32_bf16 v[140:143], v[112:115], v[20:23], v[140:143]
    v_mul_f32 v224, v250, v250
    v_mul_f32 v225, v251, v251
    v_mfma_f32_16x16x32_bf16 v[140:143], v[116:119], v[36:39], v[140:143]
    buffer_store_dword v13, v254, s[24:27], s55 offen offset:1024 sc1
    s_add_u32 s61, s59, 104448
    buffer_load_dwordx4 v[96:99], v2, s[24:27], s61 offen offset:0
    v_mfma_f32_16x16x32_bf16 v[144:147], v[112:115], v[24:27], v[144:147]
    v_cvt_pk_bf16_f32 v212, v222, v223
    v_mfma_f32_16x16x32_bf16 v[144:147], v[116:119], v[40:43], v[144:147]
    buffer_load_dwordx4 v[100:103], v2, s[24:27], s61 offen offset:1024
    v_fma_f32 v224, v224, v204, v203
    v_fma_f32 v225, v225, v204, v203
    v_mfma_f32_16x16x32_bf16 v[148:151], v[112:115], v[28:31], v[148:151]
    v_mul_f32 v224, v250, v224
    v_mul_f32 v225, v251, v225
    v_mfma_f32_16x16x32_bf16 v[148:151], v[116:119], v[44:47], v[148:151]
    s_waitcnt lgkmcnt(0)
    v_exp_f32 v224, v224
    v_exp_f32_e64 v225, v225
    v_mfma_f32_16x16x16_bf16 v[136:139], v[184:185], v[186:187], v[136:139]
    v_fma_f32 v224, v224, v205, v205
    v_fma_f32 v225, v225, v205, v205
    v_mfma_f32_16x16x16_bf16 v[140:143], v[184:185], v[188:189], v[140:143]
    v_rcp_f32_e64 v224, v224
    v_mfma_f32_16x16x16_bf16 v[144:147], v[184:185], v[190:191], v[144:147]
    v_rcp_f32_e64 v225, v225
    v_mfma_f32_16x16x16_bf16 v[148:151], v[184:185], v[192:193], v[148:151]
    s_waitcnt vmcnt(13)
    v_mul_f32 v224, v250, v224
    v_mul_f32_e64 v225, v251, v225
    v_cvt_pk_bf16_f32 v213, v224, v225
    v_mfma_f32_16x16x32_bf16 v[214:217], v[48:51], a[0:3], 0
    v_mul_f32 v222, v120, v120
    v_mul_f32 v223, v121, v121
    v_mfma_f32_16x16x32_bf16 v[214:217], v[52:55], a[16:19], v[214:217]
    ds_write_b64 v231, v[212:213] offset:19456
    buffer_load_dwordx4 v[104:107], v2, s[24:27], s61 offen offset:2048
    v_mfma_f32_16x16x32_bf16 v[218:221], v[48:51], a[4:7], 0
    v_fma_f32 v222, v222, v195, v194
    v_fma_f32 v223, v223, v195, v194
    v_mfma_f32_16x16x32_bf16 v[218:221], v[52:55], a[20:23], v[218:221]
    v_mul_f32 v222, v120, v222
    v_mul_f32 v223, v121, v223
    v_exp_f32_e64 v222, v222
    v_mfma_f32_16x16x32_bf16 v[244:247], v[48:51], a[8:11], 0
    v_exp_f32_e64 v223, v223
    v_mfma_f32_16x16x32_bf16 v[244:247], v[52:55], a[24:27], v[244:247]
    buffer_load_dwordx4 v[108:111], v2, s[24:27], s61 offen offset:3072
    v_fma_f32 v222, v222, v196, v196
    v_fma_f32 v223, v223, v196, v196
    v_mfma_f32_16x16x32_bf16 v[248:251], v[48:51], a[12:15], 0
    v_rcp_f32_e64 v222, v222
    v_mfma_f32_16x16x32_bf16 v[248:251], v[52:55], a[28:31], v[248:251]
L_pg6:
    s_cbranch_execz L_pg10
    s_waitcnt vmcnt(13)
    v_rcp_f32_e64 v223, v223
    v_mfma_f32_16x16x32_bf16 v[214:217], v[56:59], a[32:35], v[214:217]
    v_mul_f32 v222, v120, v222
    v_mul_f32 v223, v121, v223
    v_mfma_f32_16x16x32_bf16 v[214:217], v[60:63], a[48:51], v[214:217]
    s_add_u32 s61, s59, 108544
    buffer_load_dwordx4 v[112:115], v2, s[24:27], s61 offen offset:0
    v_cvt_pk_bf16_f32 v206, v222, v223
    v_mfma_f32_16x16x32_bf16 v[218:221], v[56:59], a[36:39], v[218:221]
    v_mul_f32 v224, v122, v122
    v_mul_f32 v225, v123, v123
    v_mfma_f32_16x16x32_bf16 v[218:221], v[60:63], a[52:55], v[218:221]
    v_fma_f32 v224, v224, v195, v194
    v_fma_f32 v225, v225, v195, v194
    v_mul_f32 v224, v122, v224
    v_mul_f32 v225, v123, v225
    v_mfma_f32_16x16x32_bf16 v[244:247], v[56:59], a[40:43], v[244:247]
    v_exp_f32_e64 v224, v224
    v_mfma_f32_16x16x32_bf16 v[244:247], v[60:63], a[56:59], v[244:247]
    buffer_load_dwordx4 v[116:119], v2, s[24:27], s61 offen offset:1024
    v_mfma_f32_16x16x32_bf16 v[248:251], v[56:59], a[44:47], v[248:251]
    v_exp_f32_e64 v225, v225
    v_mfma_f32_16x16x32_bf16 v[248:251], v[60:63], a[60:63], v[248:251]
    s_waitcnt vmcnt(13)
    v_fma_f32 v224, v224, v196, v196
    v_fma_f32 v225, v225, v196, v196
    v_rcp_f32 v224, v224
    v_mfma_f32_16x16x32_bf16 v[214:217], v[64:67], a[64:67], v[214:217]
    v_rcp_f32_e64 v225, v225
    v_mfma_f32_16x16x32_bf16 v[214:217], v[68:71], a[80:83], v[214:217]
    buffer_load_dwordx4 v[48:51], v2, s[24:27], s61 offen offset:2048
    v_mul_f32 v224, v122, v224
    v_mul_f32 v225, v123, v225
    v_mfma_f32_16x16x32_bf16 v[218:221], v[64:67], a[68:71], v[218:221]
    v_cvt_pk_bf16_f32 v207, v224, v225
    v_mfma_f32_16x16x32_bf16 v[218:221], v[68:71], a[84:87], v[218:221]
    ds_write_b64 v231, v[206:207] offset:24576
    v_mul_f32 v222, v124, v124
    v_mul_f32 v223, v125, v125
    v_mfma_f32_16x16x32_bf16 v[244:247], v[64:67], a[72:75], v[244:247]
    v_fma_f32 v222, v222, v198, v197
    v_fma_f32 v223, v223, v198, v197
    v_mfma_f32_16x16x32_bf16 v[244:247], v[68:71], a[88:91], v[244:247]
    buffer_load_dwordx4 v[52:55], v2, s[24:27], s61 offen offset:3072
    v_mul_f32 v222, v124, v222
    v_mul_f32 v223, v125, v223
    v_mfma_f32_16x16x32_bf16 v[248:251], v[64:67], a[76:79], v[248:251]
    v_exp_f32_e64 v222, v222
    v_mfma_f32_16x16x32_bf16 v[248:251], v[68:71], a[92:95], v[248:251]
    s_waitcnt vmcnt(13)
    v_exp_f32 v223, v223
    v_mfma_f32_16x16x32_bf16 v[214:217], v[72:75], a[96:99], v[214:217]
    v_fma_f32 v222, v222, v199, v199
    v_fma_f32 v223, v223, v199, v199
    v_mfma_f32_16x16x32_bf16 v[214:217], v[76:79], a[112:115], v[214:217]
    s_add_u32 s61, s59, 112640
    buffer_load_dwordx4 v[56:59], v2, s[24:27], s61 offen offset:0
    v_rcp_f32_e64 v222, v222
    v_mfma_f32_16x16x32_bf16 v[218:221], v[72:75], a[100:103], v[218:221]
    v_rcp_f32_e64 v223, v223
    v_mfma_f32_16x16x32_bf16 v[218:221], v[76:79], a[116:119], v[218:221]
    v_mul_f32 v222, v124, v222
    v_mul_f32 v223, v125, v223
    v_cvt_pk_bf16_f32 v208, v222, v223
    v_mfma_f32_16x16x32_bf16 v[244:247], v[72:75], a[104:107], v[244:247]
    v_mul_f32 v224, v126, v126
    v_mul_f32 v225, v127, v127
    v_mfma_f32_16x16x32_bf16 v[244:247], v[76:79], a[120:123], v[244:247]
    buffer_load_dwordx4 v[60:63], v2, s[24:27], s61 offen offset:1024
    v_fma_f32 v224, v224, v198, v197
    v_fma_f32 v225, v225, v198, v197
    v_mfma_f32_16x16x32_bf16 v[248:251], v[72:75], a[108:111], v[248:251]
    v_mul_f32 v224, v126, v224
    v_mul_f32 v225, v127, v225
    v_mfma_f32_16x16x32_bf16 v[248:251], v[76:79], a[124:127], v[248:251]
    s_waitcnt vmcnt(13)
    v_exp_f32 v224, v224
    v_mfma_f32_16x16x32_bf16 v[214:217], v[80:83], a[128:131], v[214:217]
    v_exp_f32_e64 v225, v225
    v_mfma_f32_16x16x32_bf16 v[214:217], v[84:87], a[144:147], v[214:217]
    buffer_load_dwordx4 v[64:67], v2, s[24:27], s61 offen offset:2048
    v_fma_f32 v224, v224, v199, v199
    v_fma_f32 v225, v225, v199, v199
    v_mfma_f32_16x16x32_bf16 v[218:221], v[80:83], a[132:135], v[218:221]
    v_rcp_f32_e64 v224, v224
    v_mfma_f32_16x16x32_bf16 v[218:221], v[84:87], a[148:151], v[218:221]
    buffer_load_dwordx4 v[68:71], v2, s[24:27], s61 offen offset:3072
    v_mfma_f32_16x16x32_bf16 v[244:247], v[80:83], a[136:139], v[244:247]
    v_rcp_f32_e64 v225, v225
    v_mfma_f32_16x16x32_bf16 v[244:247], v[84:87], a[152:155], v[244:247]
    s_add_u32 s61, s59, 116736
    buffer_load_dwordx4 v[72:75], v2, s[24:27], s61 offen offset:0
    v_mul_f32 v224, v126, v224
    v_mul_f32 v225, v127, v225
    v_mfma_f32_16x16x32_bf16 v[248:251], v[80:83], a[140:143], v[248:251]
    v_cvt_pk_bf16_f32 v209, v224, v225
    v_mfma_f32_16x16x32_bf16 v[248:251], v[84:87], a[156:159], v[248:251]
    s_waitcnt vmcnt(14)
    ds_write_b64 v231, v[208:209] offset:25600
    v_mul_f32 v222, v128, v128
    v_mul_f32_e64 v223, v129, v129
    v_fma_f32 v222, v222, v201, v200
    v_fma_f32 v223, v223, v201, v200
    v_mfma_f32_16x16x32_bf16 v[214:217], v[88:91], a[160:163], v[214:217]
    v_mul_f32 v222, v128, v222
    v_mul_f32 v223, v129, v223
    v_mfma_f32_16x16x32_bf16 v[214:217], v[92:95], a[176:179], v[214:217]
    buffer_load_dwordx4 v[76:79], v2, s[24:27], s61 offen offset:1024
    v_mfma_f32_16x16x32_bf16 v[218:221], v[88:91], a[164:167], v[218:221]
    v_exp_f32_e64 v222, v222
    v_mfma_f32_16x16x32_bf16 v[218:221], v[92:95], a[180:183], v[218:221]
    v_exp_f32_e64 v223, v223
    v_fma_f32 v222, v222, v202, v202
    v_fma_f32 v223, v223, v202, v202
    v_mfma_f32_16x16x32_bf16 v[244:247], v[88:91], a[168:171], v[244:247]
    v_rcp_f32_e64 v222, v222
    v_mfma_f32_16x16x32_bf16 v[244:247], v[92:95], a[184:187], v[244:247]
    buffer_load_dwordx4 v[80:83], v2, s[24:27], s61 offen offset:2048
    v_mfma_f32_16x16x32_bf16 v[248:251], v[88:91], a[172:175], v[248:251]
    v_rcp_f32_e64 v223, v223
    v_mfma_f32_16x16x32_bf16 v[248:251], v[92:95], a[188:191], v[248:251]
    s_waitcnt vmcnt(13)
    v_mul_f32 v222, v128, v222
    v_mul_f32_e64 v223, v129, v223
    v_cvt_pk_bf16_f32 v210, v222, v223
    v_mfma_f32_16x16x32_bf16 v[214:217], v[96:99], a[192:195], v[214:217]
    v_mul_f32 v224, v130, v130
    v_mul_f32 v225, v131, v131
    v_mfma_f32_16x16x32_bf16 v[214:217], v[100:103], a[208:211], v[214:217]
    buffer_load_dwordx4 v[84:87], v2, s[24:27], s61 offen offset:3072
    v_fma_f32 v224, v224, v201, v200
    v_fma_f32 v225, v225, v201, v200
    v_mfma_f32_16x16x32_bf16 v[218:221], v[96:99], a[196:199], v[218:221]
    v_mul_f32 v224, v130, v224
    v_mul_f32 v225, v131, v225
    v_mfma_f32_16x16x32_bf16 v[218:221], v[100:103], a[212:215], v[218:221]
    v_exp_f32 v224, v224
    v_exp_f32 v225, v225
    v_mfma_f32_16x16x32_bf16 v[244:247], v[96:99], a[200:203], v[244:247]
    v_fma_f32 v224, v224, v202, v202
    v_fma_f32 v225, v225, v202, v202
    v_mfma_f32_16x16x32_bf16 v[244:247], v[100:103], a[216:219], v[244:247]
    s_add_u32 s61, s59, 120832
    buffer_load_dwordx4 v[88:91], v2, s[24:27], s61 offen offset:0
    v_mfma_f32_16x16x32_bf16 v[248:251], v[96:99], a[204:207], v[248:251]
    v_rcp_f32_e64 v224, v224
    v_mfma_f32_16x16x32_bf16 v[248:251], v[100:103], a[220:223], v[248:251]
    s_waitcnt vmcnt(13)
    v_rcp_f32 v225, v225
    v_mul_f32 v224, v130, v224
    v_mul_f32 v225, v131, v225
    v_mfma_f32_16x16x32_bf16 v[214:217], v[104:107], a[224:227], v[214:217]
    v_cvt_pk_bf16_f32 v211, v224, v225
    v_mfma_f32_16x16x32_bf16 v[214:217], v[108:111], a[240:243], v[214:217]
    ds_write_b64 v231, v[210:211] offset:26624
    buffer_load_dwordx4 v[92:95], v2, s[24:27], s61 offen offset:1024
    v_mfma_f32_16x16x32_bf16 v[218:221], v[104:107], a[228:231], v[218:221]
    v_mul_f32 v222, v132, v132
    v_mul_f32 v223, v133, v133
    v_mfma_f32_16x16x32_bf16 v[218:221], v[108:111], a[244:247], v[218:221]
    ds_read_b64_tr_b16 v[184:185], v233 offset:6400
    v_fma_f32 v222, v222, v204, v203
    v_fma_f32 v223, v223, v204, v203
    v_mul_f32 v222, v132, v222
    v_mul_f32 v223, v133, v223
    v_mfma_f32_16x16x32_bf16 v[244:247], v[104:107], a[232:235], v[244:247]
    v_exp_f32_e64 v222, v222
    v_mfma_f32_16x16x32_bf16 v[244:247], v[108:111], a[248:251], v[244:247]
    buffer_load_dwordx4 v[96:99], v2, s[24:27], s61 offen offset:2048
    v_mfma_f32_16x16x32_bf16 v[248:251], v[104:107], a[236:239], v[248:251]
    v_exp_f32_e64 v223, v223
    v_mfma_f32_16x16x32_bf16 v[248:251], v[108:111], a[252:255], v[248:251]
    s_waitcnt vmcnt(13)
    v_fma_f32 v222, v222, v205, v205
    v_fma_f32 v223, v223, v205, v205
    v_rcp_f32 v222, v222
    v_mfma_f32_16x16x32_bf16 v[214:217], v[112:115], v[16:19], v[214:217]
    v_rcp_f32_e64 v223, v223
    v_mfma_f32_16x16x32_bf16 v[214:217], v[116:119], v[32:35], v[214:217]
    buffer_load_dwordx4 v[100:103], v2, s[24:27], s61 offen offset:3072
    v_mfma_f32_16x16x32_bf16 v[218:221], v[112:115], v[20:23], v[218:221]
    v_mul_f32 v222, v132, v222
    v_mul_f32 v223, v133, v223
    v_mfma_f32_16x16x32_bf16 v[218:221], v[116:119], v[36:39], v[218:221]
    s_add_u32 s61, s59, 124928
    buffer_load_dwordx4 v[104:107], v2, s[24:27], s61 offen offset:0
    v_cvt_pk_bf16_f32 v212, v222, v223
    v_mfma_f32_16x16x32_bf16 v[244:247], v[112:115], v[24:27], v[244:247]
    v_mul_f32 v224, v134, v134
    v_mul_f32 v225, v135, v135
    v_mfma_f32_16x16x32_bf16 v[244:247], v[116:119], v[40:43], v[244:247]
    buffer_load_dwordx4 v[108:111], v2, s[24:27], s61 offen offset:1024
    v_fma_f32 v224, v224, v204, v203
    v_fma_f32 v225, v225, v204, v203
    v_mfma_f32_16x16x32_bf16 v[248:251], v[112:115], v[28:31], v[248:251]
    v_mul_f32 v224, v134, v224
    v_mul_f32 v225, v135, v225
    v_mfma_f32_16x16x32_bf16 v[248:251], v[116:119], v[44:47], v[248:251]
    s_waitcnt lgkmcnt(0)
    v_exp_f32 v224, v224
    v_exp_f32_e64 v225, v225
    v_mfma_f32_16x16x16_bf16 v[214:217], v[184:185], v[186:187], v[214:217]
    v_fma_f32 v224, v224, v205, v205
    v_fma_f32 v225, v225, v205, v205
    v_mfma_f32_16x16x16_bf16 v[218:221], v[184:185], v[188:189], v[218:221]
    v_rcp_f32_e64 v224, v224
    v_mfma_f32_16x16x16_bf16 v[244:247], v[184:185], v[190:191], v[244:247]
    v_rcp_f32_e64 v225, v225
    v_mfma_f32_16x16x16_bf16 v[248:251], v[184:185], v[192:193], v[248:251]
    s_waitcnt vmcnt(14)
    v_mul_f32 v224, v134, v224
    v_mul_f32_e64 v225, v135, v225
    v_cvt_pk_bf16_f32 v213, v224, v225
    v_mfma_f32_16x16x32_bf16 v[120:123], v[48:51], a[0:3], 0
    v_mul_f32 v222, v136, v136
    v_mul_f32 v223, v137, v137
    v_mfma_f32_16x16x32_bf16 v[120:123], v[52:55], a[16:19], v[120:123]
    ds_write_b64 v231, v[212:213] offset:27648
    buffer_load_dwordx4 v[112:115], v2, s[24:27], s61 offen offset:2048
    v_mfma_f32_16x16x32_bf16 v[124:127], v[48:51], a[4:7], 0
    v_fma_f32 v222, v222, v195, v194
    v_fma_f32 v223, v223, v195, v194
    v_mfma_f32_16x16x32_bf16 v[124:127], v[52:55], a[20:23], v[124:127]
    v_mul_f32 v222, v136, v222
    v_mul_f32 v223, v137, v223
    v_exp_f32_e64 v222, v222
    v_mfma_f32_16x16x32_bf16 v[128:131], v[48:51], a[8:11], 0
    v_exp_f32_e64 v223, v223
    v_mfma_f32_16x16x32_bf16 v[128:131], v[52:55], a[24:27], v[128:131]
    buffer_load_dwordx4 v[116:119], v2, s[24:27], s61 offen offset:3072
    v_mfma_f32_16x16x32_bf16 v[132:135], v[48:51], a[12:15], 0
    v_fma_f32 v222, v222, v196, v196
    v_fma_f32 v223, v223, v196, v196
    v_mfma_f32_16x16x32_bf16 v[132:135], v[52:55], a[28:31], v[132:135]
    s_waitcnt vmcnt(14)
    v_rcp_f32 v222, v222
    v_rcp_f32_e64 v223, v223
    v_mfma_f32_16x16x32_bf16 v[120:123], v[56:59], a[32:35], v[120:123]
    v_mul_f32 v222, v136, v222
    v_mul_f32 v223, v137, v223
    v_mfma_f32_16x16x32_bf16 v[120:123], v[60:63], a[48:51], v[120:123]
    s_add_u32 s61, s59, 129024
    buffer_load_dwordx4 v[48:51], v2, s[24:27], s61 offen offset:0
    v_cvt_pk_bf16_f32 v206, v222, v223
    v_mfma_f32_16x16x32_bf16 v[124:127], v[56:59], a[36:39], v[124:127]
    v_mul_f32 v224, v138, v138
    v_mul_f32 v225, v139, v139
    v_mfma_f32_16x16x32_bf16 v[124:127], v[60:63], a[52:55], v[124:127]
    v_fma_f32 v224, v224, v195, v194
    v_fma_f32 v225, v225, v195, v194
    v_mfma_f32_16x16x32_bf16 v[128:131], v[56:59], a[40:43], v[128:131]
    v_mul_f32 v224, v138, v224
    v_mul_f32 v225, v139, v225
    v_mfma_f32_16x16x32_bf16 v[128:131], v[60:63], a[56:59], v[128:131]
    buffer_load_dwordx4 v[52:55], v2, s[24:27], s61 offen offset:1024
    v_exp_f32_e64 v224, v224
    v_mfma_f32_16x16x32_bf16 v[132:135], v[56:59], a[44:47], v[132:135]
    v_exp_f32_e64 v225, v225
    v_mfma_f32_16x16x32_bf16 v[132:135], v[60:63], a[60:63], v[132:135]
    s_waitcnt vmcnt(14)
    v_fma_f32 v224, v224, v196, v196
    v_fma_f32 v225, v225, v196, v196
    v_rcp_f32 v224, v224
    v_mfma_f32_16x16x32_bf16 v[120:123], v[64:67], a[64:67], v[120:123]
    v_rcp_f32_e64 v225, v225
    v_mfma_f32_16x16x32_bf16 v[120:123], v[68:71], a[80:83], v[120:123]
    buffer_load_dwordx4 v[56:59], v2, s[24:27], s61 offen offset:2048
    v_mfma_f32_16x16x32_bf16 v[124:127], v[64:67], a[68:71], v[124:127]
    v_mul_f32 v224, v138, v224
    v_mul_f32 v225, v139, v225
    v_mfma_f32_16x16x32_bf16 v[124:127], v[68:71], a[84:87], v[124:127]
    v_cvt_pk_bf16_f32 v207, v224, v225
    v_mul_f32 v222, v140, v140
    v_mul_f32 v223, v141, v141
    v_mfma_f32_16x16x32_bf16 v[128:131], v[64:67], a[72:75], v[128:131]
    v_fma_f32 v222, v222, v198, v197
    v_fma_f32 v223, v223, v198, v197
    v_mfma_f32_16x16x32_bf16 v[128:131], v[68:71], a[88:91], v[128:131]
    ds_write_b64 v231, v[206:207] offset:32768
    buffer_load_dwordx4 v[60:63], v2, s[24:27], s61 offen offset:3072
    v_mfma_f32_16x16x32_bf16 v[132:135], v[64:67], a[76:79], v[132:135]
    v_mul_f32 v222, v140, v222
    v_mul_f32 v223, v141, v223
    v_mfma_f32_16x16x32_bf16 v[132:135], v[68:71], a[92:95], v[132:135]
    s_waitcnt vmcnt(14)
    v_exp_f32 v222, v222
    v_exp_f32_e64 v223, v223
    v_mfma_f32_16x16x32_bf16 v[120:123], v[72:75], a[96:99], v[120:123]
    v_fma_f32 v222, v222, v199, v199
    v_fma_f32 v223, v223, v199, v199
    v_mfma_f32_16x16x32_bf16 v[120:123], v[76:79], a[112:115], v[120:123]
    s_add_u32 s61, s59, 133120
    buffer_load_dwordx4 v[64:67], v2, s[24:27], s61 offen offset:0
    v_mfma_f32_16x16x32_bf16 v[124:127], v[72:75], a[100:103], v[124:127]
    v_rcp_f32_e64 v222, v222
    v_mfma_f32_16x16x32_bf16 v[124:127], v[76:79], a[116:119], v[124:127]
    v_rcp_f32 v223, v223
    v_mul_f32 v222, v140, v222
    v_mul_f32_e64 v223, v141, v223
    v_mfma_f32_16x16x32_bf16 v[128:131], v[72:75], a[104:107], v[128:131]
    v_mul_f32 v224, v142, v142
    v_mul_f32 v225, v143, v143
    v_mfma_f32_16x16x32_bf16 v[128:131], v[76:79], a[120:123], v[128:131]
    buffer_load_dwordx4 v[68:71], v2, s[24:27], s61 offen offset:1024
    v_cvt_pk_bf16_f32 v208, v222, v223
    v_mfma_f32_16x16x32_bf16 v[132:135], v[72:75], a[108:111], v[132:135]
    v_fma_f32 v224, v224, v198, v197
    v_fma_f32 v225, v225, v198, v197
    v_mfma_f32_16x16x32_bf16 v[132:135], v[76:79], a[124:127], v[132:135]
    s_waitcnt vmcnt(14)
    v_mul_f32 v224, v142, v224
    v_mul_f32_e64 v225, v143, v225
    v_mfma_f32_16x16x32_bf16 v[120:123], v[80:83], a[128:131], v[120:123]
    v_exp_f32_e64 v224, v224
    v_mfma_f32_16x16x32_bf16 v[120:123], v[84:87], a[144:147], v[120:123]
    buffer_load_dwordx4 v[72:75], v2, s[24:27], s61 offen offset:2048
    v_exp_f32_e64 v225, v225
    v_mfma_f32_16x16x32_bf16 v[124:127], v[80:83], a[132:135], v[124:127]
    v_fma_f32 v224, v224, v199, v199
    v_fma_f32 v225, v225, v199, v199
    v_mfma_f32_16x16x32_bf16 v[124:127], v[84:87], a[148:151], v[124:127]
    v_rcp_f32_e64 v224, v224
    v_mfma_f32_16x16x32_bf16 v[128:131], v[80:83], a[136:139], v[128:131]
    v_rcp_f32_e64 v225, v225
    v_mfma_f32_16x16x32_bf16 v[128:131], v[84:87], a[152:155], v[128:131]
    buffer_load_dwordx4 v[76:79], v2, s[24:27], s61 offen offset:3072
    v_mul_f32 v224, v142, v224
    v_mul_f32 v225, v143, v225
    v_mfma_f32_16x16x32_bf16 v[132:135], v[80:83], a[140:143], v[132:135]
    v_cvt_pk_bf16_f32 v209, v224, v225
    v_mfma_f32_16x16x32_bf16 v[132:135], v[84:87], a[156:159], v[132:135]
    s_waitcnt vmcnt(14)
    ds_write_b64 v231, v[208:209] offset:33792
    v_mul_f32 v222, v144, v144
    v_mul_f32_e64 v223, v145, v145
    v_fma_f32 v222, v222, v201, v200
    v_fma_f32 v223, v223, v201, v200
    v_mfma_f32_16x16x32_bf16 v[120:123], v[88:91], a[160:163], v[120:123]
    v_mul_f32 v222, v144, v222
    v_mul_f32 v223, v145, v223
    v_mfma_f32_16x16x32_bf16 v[120:123], v[92:95], a[176:179], v[120:123]
    s_add_u32 s61, s59, 137216
    buffer_load_dwordx4 v[80:83], v2, s[24:27], s61 offen offset:0
    v_mfma_f32_16x16x32_bf16 v[124:127], v[88:91], a[164:167], v[124:127]
    v_exp_f32_e64 v222, v222
    v_mfma_f32_16x16x32_bf16 v[124:127], v[92:95], a[180:183], v[124:127]
    v_exp_f32_e64 v223, v223
    v_fma_f32 v222, v222, v202, v202
    v_fma_f32 v223, v223, v202, v202
    v_mfma_f32_16x16x32_bf16 v[128:131], v[88:91], a[168:171], v[128:131]
    v_rcp_f32_e64 v222, v222
    v_mfma_f32_16x16x32_bf16 v[128:131], v[92:95], a[184:187], v[128:131]
    buffer_load_dwordx4 v[84:87], v2, s[24:27], s61 offen offset:1024
    v_mfma_f32_16x16x32_bf16 v[132:135], v[88:91], a[172:175], v[132:135]
    v_rcp_f32_e64 v223, v223
    v_mfma_f32_16x16x32_bf16 v[132:135], v[92:95], a[188:191], v[132:135]
    s_waitcnt vmcnt(14)
    v_mul_f32 v222, v144, v222
    v_mul_f32_e64 v223, v145, v223
    v_cvt_pk_bf16_f32 v210, v222, v223
    v_mfma_f32_16x16x32_bf16 v[120:123], v[96:99], a[192:195], v[120:123]
    v_mul_f32 v224, v146, v146
    v_mul_f32 v225, v147, v147
    v_mfma_f32_16x16x32_bf16 v[120:123], v[100:103], a[208:211], v[120:123]
    buffer_load_dwordx4 v[88:91], v2, s[24:27], s61 offen offset:2048
    v_fma_f32 v224, v224, v201, v200
    v_fma_f32 v225, v225, v201, v200
    v_mfma_f32_16x16x32_bf16 v[124:127], v[96:99], a[196:199], v[124:127]
    v_mul_f32 v224, v146, v224
    v_mul_f32 v225, v147, v225
    v_mfma_f32_16x16x32_bf16 v[124:127], v[100:103], a[212:215], v[124:127]
    v_exp_f32_e64 v224, v224
    v_mfma_f32_16x16x32_bf16 v[128:131], v[96:99], a[200:203], v[128:131]
    v_exp_f32_e64 v225, v225
    v_mfma_f32_16x16x32_bf16 v[128:131], v[100:103], a[216:219], v[128:131]
    buffer_load_dwordx4 v[92:95], v2, s[24:27], s61 offen offset:3072
    v_fma_f32 v224, v224, v202, v202
    v_fma_f32 v225, v225, v202, v202
    v_mfma_f32_16x16x32_bf16 v[132:135], v[96:99], a[204:207], v[132:135]
    v_rcp_f32_e64 v224, v224
    v_mfma_f32_16x16x32_bf16 v[132:135], v[100:103], a[220:223], v[132:135]
    s_waitcnt vmcnt(14)
    v_rcp_f32 v225, v225
    v_mfma_f32_16x16x32_bf16 v[120:123], v[104:107], a[224:227], v[120:123]
    v_mul_f32 v224, v146, v224
    v_mul_f32 v225, v147, v225
    v_mfma_f32_16x16x32_bf16 v[120:123], v[108:111], a[240:243], v[120:123]
    s_add_u32 s61, s59, 141312
    buffer_load_dwordx4 v[96:99], v2, s[24:27], s61 offen offset:0
    v_cvt_pk_bf16_f32 v211, v224, v225
    v_mfma_f32_16x16x32_bf16 v[124:127], v[104:107], a[228:231], v[124:127]
    v_mul_f32 v222, v148, v148
    v_mul_f32 v223, v149, v149
    v_mfma_f32_16x16x32_bf16 v[124:127], v[108:111], a[244:247], v[124:127]
    ds_write_b64 v231, v[210:211] offset:34816
    ds_read_b64_tr_b16 v[184:185], v233 offset:7680
    v_fma_f32 v222, v222, v204, v203
    v_fma_f32 v223, v223, v204, v203
    v_mfma_f32_16x16x32_bf16 v[128:131], v[104:107], a[232:235], v[128:131]
    v_mul_f32 v222, v148, v222
    v_mul_f32 v223, v149, v223
    v_mfma_f32_16x16x32_bf16 v[128:131], v[108:111], a[248:251], v[128:131]
    buffer_load_dwordx4 v[100:103], v2, s[24:27], s61 offen offset:1024
    v_mfma_f32_16x16x32_bf16 v[132:135], v[104:107], a[236:239], v[132:135]
    v_exp_f32_e64 v222, v222
    v_mfma_f32_16x16x32_bf16 v[132:135], v[108:111], a[252:255], v[132:135]
    s_waitcnt vmcnt(14)
    v_exp_f32 v223, v223
    v_fma_f32 v222, v222, v205, v205
    v_fma_f32 v223, v223, v205, v205
    v_mfma_f32_16x16x32_bf16 v[120:123], v[112:115], v[16:19], v[120:123]
    v_rcp_f32_e64 v222, v222
    v_mfma_f32_16x16x32_bf16 v[120:123], v[116:119], v[32:35], v[120:123]
    buffer_load_dwordx4 v[104:107], v2, s[24:27], s61 offen offset:2048
    v_rcp_f32_e64 v223, v223
    v_mfma_f32_16x16x32_bf16 v[124:127], v[112:115], v[20:23], v[124:127]
    v_mul_f32 v222, v148, v222
    v_mul_f32 v223, v149, v223
    v_mfma_f32_16x16x32_bf16 v[124:127], v[116:119], v[36:39], v[124:127]
    v_cvt_pk_bf16_f32 v212, v222, v223
    v_mul_f32 v224, v150, v150
    v_mul_f32 v225, v151, v151
    v_mfma_f32_16x16x32_bf16 v[128:131], v[112:115], v[24:27], v[128:131]
    v_fma_f32 v224, v224, v204, v203
    v_fma_f32 v225, v225, v204, v203
    v_mfma_f32_16x16x32_bf16 v[128:131], v[116:119], v[40:43], v[128:131]
    buffer_load_dwordx4 v[108:111], v2, s[24:27], s61 offen offset:3072
    v_mfma_f32_16x16x32_bf16 v[132:135], v[112:115], v[28:31], v[132:135]
    v_mul_f32 v224, v150, v224
    v_mul_f32 v225, v151, v225
    v_mfma_f32_16x16x32_bf16 v[132:135], v[116:119], v[44:47], v[132:135]
    s_waitcnt lgkmcnt(0)
    v_exp_f32 v224, v224
    v_exp_f32_e64 v225, v225
    v_mfma_f32_16x16x16_bf16 v[120:123], v[184:185], v[186:187], v[120:123]
    v_fma_f32 v224, v224, v205, v205
    v_fma_f32 v225, v225, v205, v205
    v_mfma_f32_16x16x16_bf16 v[124:127], v[184:185], v[188:189], v[124:127]
    v_rcp_f32_e64 v224, v224
    v_mfma_f32_16x16x16_bf16 v[128:131], v[184:185], v[190:191], v[128:131]
    v_rcp_f32_e64 v225, v225
    v_mfma_f32_16x16x16_bf16 v[132:135], v[184:185], v[192:193], v[132:135]
    s_waitcnt vmcnt(14)
    v_mul_f32 v224, v150, v224
    v_mul_f32_e64 v225, v151, v225
    v_cvt_pk_bf16_f32 v213, v224, v225
    v_mfma_f32_16x16x32_bf16 v[136:139], v[48:51], a[0:3], 0
    v_mul_f32 v222, v214, v214
    v_mul_f32 v223, v215, v215
    v_mfma_f32_16x16x32_bf16 v[136:139], v[52:55], a[16:19], v[136:139]
    ds_write_b64 v231, v[212:213] offset:35840
    s_add_u32 s61, s59, 145408
    buffer_load_dwordx4 v[112:115], v2, s[24:27], s61 offen offset:0
    v_mfma_f32_16x16x32_bf16 v[140:143], v[48:51], a[4:7], 0
    v_fma_f32 v222, v222, v195, v194
    v_fma_f32 v223, v223, v195, v194
    v_mfma_f32_16x16x32_bf16 v[140:143], v[52:55], a[20:23], v[140:143]
    buffer_load_dwordx4 v[152:155], v8, s[24:27], s54 offen offset:1024 sc1
    v_mul_f32 v222, v214, v222
    v_mul_f32 v223, v215, v223
    v_mfma_f32_16x16x32_bf16 v[144:147], v[48:51], a[8:11], 0
    v_exp_f32_e64 v222, v222
    v_mfma_f32_16x16x32_bf16 v[144:147], v[52:55], a[24:27], v[144:147]
    buffer_load_dwordx4 v[116:119], v2, s[24:27], s61 offen offset:1024
    v_mfma_f32_16x16x32_bf16 v[148:151], v[48:51], a[12:15], 0
    v_exp_f32_e64 v223, v223
    v_mfma_f32_16x16x32_bf16 v[148:151], v[52:55], a[28:31], v[148:151]
    s_waitcnt vmcnt(15)
    v_fma_f32 v222, v222, v196, v196
    v_fma_f32 v223, v223, v196, v196
    v_rcp_f32 v222, v222
    v_mfma_f32_16x16x32_bf16 v[136:139], v[56:59], a[32:35], v[136:139]
    v_rcp_f32_e64 v223, v223
    v_mfma_f32_16x16x32_bf16 v[136:139], v[60:63], a[48:51], v[136:139]
    buffer_load_dwordx4 v[48:51], v2, s[24:27], s61 offen offset:2048
    v_mul_f32 v222, v214, v222
    v_mul_f32 v223, v215, v223
    v_mfma_f32_16x16x32_bf16 v[140:143], v[56:59], a[36:39], v[140:143]
    v_mul_f32 v224, v216, v216
    v_mul_f32 v225, v217, v217
    v_mfma_f32_16x16x32_bf16 v[140:143], v[60:63], a[52:55], v[140:143]
    v_cvt_pk_bf16_f32 v206, v222, v223
    v_fma_f32 v224, v224, v195, v194
    v_fma_f32 v225, v225, v195, v194
    v_mfma_f32_16x16x32_bf16 v[144:147], v[56:59], a[40:43], v[144:147]
    v_mul_f32 v224, v216, v224
    v_mul_f32 v225, v217, v225
    v_mfma_f32_16x16x32_bf16 v[144:147], v[60:63], a[56:59], v[144:147]
    buffer_load_dwordx4 v[52:55], v2, s[24:27], s61 offen offset:3072
    v_mfma_f32_16x16x32_bf16 v[148:151], v[56:59], a[44:47], v[148:151]
    v_exp_f32_e64 v224, v224
    v_mfma_f32_16x16x32_bf16 v[148:151], v[60:63], a[60:63], v[148:151]
    s_waitcnt vmcnt(15)
    v_exp_f32 v225, v225
    v_fma_f32 v224, v224, v196, v196
    v_fma_f32 v225, v225, v196, v196
    v_mfma_f32_16x16x32_bf16 v[136:139], v[64:67], a[64:67], v[136:139]
    v_rcp_f32_e64 v224, v224
    v_mfma_f32_16x16x32_bf16 v[136:139], v[68:71], a[80:83], v[136:139]
    s_add_u32 s61, s59, 149504
    buffer_load_dwordx4 v[56:59], v2, s[24:27], s61 offen offset:0
    v_mfma_f32_16x16x32_bf16 v[140:143], v[64:67], a[68:71], v[140:143]
    v_rcp_f32_e64 v225, v225
    v_mfma_f32_16x16x32_bf16 v[140:143], v[68:71], a[84:87], v[140:143]
    v_mul_f32 v224, v216, v224
    v_mul_f32 v225, v217, v225
    v_cvt_pk_bf16_f32 v207, v224, v225
    v_mfma_f32_16x16x32_bf16 v[144:147], v[64:67], a[72:75], v[144:147]
    v_mul_f32 v222, v218, v218
    v_mul_f32 v223, v219, v219
    v_mfma_f32_16x16x32_bf16 v[144:147], v[68:71], a[88:91], v[144:147]
    ds_write_b64 v232, v[206:207] offset:0
    buffer_load_dwordx4 v[60:63], v2, s[24:27], s61 offen offset:1024
    v_mfma_f32_16x16x32_bf16 v[148:151], v[64:67], a[76:79], v[148:151]
    v_fma_f32 v222, v222, v198, v197
    v_fma_f32 v223, v223, v198, v197
    v_mfma_f32_16x16x32_bf16 v[148:151], v[68:71], a[92:95], v[148:151]
    s_waitcnt vmcnt(15)
    v_mul_f32 v222, v218, v222
    v_mul_f32 v223, v219, v223
    v_exp_f32 v222, v222
    v_mfma_f32_16x16x32_bf16 v[136:139], v[72:75], a[96:99], v[136:139]
    v_exp_f32_e64 v223, v223
    v_mfma_f32_16x16x32_bf16 v[136:139], v[76:79], a[112:115], v[136:139]
    buffer_load_dwordx4 v[64:67], v2, s[24:27], s61 offen offset:2048
    v_fma_f32 v222, v222, v199, v199
    v_fma_f32 v223, v223, v199, v199
    v_mfma_f32_16x16x32_bf16 v[140:143], v[72:75], a[100:103], v[140:143]
    v_rcp_f32_e64 v222, v222
    v_mfma_f32_16x16x32_bf16 v[140:143], v[76:79], a[116:119], v[140:143]
    v_rcp_f32_e64 v223, v223
    v_mfma_f32_16x16x32_bf16 v[144:147], v[72:75], a[104:107], v[144:147]
    v_mul_f32 v222, v218, v222
    v_mul_f32 v223, v219, v223
    v_mfma_f32_16x16x32_bf16 v[144:147], v[76:79], a[120:123], v[144:147]
    buffer_load_dwordx4 v[68:71], v2, s[24:27], s61 offen offset:3072
    v_cvt_pk_bf16_f32 v208, v222, v223
    v_mfma_f32_16x16x32_bf16 v[148:151], v[72:75], a[108:111], v[148:151]
    v_mul_f32 v224, v220, v220
    v_mul_f32 v225, v221, v221
    v_mfma_f32_16x16x32_bf16 v[148:151], v[76:79], a[124:127], v[148:151]
    s_waitcnt vmcnt(15)
    v_fma_f32 v224, v224, v198, v197
    v_fma_f32 v225, v225, v198, v197
    v_mul_f32 v224, v220, v224
    v_mul_f32_e64 v225, v221, v225
    v_mfma_f32_16x16x32_bf16 v[136:139], v[80:83], a[128:131], v[136:139]
    v_exp_f32_e64 v224, v224
    v_mfma_f32_16x16x32_bf16 v[136:139], v[84:87], a[144:147], v[136:139]
    s_add_u32 s61, s59, 153600
    buffer_load_dwordx4 v[72:75], v2, s[24:27], s61 offen offset:0
    v_mfma_f32_16x16x32_bf16 v[140:143], v[80:83], a[132:135], v[140:143]
    v_exp_f32_e64 v225, v225
    v_mfma_f32_16x16x32_bf16 v[140:143], v[84:87], a[148:151], v[140:143]
    v_fma_f32 v224, v224, v199, v199
    v_fma_f32 v225, v225, v199, v199
    v_rcp_f32_e64 v224, v224
    v_mfma_f32_16x16x32_bf16 v[144:147], v[80:83], a[136:139], v[144:147]
    v_rcp_f32_e64 v225, v225
    v_mfma_f32_16x16x32_bf16 v[144:147], v[84:87], a[152:155], v[144:147]
    buffer_load_dwordx4 v[76:79], v2, s[24:27], s61 offen offset:1024
    v_mul_f32 v224, v220, v224
    v_mul_f32 v225, v221, v225
    v_mfma_f32_16x16x32_bf16 v[148:151], v[80:83], a[140:143], v[148:151]
    v_cvt_pk_bf16_f32 v209, v224, v225
    v_mfma_f32_16x16x32_bf16 v[148:151], v[84:87], a[156:159], v[148:151]
    s_waitcnt vmcnt(15)
    ds_write_b64 v232, v[208:209] offset:1024
    v_mul_f32 v222, v244, v244
    v_mul_f32_e64 v223, v245, v245
    v_mfma_f32_16x16x32_bf16 v[136:139], v[88:91], a[160:163], v[136:139]
    v_fma_f32 v222, v222, v201, v200
    v_fma_f32 v223, v223, v201, v200
    v_mfma_f32_16x16x32_bf16 v[136:139], v[92:95], a[176:179], v[136:139]
    buffer_load_dwordx4 v[80:83], v2, s[24:27], s61 offen offset:2048
    v_mul_f32 v222, v244, v222
    v_mul_f32 v223, v245, v223
    v_mfma_f32_16x16x32_bf16 v[140:143], v[88:91], a[164:167], v[140:143]
    v_exp_f32_e64 v222, v222
    v_mfma_f32_16x16x32_bf16 v[140:143], v[92:95], a[180:183], v[140:143]
    v_exp_f32_e64 v223, v223
    v_mfma_f32_16x16x32_bf16 v[144:147], v[88:91], a[168:171], v[144:147]
    v_fma_f32 v222, v222, v202, v202
    v_fma_f32 v223, v223, v202, v202
    v_mfma_f32_16x16x32_bf16 v[144:147], v[92:95], a[184:187], v[144:147]
    buffer_load_dwordx4 v[84:87], v2, s[24:27], s61 offen offset:3072
    v_rcp_f32_e64 v222, v222
    v_mfma_f32_16x16x32_bf16 v[148:151], v[88:91], a[172:175], v[148:151]
L_pg7:
    s_cbranch_execz L_pg11
    v_rcp_f32 v223, v223
    v_mfma_f32_16x16x32_bf16 v[148:151], v[92:95], a[188:191], v[148:151]
    s_waitcnt vmcnt(15)
    v_mul_f32 v222, v244, v222
    v_mul_f32_e64 v223, v245, v223
    v_cvt_pk_bf16_f32 v210, v222, v223
    v_mfma_f32_16x16x32_bf16 v[136:139], v[96:99], a[192:195], v[136:139]
    v_mul_f32 v224, v246, v246
    v_mul_f32 v225, v247, v247
    v_mfma_f32_16x16x32_bf16 v[136:139], v[100:103], a[208:211], v[136:139]
    s_add_u32 s61, s59, 157696
    buffer_load_dwordx4 v[88:91], v2, s[24:27], s61 offen offset:0
    v_mfma_f32_16x16x32_bf16 v[140:143], v[96:99], a[196:199], v[140:143]
    v_fma_f32 v224, v224, v201, v200
    v_fma_f32 v225, v225, v201, v200
    v_mfma_f32_16x16x32_bf16 v[140:143], v[100:103], a[212:215], v[140:143]
    v_mul_f32 v224, v246, v224
    v_mul_f32 v225, v247, v225
    v_exp_f32_e64 v224, v224
    v_mfma_f32_16x16x32_bf16 v[144:147], v[96:99], a[200:203], v[144:147]
    v_exp_f32_e64 v225, v225
    v_mfma_f32_16x16x32_bf16 v[144:147], v[100:103], a[216:219], v[144:147]
    buffer_load_dwordx4 v[92:95], v2, s[24:27], s61 offen offset:1024
    v_fma_f32 v224, v224, v202, v202
    v_fma_f32 v225, v225, v202, v202
    v_mfma_f32_16x16x32_bf16 v[148:151], v[96:99], a[204:207], v[148:151]
    v_rcp_f32_e64 v224, v224
    v_mfma_f32_16x16x32_bf16 v[148:151], v[100:103], a[220:223], v[148:151]
    s_waitcnt vmcnt(15)
    v_rcp_f32 v225, v225
    v_mfma_f32_16x16x32_bf16 v[136:139], v[104:107], a[224:227], v[136:139]
    v_mul_f32 v224, v246, v224
    v_mul_f32 v225, v247, v225
    v_mfma_f32_16x16x32_bf16 v[136:139], v[108:111], a[240:243], v[136:139]
    buffer_load_dwordx4 v[96:99], v2, s[24:27], s61 offen offset:2048
    v_cvt_pk_bf16_f32 v211, v224, v225
    v_mfma_f32_16x16x32_bf16 v[140:143], v[104:107], a[228:231], v[140:143]
    v_mul_f32 v222, v248, v248
    v_mul_f32 v223, v249, v249
    v_mfma_f32_16x16x32_bf16 v[140:143], v[108:111], a[244:247], v[140:143]
    ds_write_b64 v232, v[210:211] offset:2048
    ds_read_b64_tr_b16 v[184:185], v233 offset:8960
    v_fma_f32 v222, v222, v204, v203
    v_fma_f32 v223, v223, v204, v203
    v_mfma_f32_16x16x32_bf16 v[144:147], v[104:107], a[232:235], v[144:147]
    v_mul_f32 v222, v248, v222
    v_mul_f32 v223, v249, v223
    v_mfma_f32_16x16x32_bf16 v[144:147], v[108:111], a[248:251], v[144:147]
    buffer_load_dwordx4 v[100:103], v2, s[24:27], s61 offen offset:3072
    v_mfma_f32_16x16x32_bf16 v[148:151], v[104:107], a[236:239], v[148:151]
    v_exp_f32_e64 v222, v222
    v_mfma_f32_16x16x32_bf16 v[148:151], v[108:111], a[252:255], v[148:151]
    s_waitcnt vmcnt(14)
    v_exp_f32 v223, v223
    v_fma_f32 v222, v222, v205, v205
    v_fma_f32 v223, v223, v205, v205
    v_mfma_f32_16x16x32_bf16 v[136:139], v[112:115], v[16:19], v[136:139]
    v_rcp_f32_e64 v222, v222
    v_mfma_f32_16x16x32_bf16 v[136:139], v[116:119], v[32:35], v[136:139]
    s_add_u32 s61, s59, 161792
    buffer_load_dwordx4 v[104:107], v2, s[24:27], s61 offen offset:0
    v_mfma_f32_16x16x32_bf16 v[140:143], v[112:115], v[20:23], v[140:143]
    v_rcp_f32_e64 v223, v223
    v_mfma_f32_16x16x32_bf16 v[140:143], v[116:119], v[36:39], v[140:143]
    v_mul_f32 v222, v248, v222
    v_mul_f32 v223, v249, v223
    v_cvt_pk_bf16_f32 v212, v222, v223
    v_mfma_f32_16x16x32_bf16 v[144:147], v[112:115], v[24:27], v[144:147]
    v_mul_f32 v224, v250, v250
    v_mul_f32 v225, v251, v251
    v_mfma_f32_16x16x32_bf16 v[144:147], v[116:119], v[40:43], v[144:147]
    buffer_load_dwordx4 v[108:111], v2, s[24:27], s61 offen offset:1024
    v_fma_f32 v224, v224, v204, v203
    v_fma_f32 v225, v225, v204, v203
    v_mfma_f32_16x16x32_bf16 v[148:151], v[112:115], v[28:31], v[148:151]
    v_mul_f32 v224, v250, v224
    v_mul_f32 v225, v251, v225
    v_mfma_f32_16x16x32_bf16 v[148:151], v[116:119], v[44:47], v[148:151]
    s_waitcnt lgkmcnt(0)
    v_exp_f32 v224, v224
    v_exp_f32_e64 v225, v225
    v_mfma_f32_16x16x16_bf16 v[136:139], v[184:185], v[186:187], v[136:139]
    v_fma_f32 v224, v224, v205, v205
    v_fma_f32 v225, v225, v205, v205
    v_mfma_f32_16x16x16_bf16 v[140:143], v[184:185], v[188:189], v[140:143]
    v_rcp_f32_e64 v224, v224
    v_mfma_f32_16x16x16_bf16 v[144:147], v[184:185], v[190:191], v[144:147]
    v_rcp_f32_e64 v225, v225
    v_mfma_f32_16x16x16_bf16 v[148:151], v[184:185], v[192:193], v[148:151]
    s_waitcnt vmcnt(14)
    v_mul_f32 v224, v250, v224
    v_mul_f32_e64 v225, v251, v225
    v_cvt_pk_bf16_f32 v213, v224, v225
    v_mfma_f32_16x16x32_bf16 v[214:217], v[48:51], a[0:3], 0
    v_mul_f32 v222, v120, v120
    v_mul_f32 v223, v121, v121
    v_mfma_f32_16x16x32_bf16 v[214:217], v[52:55], a[16:19], v[214:217]
    ds_write_b64 v232, v[212:213] offset:3072
    buffer_load_dwordx4 v[112:115], v2, s[24:27], s61 offen offset:2048
    v_fma_f32 v222, v222, v195, v194
    v_fma_f32 v223, v223, v195, v194
    v_mfma_f32_16x16x32_bf16 v[218:221], v[48:51], a[4:7], 0
    v_mul_f32 v222, v120, v222
    v_mul_f32 v223, v121, v223
    v_mfma_f32_16x16x32_bf16 v[218:221], v[52:55], a[20:23], v[218:221]
    v_exp_f32_e64 v222, v222
    v_mfma_f32_16x16x32_bf16 v[244:247], v[48:51], a[8:11], 0
    v_exp_f32_e64 v223, v223
    v_mfma_f32_16x16x32_bf16 v[244:247], v[52:55], a[24:27], v[244:247]
    buffer_load_dwordx4 v[116:119], v2, s[24:27], s61 offen offset:3072
    v_fma_f32 v222, v222, v196, v196
    v_fma_f32 v223, v223, v196, v196
    v_mfma_f32_16x16x32_bf16 v[248:251], v[48:51], a[12:15], 0
    v_rcp_f32_e64 v222, v222
    v_mfma_f32_16x16x32_bf16 v[248:251], v[52:55], a[28:31], v[248:251]
    s_waitcnt vmcnt(14)
    s_mov_b32 s49, 0
    s_cmp_eq_u32 s46, 3
    s_cbranch_scc0 L_sf2ok
L_sf2:
    v_min3_u32 v152, v152, v153, v154
    v_min_u32_e64 v152, v152, v155
    v_cmp_gt_u32 vcc, 1, v152
    s_cbranch_vccz L_sf2ok
    buffer_load_dwordx4 v[152:155], v8, s[24:27], s54 offen offset:1024 sc1
    s_add_u32 s49, s49, 1
    s_cmp_lt_u32 s49, 262144
    s_waitcnt vmcnt(0)
    s_cbranch_scc1 L_sf2
L_sf2ok:
    s_waitcnt lgkmcnt(0)
    s_barrier
    v_mfma_f32_16x16x32_bf16 v[214:217], v[56:59], a[32:35], v[214:217]
    v_rcp_f32 v223, v223
    v_mfma_f32_16x16x32_bf16 v[214:217], v[60:63], a[48:51], v[214:217]
    s_add_u32 s61, s59, 165888
    buffer_load_dwordx4 v[48:51], v2, s[24:27], s61 offen offset:0
    v_mul_f32 v222, v120, v222
    v_mul_f32 v223, v121, v223
    v_mfma_f32_16x16x32_bf16 v[218:221], v[56:59], a[36:39], v[218:221]
    v_mul_f32 v224, v122, v122
    v_mul_f32 v225, v123, v123
    v_mfma_f32_16x16x32_bf16 v[218:221], v[60:63], a[52:55], v[218:221]
    v_cvt_pk_bf16_f32 v206, v222, v223
    v_fma_f32 v224, v224, v195, v194
    v_fma_f32 v225, v225, v195, v194
    v_mfma_f32_16x16x32_bf16 v[244:247], v[56:59], a[40:43], v[244:247]
    v_mul_f32 v224, v122, v224
    v_mul_f32 v225, v123, v225
    v_mfma_f32_16x16x32_bf16 v[244:247], v[60:63], a[56:59], v[244:247]
    buffer_load_dwordx4 v[52:55], v2, s[24:27], s61 offen offset:1024
    v_exp_f32_e64 v224, v224
    v_mfma_f32_16x16x32_bf16 v[248:251], v[56:59], a[44:47], v[248:251]
    v_exp_f32_e64 v225, v225
    v_mfma_f32_16x16x32_bf16 v[248:251], v[60:63], a[60:63], v[248:251]
    s_waitcnt vmcnt(14)
    v_fma_f32 v224, v224, v196, v196
    v_fma_f32 v225, v225, v196, v196
    v_rcp_f32 v224, v224
    v_mfma_f32_16x16x32_bf16 v[214:217], v[64:67], a[64:67], v[214:217]
    v_rcp_f32_e64 v225, v225
    v_mfma_f32_16x16x32_bf16 v[214:217], v[68:71], a[80:83], v[214:217]
    s_add_u32 s61, s59, 184320
    buffer_load_dwordx4 v[56:59], v2, s[24:27], s61 offen offset:0
    v_mfma_f32_16x16x32_bf16 v[218:221], v[64:67], a[68:71], v[218:221]
    v_mul_f32 v224, v122, v224
    v_mul_f32 v225, v123, v225
    v_mfma_f32_16x16x32_bf16 v[218:221], v[68:71], a[84:87], v[218:221]
    v_cvt_pk_bf16_f32 v207, v224, v225
    v_mul_f32 v222, v124, v124
    v_mul_f32 v223, v125, v125
    v_fma_f32 v222, v222, v198, v197
    v_fma_f32 v223, v223, v198, v197
    v_mfma_f32_16x16x32_bf16 v[244:247], v[64:67], a[72:75], v[244:247]
    v_mul_f32 v222, v124, v222
    v_mul_f32 v223, v125, v223
    v_mfma_f32_16x16x32_bf16 v[244:247], v[68:71], a[88:91], v[244:247]
    ds_write_b64 v232, v[206:207] offset:8192
    buffer_load_dwordx4 v[60:63], v2, s[24:27], s61 offen offset:1024
    v_mfma_f32_16x16x32_bf16 v[248:251], v[64:67], a[76:79], v[248:251]
    v_exp_f32_e64 v222, v222
    v_mfma_f32_16x16x32_bf16 v[248:251], v[68:71], a[92:95], v[248:251]
    s_waitcnt vmcnt(14)
    v_exp_f32 v223, v223
    v_fma_f32 v222, v222, v199, v199
    v_fma_f32 v223, v223, v199, v199
    v_mfma_f32_16x16x32_bf16 v[214:217], v[72:75], a[96:99], v[214:217]
    v_rcp_f32_e64 v222, v222
    v_mfma_f32_16x16x32_bf16 v[214:217], v[76:79], a[112:115], v[214:217]
    s_add_u32 s61, s59, 202752
    buffer_load_dwordx4 v[64:67], v2, s[24:27], s61 offen offset:0
    v_rcp_f32_e64 v223, v223
    v_mfma_f32_16x16x32_bf16 v[218:221], v[72:75], a[100:103], v[218:221]
    v_mul_f32 v222, v124, v222
    v_mul_f32 v223, v125, v223
    v_mfma_f32_16x16x32_bf16 v[218:221], v[76:79], a[116:119], v[218:221]
    v_cvt_pk_bf16_f32 v208, v222, v223
    v_mul_f32 v224, v126, v126
    v_mul_f32 v225, v127, v127
    v_mfma_f32_16x16x32_bf16 v[244:247], v[72:75], a[104:107], v[244:247]
    v_fma_f32 v224, v224, v198, v197
    v_fma_f32 v225, v225, v198, v197
    v_mfma_f32_16x16x32_bf16 v[244:247], v[76:79], a[120:123], v[244:247]
    buffer_load_dwordx4 v[68:71], v2, s[24:27], s61 offen offset:1024
    v_mul_f32 v224, v126, v224
    v_mul_f32 v225, v127, v225
    v_mfma_f32_16x16x32_bf16 v[248:251], v[72:75], a[108:111], v[248:251]
    v_exp_f32_e64 v224, v224
    v_mfma_f32_16x16x32_bf16 v[248:251], v[76:79], a[124:127], v[248:251]
    s_waitcnt vmcnt(14)
    v_exp_f32 v225, v225
    v_fma_f32 v224, v224, v199, v199
    v_fma_f32 v225, v225, v199, v199
    v_mfma_f32_16x16x32_bf16 v[214:217], v[80:83], a[128:131], v[214:217]
    v_rcp_f32_e64 v224, v224
    v_mfma_f32_16x16x32_bf16 v[214:217], v[84:87], a[144:147], v[214:217]
    s_add_u32 s61, s59, 167936
    buffer_load_dwordx4 v[72:75], v2, s[24:27], s61 offen offset:0
    v_mfma_f32_16x16x32_bf16 v[218:221], v[80:83], a[132:135], v[218:221]
    v_rcp_f32_e64 v225, v225
    v_mfma_f32_16x16x32_bf16 v[218:221], v[84:87], a[148:151], v[218:221]
    v_mul_f32 v224, v126, v224
    v_mul_f32 v225, v127, v225
    v_cvt_pk_bf16_f32 v209, v224, v225
    v_mul_f32 v222, v128, v128
    v_mul_f32 v223, v129, v129
    v_mfma_f32_16x16x32_bf16 v[244:247], v[80:83], a[136:139], v[244:247]
    v_fma_f32 v222, v222, v201, v200
    v_fma_f32 v223, v223, v201, v200
    v_mfma_f32_16x16x32_bf16 v[244:247], v[84:87], a[152:155], v[244:247]
    ds_write_b64 v232, v[208:209] offset:9216
    buffer_load_dwordx4 v[76:79], v2, s[24:27], s61 offen offset:1024
    v_mfma_f32_16x16x32_bf16 v[248:251], v[80:83], a[140:143], v[248:251]
    v_mul_f32 v222, v128, v222
    v_mul_f32 v223, v129, v223
    v_mfma_f32_16x16x32_bf16 v[248:251], v[84:87], a[156:159], v[248:251]
    s_waitcnt vmcnt(14)
    v_exp_f32 v222, v222
    v_exp_f32_e64 v223, v223
    v_mfma_f32_16x16x32_bf16 v[214:217], v[88:91], a[160:163], v[214:217]
    v_fma_f32 v222, v222, v202, v202
    v_fma_f32 v223, v223, v202, v202
    v_mfma_f32_16x16x32_bf16 v[214:217], v[92:95], a[176:179], v[214:217]
    s_add_u32 s61, s59, 186368
    buffer_load_dwordx4 v[80:83], v2, s[24:27], s61 offen offset:0
    v_rcp_f32_e64 v222, v222
    v_mfma_f32_16x16x32_bf16 v[218:221], v[88:91], a[164:167], v[218:221]
    ds_read_b128 a[0:3], v2 offset:0
    v_mfma_f32_16x16x32_bf16 v[218:221], v[92:95], a[180:183], v[218:221]
    v_rcp_f32 v223, v223
    v_mul_f32 v222, v128, v222
    v_mul_f32_e64 v223, v129, v223
    v_mfma_f32_16x16x32_bf16 v[244:247], v[88:91], a[168:171], v[244:247]
    ds_read_b128 a[16:19], v2 offset:4096
    v_cvt_pk_bf16_f32 v210, v222, v223
    v_mfma_f32_16x16x32_bf16 v[244:247], v[92:95], a[184:187], v[244:247]
    buffer_load_dwordx4 v[84:87], v2, s[24:27], s61 offen offset:1024
    v_mul_f32 v224, v130, v130
    v_mul_f32 v225, v131, v131
    v_mfma_f32_16x16x32_bf16 v[248:251], v[88:91], a[172:175], v[248:251]
    ds_read_b128 a[4:7], v2 offset:1024
    v_mfma_f32_16x16x32_bf16 v[248:251], v[92:95], a[188:191], v[248:251]
    s_waitcnt vmcnt(14)
    v_fma_f32 v224, v224, v201, v200
    v_fma_f32 v225, v225, v201, v200
    v_mul_f32 v224, v130, v224
    v_mul_f32_e64 v225, v131, v225
    v_mfma_f32_16x16x32_bf16 v[214:217], v[96:99], a[192:195], v[214:217]
    ds_read_b128 a[20:23], v2 offset:5120
    v_mfma_f32_16x16x32_bf16 v[214:217], v[100:103], a[208:211], v[214:217]
    s_add_u32 s61, s59, 204800
    buffer_load_dwordx4 v[88:91], v2, s[24:27], s61 offen offset:0
    v_exp_f32_e64 v224, v224
    v_mfma_f32_16x16x32_bf16 v[218:221], v[96:99], a[196:199], v[218:221]
    ds_read_b128 a[8:11], v2 offset:2048
    v_mfma_f32_16x16x32_bf16 v[218:221], v[100:103], a[212:215], v[218:221]
    v_exp_f32_e64 v225, v225
    v_fma_f32 v224, v224, v202, v202
    v_fma_f32 v225, v225, v202, v202
    v_rcp_f32_e64 v224, v224
    v_mfma_f32_16x16x32_bf16 v[244:247], v[96:99], a[200:203], v[244:247]
    ds_read_b128 a[24:27], v2 offset:6144
    v_mfma_f32_16x16x32_bf16 v[244:247], v[100:103], a[216:219], v[244:247]
    buffer_load_dwordx4 v[92:95], v2, s[24:27], s61 offen offset:1024
    v_rcp_f32_e64 v225, v225
    v_mfma_f32_16x16x32_bf16 v[248:251], v[96:99], a[204:207], v[248:251]
    ds_read_b128 a[12:15], v2 offset:3072
    v_mfma_f32_16x16x32_bf16 v[248:251], v[100:103], a[220:223], v[248:251]
    s_waitcnt vmcnt(14)
    v_mul_f32 v224, v130, v224
    v_mul_f32_e64 v225, v131, v225
    v_cvt_pk_bf16_f32 v211, v224, v225
    v_mul_f32 v222, v132, v132
    v_mul_f32 v223, v133, v133
    v_mfma_f32_16x16x32_bf16 v[214:217], v[104:107], a[224:227], v[214:217]
    ds_read_b128 a[28:31], v2 offset:7168
    v_mfma_f32_16x16x32_bf16 v[214:217], v[108:111], a[240:243], v[214:217]
    ds_write_b64 v232, v[210:211] offset:10240
    s_add_u32 s61, s59, 169984
    buffer_load_dwordx4 v[96:99], v2, s[24:27], s61 offen offset:0
    v_fma_f32 v222, v222, v204, v203
    v_fma_f32 v223, v223, v204, v203
    v_mfma_f32_16x16x32_bf16 v[218:221], v[104:107], a[228:231], v[218:221]
    ds_read_b128 a[32:35], v2 offset:8192
    v_mfma_f32_16x16x32_bf16 v[218:221], v[108:111], a[244:247], v[218:221]
    ds_read_b64_tr_b16 v[184:185], v233 offset:10240
    v_mul_f32 v222, v132, v222
    v_mul_f32 v223, v133, v223
    v_mfma_f32_16x16x32_bf16 v[244:247], v[104:107], a[232:235], v[244:247]
    ds_read_b128 a[48:51], v2 offset:12288
    v_mfma_f32_16x16x32_bf16 v[244:247], v[108:111], a[248:251], v[244:247]
    buffer_load_dwordx4 v[100:103], v2, s[24:27], s61 offen offset:1024
    v_exp_f32 v222, v222
    v_exp_f32 v223, v223
    v_mfma_f32_16x16x32_bf16 v[248:251], v[104:107], a[236:239], v[248:251]
    ds_read_b128 a[36:39], v2 offset:9216
    v_mfma_f32_16x16x32_bf16 v[248:251], v[108:111], a[252:255], v[248:251]
    s_waitcnt vmcnt(14)
    v_fma_f32 v222, v222, v205, v205
    v_fma_f32 v223, v223, v205, v205
    v_rcp_f32 v222, v222
    v_mfma_f32_16x16x32_bf16 v[214:217], v[112:115], v[16:19], v[214:217]
    ds_read_b128 a[52:55], v2 offset:13312
    v_mfma_f32_16x16x32_bf16 v[214:217], v[116:119], v[32:35], v[214:217]
    s_add_u32 s61, s59, 188416
    buffer_load_dwordx4 v[104:107], v2, s[24:27], s61 offen offset:0
    v_rcp_f32_e64 v223, v223
    v_mfma_f32_16x16x32_bf16 v[218:221], v[112:115], v[20:23], v[218:221]
    ds_read_b128 a[40:43], v2 offset:10240
    v_mfma_f32_16x16x32_bf16 v[218:221], v[116:119], v[36:39], v[218:221]
    v_mul_f32 v222, v132, v222
    v_mul_f32 v223, v133, v223
    v_cvt_pk_bf16_f32 v212, v222, v223
    v_mul_f32 v224, v134, v134
    v_mul_f32 v225, v135, v135
    v_mfma_f32_16x16x32_bf16 v[244:247], v[112:115], v[24:27], v[244:247]
    ds_read_b128 a[56:59], v2 offset:14336
    v_mfma_f32_16x16x32_bf16 v[244:247], v[116:119], v[40:43], v[244:247]
    buffer_load_dwordx4 v[108:111], v2, s[24:27], s61 offen offset:1024
    v_fma_f32 v224, v224, v204, v203
    v_fma_f32 v225, v225, v204, v203
    v_mfma_f32_16x16x32_bf16 v[248:251], v[112:115], v[28:31], v[248:251]
    ds_read_b128 a[44:47], v2 offset:11264
    v_mfma_f32_16x16x32_bf16 v[248:251], v[116:119], v[44:47], v[248:251]
    s_waitcnt lgkmcnt(6)
    v_mul_f32 v224, v134, v224
    v_mul_f32 v225, v135, v225
    v_exp_f32 v224, v224
    v_exp_f32_e64 v225, v225
    v_mfma_f32_16x16x16_bf16 v[214:217], v[184:185], v[186:187], v[214:217]
    ds_read_b128 a[60:63], v2 offset:15360
    v_fma_f32 v224, v224, v205, v205
    v_fma_f32 v225, v225, v205, v205
    v_mfma_f32_16x16x16_bf16 v[218:221], v[184:185], v[188:189], v[218:221]
    v_rcp_f32_e64 v224, v224
    v_mfma_f32_16x16x16_bf16 v[244:247], v[184:185], v[190:191], v[244:247]
    v_rcp_f32_e64 v225, v225
    v_mfma_f32_16x16x16_bf16 v[248:251], v[184:185], v[192:193], v[248:251]
    s_waitcnt vmcnt(14)
    v_mul_f32 v224, v134, v224
    v_mul_f32_e64 v225, v135, v225
    v_cvt_pk_bf16_f32 v213, v224, v225
    v_mfma_f32_16x16x32_bf16 v[120:123], v[48:51], a[0:3], 0
    v_mul_f32 v222, v136, v136
    v_mul_f32 v223, v137, v137
    v_mfma_f32_16x16x32_bf16 v[120:123], v[52:55], a[16:19], v[120:123]
    ds_write_b64 v232, v[212:213] offset:11264
    s_add_u32 s61, s59, 206848
    buffer_load_dwordx4 v[112:115], v2, s[24:27], s61 offen offset:0
    v_mfma_f32_16x16x32_bf16 v[124:127], v[48:51], a[4:7], 0
    v_fma_f32 v222, v222, v195, v194
    v_fma_f32 v223, v223, v195, v194
    v_mfma_f32_16x16x32_bf16 v[124:127], v[52:55], a[20:23], v[124:127]
    ds_read_b128 a[64:67], v2 offset:16384
    ds_read_b128 a[68:71], v2 offset:17408
    v_mul_f32 v222, v136, v222
    v_mul_f32 v223, v137, v223
    v_mfma_f32_16x16x32_bf16 v[128:131], v[48:51], a[8:11], 0
    v_exp_f32_e64 v222, v222
    v_mfma_f32_16x16x32_bf16 v[128:131], v[52:55], a[24:27], v[128:131]
    buffer_load_dwordx4 v[116:119], v2, s[24:27], s61 offen offset:1024
    v_exp_f32_e64 v223, v223
    v_mfma_f32_16x16x32_bf16 v[132:135], v[48:51], a[12:15], 0
    v_fma_f32 v222, v222, v196, v196
    v_fma_f32 v223, v223, v196, v196
    v_mfma_f32_16x16x32_bf16 v[132:135], v[52:55], a[28:31], v[132:135]
    s_waitcnt vmcnt(14)
    ds_read_b128 a[80:83], v2 offset:20480
    v_rcp_f32 v222, v222
    v_mfma_f32_16x16x32_bf16 v[152:155], v[56:59], a[0:3], 0
    v_rcp_f32_e64 v223, v223
    v_mfma_f32_16x16x32_bf16 v[152:155], v[60:63], a[16:19], v[152:155]
    s_add_u32 s61, s59, 172032
    buffer_load_dwordx4 v[48:51], v2, s[24:27], s61 offen offset:0
    v_mul_f32 v222, v136, v222
    v_mul_f32 v223, v137, v223
    v_mfma_f32_16x16x32_bf16 v[156:159], v[56:59], a[4:7], 0
    v_mul_f32 v224, v138, v138
    v_mul_f32 v225, v139, v139
    v_mfma_f32_16x16x32_bf16 v[156:159], v[60:63], a[20:23], v[156:159]
    ds_read_b128 a[84:87], v2 offset:21504
    v_cvt_pk_bf16_f32 v206, v222, v223
    v_fma_f32 v224, v224, v195, v194
    v_fma_f32 v225, v225, v195, v194
    v_mfma_f32_16x16x32_bf16 v[160:163], v[56:59], a[8:11], 0
    v_mul_f32 v224, v138, v224
    v_mul_f32 v225, v139, v225
    v_mfma_f32_16x16x32_bf16 v[160:163], v[60:63], a[24:27], v[160:163]
    buffer_load_dwordx4 v[52:55], v2, s[24:27], s61 offen offset:1024
    v_mfma_f32_16x16x32_bf16 v[164:167], v[56:59], a[12:15], 0
    v_exp_f32_e64 v224, v224
    v_mfma_f32_16x16x32_bf16 v[164:167], v[60:63], a[28:31], v[164:167]
    s_waitcnt vmcnt(14)
    ds_read_b128 a[72:75], v2 offset:18432
    v_exp_f32 v225, v225
    v_mfma_f32_16x16x32_bf16 v[168:171], v[64:67], a[0:3], 0
    v_fma_f32 v224, v224, v196, v196
    v_fma_f32 v225, v225, v196, v196
    v_mfma_f32_16x16x32_bf16 v[168:171], v[68:71], a[16:19], v[168:171]
    s_add_u32 s61, s59, 190464
    buffer_load_dwordx4 v[56:59], v2, s[24:27], s61 offen offset:0
    v_rcp_f32_e64 v224, v224
    v_mfma_f32_16x16x32_bf16 v[172:175], v[64:67], a[4:7], 0
    v_rcp_f32_e64 v225, v225
    v_mfma_f32_16x16x32_bf16 v[172:175], v[68:71], a[20:23], v[172:175]
    ds_read_b128 a[88:91], v2 offset:22528
    ds_read_b128 a[92:95], v2 offset:23552
    v_mul_f32 v224, v138, v224
    v_mul_f32 v225, v139, v225
    v_mfma_f32_16x16x32_bf16 v[176:179], v[64:67], a[8:11], 0
    v_cvt_pk_bf16_f32 v207, v224, v225
    v_mfma_f32_16x16x32_bf16 v[176:179], v[68:71], a[24:27], v[176:179]
    ds_write_b64 v232, v[206:207] offset:16384
    buffer_load_dwordx4 v[60:63], v2, s[24:27], s61 offen offset:1024
    v_mfma_f32_16x16x32_bf16 v[180:183], v[64:67], a[12:15], 0
    v_mul_f32 v222, v140, v140
    v_mul_f32 v223, v141, v141
    v_mfma_f32_16x16x32_bf16 v[180:183], v[68:71], a[28:31], v[180:183]
    s_waitcnt vmcnt(14)
    ds_read_b128 a[76:79], v2 offset:19456
    v_fma_f32 v222, v222, v198, v197
    v_fma_f32 v223, v223, v198, v197
    v_mfma_f32_16x16x32_bf16 v[120:123], v[72:75], a[32:35], v[120:123]
    s_waitcnt lgkmcnt(15)
    v_mul_f32 v222, v140, v222
    v_mul_f32 v223, v141, v223
    v_mfma_f32_16x16x32_bf16 v[120:123], v[76:79], a[48:51], v[120:123]
    s_add_u32 s61, s59, 208896
    buffer_load_dwordx4 v[64:67], v2, s[24:27], s61 offen offset:0
    v_exp_f32_e64 v222, v222
    v_mfma_f32_16x16x32_bf16 v[124:127], v[72:75], a[36:39], v[124:127]
    s_waitcnt lgkmcnt(14)
    v_exp_f32 v223, v223
    v_mfma_f32_16x16x32_bf16 v[124:127], v[76:79], a[52:55], v[124:127]
    s_waitcnt lgkmcnt(13)
    ds_read_b128 a[96:99], v2 offset:24576
    v_fma_f32 v222, v222, v199, v199
    v_fma_f32 v223, v223, v199, v199
    v_mfma_f32_16x16x32_bf16 v[128:131], v[72:75], a[40:43], v[128:131]
    s_waitcnt lgkmcnt(13)
    v_rcp_f32_e64 v222, v222
    v_mfma_f32_16x16x32_bf16 v[128:131], v[76:79], a[56:59], v[128:131]
    s_waitcnt lgkmcnt(12)
    buffer_load_dwordx4 v[68:71], v2, s[24:27], s61 offen offset:1024
    v_mfma_f32_16x16x32_bf16 v[132:135], v[72:75], a[44:47], v[132:135]
    s_waitcnt lgkmcnt(11)
    v_rcp_f32_e64 v223, v223
    v_mfma_f32_16x16x32_bf16 v[132:135], v[76:79], a[60:63], v[132:135]
    s_waitcnt vmcnt(14)
    ds_read_b128 a[112:115], v2 offset:28672
    v_mul_f32 v222, v140, v222
    v_mul_f32_e64 v223, v141, v223
    v_mfma_f32_16x16x32_bf16 v[152:155], v[80:83], a[32:35], v[152:155]
    v_mul_f32 v224, v142, v142
    v_mul_f32 v225, v143, v143
    v_mfma_f32_16x16x32_bf16 v[152:155], v[84:87], a[48:51], v[152:155]
    s_add_u32 s61, s59, 174080
    buffer_load_dwordx4 v[72:75], v2, s[24:27], s61 offen offset:0
    v_cvt_pk_bf16_f32 v208, v222, v223
    v_mfma_f32_16x16x32_bf16 v[156:159], v[80:83], a[36:39], v[156:159]
    v_fma_f32 v224, v224, v198, v197
    v_fma_f32 v225, v225, v198, v197
    v_mfma_f32_16x16x32_bf16 v[156:159], v[84:87], a[52:55], v[156:159]
    ds_read_b128 a[100:103], v2 offset:25600
    v_mul_f32 v224, v142, v224
    v_mul_f32 v225, v143, v225
    v_exp_f32_e64 v224, v224
    v_mfma_f32_16x16x32_bf16 v[160:163], v[80:83], a[40:43], v[160:163]
    v_exp_f32_e64 v225, v225
    v_mfma_f32_16x16x32_bf16 v[160:163], v[84:87], a[56:59], v[160:163]
    buffer_load_dwordx4 v[76:79], v2, s[24:27], s61 offen offset:1024
    v_mfma_f32_16x16x32_bf16 v[164:167], v[80:83], a[44:47], v[164:167]
    v_fma_f32 v224, v224, v199, v199
    v_fma_f32 v225, v225, v199, v199
    v_mfma_f32_16x16x32_bf16 v[164:167], v[84:87], a[60:63], v[164:167]
    s_waitcnt vmcnt(14)
    ds_read_b128 a[116:119], v2 offset:29696
    v_rcp_f32 v224, v224
    v_mfma_f32_16x16x32_bf16 v[168:171], v[88:91], a[32:35], v[168:171]
    v_rcp_f32_e64 v225, v225
    v_mfma_f32_16x16x32_bf16 v[168:171], v[92:95], a[48:51], v[168:171]
    s_add_u32 s61, s59, 192512
    buffer_load_dwordx4 v[80:83], v2, s[24:27], s61 offen offset:0
    v_mul_f32 v224, v142, v224
    v_mul_f32 v225, v143, v225
    v_mfma_f32_16x16x32_bf16 v[172:175], v[88:91], a[36:39], v[172:175]
    v_cvt_pk_bf16_f32 v209, v224, v225
    v_mfma_f32_16x16x32_bf16 v[172:175], v[92:95], a[52:55], v[172:175]
    ds_write_b64 v232, v[208:209] offset:17408
    ds_read_b128 a[104:107], v2 offset:26624
    ds_read_b128 a[108:111], v2 offset:27648
    v_mul_f32 v222, v144, v144
    v_mul_f32 v223, v145, v145
    v_mfma_f32_16x16x32_bf16 v[176:179], v[88:91], a[40:43], v[176:179]
    v_fma_f32 v222, v222, v201, v200
    v_fma_f32 v223, v223, v201, v200
    v_mfma_f32_16x16x32_bf16 v[176:179], v[92:95], a[56:59], v[176:179]
    buffer_load_dwordx4 v[84:87], v2, s[24:27], s61 offen offset:1024
    v_mfma_f32_16x16x32_bf16 v[180:183], v[88:91], a[44:47], v[180:183]
    v_mul_f32 v222, v144, v222
    v_mul_f32 v223, v145, v223
    v_mfma_f32_16x16x32_bf16 v[180:183], v[92:95], a[60:63], v[180:183]
    s_waitcnt vmcnt(14) lgkmcnt(15)
    ds_read_b128 a[120:123], v2 offset:30720
    v_exp_f32 v222, v222
    v_mfma_f32_16x16x32_bf16 v[120:123], v[96:99], a[64:67], v[120:123]
    s_waitcnt lgkmcnt(14)
    v_exp_f32 v223, v223
    v_mfma_f32_16x16x32_bf16 v[120:123], v[100:103], a[80:83], v[120:123]
    s_add_u32 s61, s59, 210944
    buffer_load_dwordx4 v[88:91], v2, s[24:27], s61 offen offset:0
    v_fma_f32 v222, v222, v202, v202
    v_fma_f32 v223, v223, v202, v202
    v_mfma_f32_16x16x32_bf16 v[124:127], v[96:99], a[68:71], v[124:127]
    s_waitcnt lgkmcnt(13)
    v_rcp_f32 v222, v222
    v_mfma_f32_16x16x32_bf16 v[124:127], v[100:103], a[84:87], v[124:127]
    s_waitcnt lgkmcnt(12)
    ds_read_b128 a[124:127], v2 offset:31744
    v_rcp_f32 v223, v223
    v_mfma_f32_16x16x32_bf16 v[128:131], v[96:99], a[72:75], v[128:131]
    s_waitcnt lgkmcnt(12)
    v_mul_f32 v222, v144, v222
    v_mul_f32_e64 v223, v145, v223
    v_mfma_f32_16x16x32_bf16 v[128:131], v[100:103], a[88:91], v[128:131]
    s_waitcnt lgkmcnt(9)
    buffer_load_dwordx4 v[92:95], v2, s[24:27], s61 offen offset:1024
    v_mfma_f32_16x16x32_bf16 v[132:135], v[96:99], a[76:79], v[132:135]
    v_mul_f32 v224, v146, v146
    v_mul_f32_e64 v225, v147, v147
    v_mfma_f32_16x16x32_bf16 v[132:135], v[100:103], a[92:95], v[132:135]
    s_waitcnt vmcnt(14)
    ds_read_b128 a[128:131], v2 offset:32768
    v_cvt_pk_bf16_f32 v210, v222, v223
    v_mfma_f32_16x16x32_bf16 v[152:155], v[104:107], a[64:67], v[152:155]
    v_fma_f32 v224, v224, v201, v200
    v_fma_f32 v225, v225, v201, v200
    v_mfma_f32_16x16x32_bf16 v[152:155], v[108:111], a[80:83], v[152:155]
    s_add_u32 s61, s59, 176128
    buffer_load_dwordx4 v[96:99], v2, s[24:27], s61 offen offset:0
    v_mul_f32 v224, v146, v224
    v_mul_f32_e64 v225, v147, v225
    v_mfma_f32_16x16x32_bf16 v[156:159], v[104:107], a[68:71], v[156:159]
    v_exp_f32_e64 v224, v224
    v_mfma_f32_16x16x32_bf16 v[156:159], v[108:111], a[84:87], v[156:159]
    ds_read_b128 a[144:147], v2 offset:36864
    ds_read_b128 a[148:151], v2 offset:37888
    v_exp_f32_e64 v225, v225
    v_mfma_f32_16x16x32_bf16 v[160:163], v[104:107], a[72:75], v[160:163]
    v_fma_f32 v224, v224, v202, v202
    v_fma_f32 v225, v225, v202, v202
    v_mfma_f32_16x16x32_bf16 v[160:163], v[108:111], a[88:91], v[160:163]
    buffer_load_dwordx4 v[100:103], v2, s[24:27], s61 offen offset:1024
    v_mfma_f32_16x16x32_bf16 v[164:167], v[104:107], a[76:79], v[164:167]
    v_rcp_f32_e64 v224, v224
    v_mfma_f32_16x16x32_bf16 v[164:167], v[108:111], a[92:95], v[164:167]
    s_waitcnt vmcnt(14)
    ds_read_b128 a[132:135], v2 offset:33792
    v_rcp_f32 v225, v225
    v_mfma_f32_16x16x32_bf16 v[168:171], v[112:115], a[64:67], v[168:171]
    v_mul_f32 v224, v146, v224
    v_mul_f32 v225, v147, v225
    v_mfma_f32_16x16x32_bf16 v[168:171], v[116:119], a[80:83], v[168:171]
    s_add_u32 s61, s59, 194560
    buffer_load_dwordx4 v[104:107], v2, s[24:27], s61 offen offset:0
    v_cvt_pk_bf16_f32 v211, v224, v225
    v_mul_f32 v222, v148, v148
    v_mul_f32 v223, v149, v149
    v_mfma_f32_16x16x32_bf16 v[172:175], v[112:115], a[68:71], v[172:175]
    v_fma_f32 v222, v222, v204, v203
    v_fma_f32 v223, v223, v204, v203
    v_mfma_f32_16x16x32_bf16 v[172:175], v[116:119], a[84:87], v[172:175]
    ds_write_b64 v232, v[210:211] offset:18432
    ds_read_b128 a[136:139], v2 offset:34816
L_pg8:
    s_cbranch_execz L_pg12
    v_mfma_f32_16x16x32_bf16 v[176:179], v[112:115], a[72:75], v[176:179]
    v_mul_f32 v222, v148, v222
    v_mul_f32_e64 v223, v149, v223
    v_mfma_f32_16x16x32_bf16 v[176:179], v[116:119], a[88:91], v[176:179]
    buffer_load_dwordx4 v[108:111], v2, s[24:27], s61 offen offset:1024
    v_exp_f32_e64 v222, v222
    v_mfma_f32_16x16x32_bf16 v[180:183], v[112:115], a[76:79], v[180:183]
    v_exp_f32_e64 v223, v223
    v_mfma_f32_16x16x32_bf16 v[180:183], v[116:119], a[92:95], v[180:183]
    s_waitcnt vmcnt(14) lgkmcnt(14)
    ds_read_b128 a[152:155], v2 offset:38912
    v_fma_f32 v222, v222, v205, v205
    v_fma_f32 v223, v223, v205, v205
    v_mfma_f32_16x16x32_bf16 v[120:123], v[48:51], a[96:99], v[120:123]
    s_waitcnt lgkmcnt(14)
    v_rcp_f32_e64 v222, v222
    v_mfma_f32_16x16x32_bf16 v[120:123], v[52:55], a[112:115], v[120:123]
    s_waitcnt lgkmcnt(13)
    s_add_u32 s61, s59, 212992
    buffer_load_dwordx4 v[112:115], v2, s[24:27], s61 offen offset:0
    v_rcp_f32 v223, v223
    v_mfma_f32_16x16x32_bf16 v[124:127], v[48:51], a[100:103], v[124:127]
    s_waitcnt lgkmcnt(12)
    v_mul_f32 v222, v148, v222
    v_mul_f32_e64 v223, v149, v223
    v_mfma_f32_16x16x32_bf16 v[124:127], v[52:55], a[116:119], v[124:127]
    s_waitcnt lgkmcnt(10)
    ds_read_b128 a[140:143], v2 offset:35840
    v_cvt_pk_bf16_f32 v212, v222, v223
    v_mfma_f32_16x16x32_bf16 v[128:131], v[48:51], a[104:107], v[128:131]
    s_waitcnt lgkmcnt(9)
    v_mul_f32 v224, v150, v150
    v_mul_f32 v225, v151, v151
    v_mfma_f32_16x16x32_bf16 v[128:131], v[52:55], a[120:123], v[128:131]
    buffer_load_dwordx4 v[116:119], v2, s[24:27], s61 offen offset:1024
    v_mfma_f32_16x16x32_bf16 v[132:135], v[48:51], a[108:111], v[132:135]
    s_waitcnt lgkmcnt(8)
    v_fma_f32 v224, v224, v204, v203
    v_fma_f32 v225, v225, v204, v203
    v_mfma_f32_16x16x32_bf16 v[132:135], v[52:55], a[124:127], v[132:135]
    s_waitcnt vmcnt(14)
    ds_read_b128 a[156:159], v2 offset:39936
    v_mul_f32 v224, v150, v224
    v_mul_f32 v225, v151, v225
    v_mfma_f32_16x16x32_bf16 v[152:155], v[56:59], a[96:99], v[152:155]
    v_exp_f32_e64 v224, v224
    v_mfma_f32_16x16x32_bf16 v[152:155], v[60:63], a[112:115], v[152:155]
    s_add_u32 s61, s59, 178176
    buffer_load_dwordx4 v[48:51], v2, s[24:27], s61 offen offset:0
    v_exp_f32_e64 v225, v225
    v_mfma_f32_16x16x32_bf16 v[156:159], v[56:59], a[100:103], v[156:159]
    v_fma_f32 v224, v224, v205, v205
    v_fma_f32 v225, v225, v205, v205
    v_mfma_f32_16x16x32_bf16 v[156:159], v[60:63], a[116:119], v[156:159]
    ds_read_b128 a[160:163], v230 offset:0
    ds_read_b128 a[164:167], v230 offset:1024
    v_rcp_f32_e64 v224, v224
    v_mfma_f32_16x16x32_bf16 v[160:163], v[56:59], a[104:107], v[160:163]
    v_rcp_f32_e64 v225, v225
    v_mfma_f32_16x16x32_bf16 v[160:163], v[60:63], a[120:123], v[160:163]
    buffer_load_dwordx4 v[52:55], v2, s[24:27], s61 offen offset:1024
    v_mul_f32 v224, v150, v224
    v_mul_f32 v225, v151, v225
    v_mfma_f32_16x16x32_bf16 v[164:167], v[56:59], a[108:111], v[164:167]
    v_cvt_pk_bf16_f32 v213, v224, v225
    v_mfma_f32_16x16x32_bf16 v[164:167], v[60:63], a[124:127], v[164:167]
    s_waitcnt vmcnt(14)
    ds_write_b64 v232, v[212:213] offset:19456
    ds_read_b128 a[176:179], v230 offset:4096
    v_mfma_f32_16x16x32_bf16 v[168:171], v[64:67], a[96:99], v[168:171]
    v_mul_f32 v222, v214, v214
    v_mul_f32_e64 v223, v215, v215
    v_mfma_f32_16x16x32_bf16 v[168:171], v[68:71], a[112:115], v[168:171]
    s_add_u32 s61, s59, 196608
    buffer_load_dwordx4 v[56:59], v2, s[24:27], s61 offen offset:0
    v_fma_f32 v222, v222, v195, v194
    v_fma_f32 v223, v223, v195, v194
    v_mfma_f32_16x16x32_bf16 v[172:175], v[64:67], a[100:103], v[172:175]
    v_mul_f32 v222, v214, v222
    v_mul_f32 v223, v215, v223
    v_mfma_f32_16x16x32_bf16 v[172:175], v[68:71], a[116:119], v[172:175]
    ds_read_b128 a[180:183], v230 offset:5120
    v_exp_f32_e64 v222, v222
    v_mfma_f32_16x16x32_bf16 v[176:179], v[64:67], a[104:107], v[176:179]
    v_exp_f32_e64 v223, v223
    v_mfma_f32_16x16x32_bf16 v[176:179], v[68:71], a[120:123], v[176:179]
    buffer_load_dwordx4 v[60:63], v2, s[24:27], s61 offen offset:1024
    v_mfma_f32_16x16x32_bf16 v[180:183], v[64:67], a[108:111], v[180:183]
    v_fma_f32 v222, v222, v196, v196
    v_fma_f32 v223, v223, v196, v196
    v_mfma_f32_16x16x32_bf16 v[180:183], v[68:71], a[124:127], v[180:183]
    s_waitcnt vmcnt(14) lgkmcnt(13)
    ds_read_b128 a[168:171], v230 offset:2048
    v_rcp_f32 v222, v222
    v_mfma_f32_16x16x32_bf16 v[120:123], v[72:75], a[128:131], v[120:123]
    s_waitcnt lgkmcnt(13)
    v_rcp_f32 v223, v223
    v_mfma_f32_16x16x32_bf16 v[120:123], v[76:79], a[144:147], v[120:123]
    s_waitcnt lgkmcnt(11)
    s_add_u32 s61, s59, 215040
    buffer_load_dwordx4 v[64:67], v2, s[24:27], s61 offen offset:0
    v_mul_f32 v222, v214, v222
    v_mul_f32_e64 v223, v215, v223
    v_mfma_f32_16x16x32_bf16 v[124:127], v[72:75], a[132:135], v[124:127]
    v_mul_f32 v224, v216, v216
    v_mul_f32 v225, v217, v217
    v_mfma_f32_16x16x32_bf16 v[124:127], v[76:79], a[148:151], v[124:127]
    s_waitcnt lgkmcnt(9)
    ds_read_b128 a[184:187], v230 offset:6144
    ds_read_b128 a[188:191], v230 offset:7168
    v_cvt_pk_bf16_f32 v206, v222, v223
    v_mfma_f32_16x16x32_bf16 v[128:131], v[72:75], a[136:139], v[128:131]
    s_waitcnt lgkmcnt(10)
    v_fma_f32 v224, v224, v195, v194
    v_fma_f32 v225, v225, v195, v194
    v_mfma_f32_16x16x32_bf16 v[128:131], v[76:79], a[152:155], v[128:131]
    s_waitcnt lgkmcnt(9)
    buffer_load_dwordx4 v[68:71], v2, s[24:27], s61 offen offset:1024
    v_mul_f32 v224, v216, v224
    v_mul_f32_e64 v225, v217, v225
    v_mfma_f32_16x16x32_bf16 v[132:135], v[72:75], a[140:143], v[132:135]
    s_waitcnt lgkmcnt(8)
    v_exp_f32 v224, v224
    v_mfma_f32_16x16x32_bf16 v[132:135], v[76:79], a[156:159], v[132:135]
    s_waitcnt vmcnt(14)
    ds_read_b128 a[172:175], v230 offset:3072
    v_exp_f32 v225, v225
    v_mfma_f32_16x16x32_bf16 v[152:155], v[80:83], a[128:131], v[152:155]
    v_fma_f32 v224, v224, v196, v196
    v_fma_f32 v225, v225, v196, v196
    v_mfma_f32_16x16x32_bf16 v[152:155], v[84:87], a[144:147], v[152:155]
    s_waitcnt lgkmcnt(6)
    s_barrier
    s_add_u32 s61, s59, 180224
    buffer_load_dwordx4 v[72:75], v2, s[24:27], s61 offen offset:0
    v_mfma_f32_16x16x32_bf16 v[156:159], v[80:83], a[132:135], v[156:159]
    v_rcp_f32_e64 v224, v224
    v_mfma_f32_16x16x32_bf16 v[156:159], v[84:87], a[148:151], v[156:159]
    ds_read_b128 a[192:195], v230 offset:8192
    v_rcp_f32_e64 v225, v225
    v_mfma_f32_16x16x32_bf16 v[160:163], v[80:83], a[136:139], v[160:163]
    v_mul_f32 v224, v216, v224
    v_mul_f32 v225, v217, v225
    v_mfma_f32_16x16x32_bf16 v[160:163], v[84:87], a[152:155], v[160:163]
    buffer_load_dwordx4 v[76:79], v2, s[24:27], s61 offen offset:1024
    v_cvt_pk_bf16_f32 v207, v224, v225
    v_mul_f32 v222, v218, v218
    v_mul_f32 v223, v219, v219
    v_mfma_f32_16x16x32_bf16 v[164:167], v[80:83], a[140:143], v[164:167]
    v_fma_f32 v222, v222, v198, v197
    v_fma_f32 v223, v223, v198, v197
    v_mfma_f32_16x16x32_bf16 v[164:167], v[84:87], a[156:159], v[164:167]
    s_waitcnt vmcnt(14)
    ds_write_b64 v232, v[206:207] offset:24576
    ds_read_b128 a[208:211], v230 offset:12288
    v_mfma_f32_16x16x32_bf16 v[168:171], v[88:91], a[128:131], v[168:171]
    v_mul_f32 v222, v218, v222
    v_mul_f32_e64 v223, v219, v223
    v_mfma_f32_16x16x32_bf16 v[168:171], v[92:95], a[144:147], v[168:171]
    s_add_u32 s61, s59, 198656
    buffer_load_dwordx4 v[80:83], v2, s[24:27], s61 offen offset:0
    v_exp_f32_e64 v222, v222
    v_mfma_f32_16x16x32_bf16 v[172:175], v[88:91], a[132:135], v[172:175]
    v_exp_f32_e64 v223, v223
    v_mfma_f32_16x16x32_bf16 v[172:175], v[92:95], a[148:151], v[172:175]
    ds_read_b128 a[196:199], v230 offset:9216
    v_fma_f32 v222, v222, v199, v199
    v_fma_f32 v223, v223, v199, v199
    v_mfma_f32_16x16x32_bf16 v[176:179], v[88:91], a[136:139], v[176:179]
    v_rcp_f32_e64 v222, v222
    v_mfma_f32_16x16x32_bf16 v[176:179], v[92:95], a[152:155], v[176:179]
    buffer_load_dwordx4 v[84:87], v2, s[24:27], s61 offen offset:1024
    v_mfma_f32_16x16x32_bf16 v[180:183], v[88:91], a[140:143], v[180:183]
    v_rcp_f32_e64 v223, v223
    v_mfma_f32_16x16x32_bf16 v[180:183], v[92:95], a[156:159], v[180:183]
    s_waitcnt vmcnt(14)
    ds_read_b128 a[212:215], v230 offset:13312
    v_mul_f32 v222, v218, v222
    v_mul_f32_e64 v223, v219, v223
    v_mfma_f32_16x16x32_bf16 v[120:123], v[96:99], a[160:163], v[120:123]
    s_waitcnt lgkmcnt(10)
    v_mul_f32 v224, v220, v220
    v_mul_f32_e64 v225, v221, v221
    v_mfma_f32_16x16x32_bf16 v[120:123], v[100:103], a[176:179], v[120:123]
    s_add_u32 s61, s59, 217088
    buffer_load_dwordx4 v[88:91], v2, s[24:27], s61 offen offset:0
    v_cvt_pk_bf16_f32 v208, v222, v223
    v_fma_f32 v224, v224, v198, v197
    v_fma_f32 v225, v225, v198, v197
    v_mfma_f32_16x16x32_bf16 v[124:127], v[96:99], a[164:167], v[124:127]
    s_waitcnt lgkmcnt(9)
    v_mul_f32 v224, v220, v224
    v_mul_f32_e64 v225, v221, v225
    v_mfma_f32_16x16x32_bf16 v[124:127], v[100:103], a[180:183], v[124:127]
    s_waitcnt lgkmcnt(8)
    ds_read_b128 a[200:203], v230 offset:10240
    ds_read_b128 a[204:207], v230 offset:11264
    v_mfma_f32_16x16x32_bf16 v[128:131], v[96:99], a[168:171], v[128:131]
    s_waitcnt lgkmcnt(9)
    v_exp_f32_e64 v224, v224
    v_mfma_f32_16x16x32_bf16 v[128:131], v[100:103], a[184:187], v[128:131]
    s_waitcnt lgkmcnt(7)
    buffer_load_dwordx4 v[92:95], v2, s[24:27], s61 offen offset:1024
    v_exp_f32 v225, v225
    v_mfma_f32_16x16x32_bf16 v[132:135], v[96:99], a[172:175], v[132:135]
    v_fma_f32 v224, v224, v199, v199
    v_fma_f32 v225, v225, v199, v199
    v_mfma_f32_16x16x32_bf16 v[132:135], v[100:103], a[188:191], v[132:135]
    s_waitcnt vmcnt(14)
    ds_read_b128 a[216:219], v230 offset:14336
    v_rcp_f32 v224, v224
    v_mfma_f32_16x16x32_bf16 v[152:155], v[104:107], a[160:163], v[152:155]
    v_rcp_f32_e64 v225, v225
    v_mfma_f32_16x16x32_bf16 v[152:155], v[108:111], a[176:179], v[152:155]
    s_add_u32 s61, s59, 182272
    buffer_load_dwordx4 v[96:99], v2, s[24:27], s61 offen offset:0
    v_mul_f32 v224, v220, v224
    v_mul_f32 v225, v221, v225
    v_mfma_f32_16x16x32_bf16 v[156:159], v[104:107], a[164:167], v[156:159]
    v_cvt_pk_bf16_f32 v209, v224, v225
    v_mfma_f32_16x16x32_bf16 v[156:159], v[108:111], a[180:183], v[156:159]
    ds_write_b64 v232, v[208:209] offset:25600
    ds_read_b128 a[220:223], v230 offset:15360
    v_mul_f32 v222, v244, v244
    v_mul_f32 v223, v245, v245
    v_mfma_f32_16x16x32_bf16 v[160:163], v[104:107], a[168:171], v[160:163]
    v_fma_f32 v222, v222, v201, v200
    v_fma_f32 v223, v223, v201, v200
    v_mfma_f32_16x16x32_bf16 v[160:163], v[108:111], a[184:187], v[160:163]
    buffer_load_dwordx4 v[100:103], v2, s[24:27], s61 offen offset:1024
    v_mfma_f32_16x16x32_bf16 v[164:167], v[104:107], a[172:175], v[164:167]
    v_mul_f32 v222, v244, v222
    v_mul_f32 v223, v245, v223
    v_mfma_f32_16x16x32_bf16 v[164:167], v[108:111], a[188:191], v[164:167]
    s_waitcnt vmcnt(14)
    ds_read_b128 a[224:227], v230 offset:16384
    v_exp_f32 v222, v222
    v_mfma_f32_16x16x32_bf16 v[168:171], v[112:115], a[160:163], v[168:171]
    v_exp_f32_e64 v223, v223
    v_mfma_f32_16x16x32_bf16 v[168:171], v[116:119], a[176:179], v[168:171]
    s_add_u32 s61, s59, 200704
    buffer_load_dwordx4 v[104:107], v2, s[24:27], s61 offen offset:0
    v_fma_f32 v222, v222, v202, v202
    v_fma_f32 v223, v223, v202, v202
    v_mfma_f32_16x16x32_bf16 v[172:175], v[112:115], a[164:167], v[172:175]
    v_rcp_f32_e64 v222, v222
    v_mfma_f32_16x16x32_bf16 v[172:175], v[116:119], a[180:183], v[172:175]
    ds_read_b128 a[240:243], v230 offset:20480
    ds_read_b128 a[244:247], v230 offset:21504
    v_mfma_f32_16x16x32_bf16 v[176:179], v[112:115], a[168:171], v[176:179]
    v_rcp_f32_e64 v223, v223
    v_mfma_f32_16x16x32_bf16 v[176:179], v[116:119], a[184:187], v[176:179]
    buffer_load_dwordx4 v[108:111], v2, s[24:27], s61 offen offset:1024
    v_mul_f32 v222, v244, v222
    v_mul_f32 v223, v245, v223
    v_mfma_f32_16x16x32_bf16 v[180:183], v[112:115], a[172:175], v[180:183]
    v_mul_f32 v224, v246, v246
    v_mul_f32 v225, v247, v247
    v_mfma_f32_16x16x32_bf16 v[180:183], v[116:119], a[188:191], v[180:183]
    s_waitcnt vmcnt(14) lgkmcnt(12)
    ds_read_b128 a[228:231], v230 offset:17408
    v_cvt_pk_bf16_f32 v210, v222, v223
    v_mfma_f32_16x16x32_bf16 v[120:123], v[48:51], a[192:195], v[120:123]
    s_waitcnt lgkmcnt(11)
    v_fma_f32 v224, v224, v201, v200
    v_fma_f32 v225, v225, v201, v200
    v_mfma_f32_16x16x32_bf16 v[120:123], v[52:55], a[208:211], v[120:123]
    s_waitcnt lgkmcnt(10)
    s_add_u32 s61, s59, 219136
    buffer_load_dwordx4 v[112:115], v2, s[24:27], s61 offen offset:0
    v_mul_f32 v224, v246, v224
    v_mul_f32_e64 v225, v247, v225
    v_mfma_f32_16x16x32_bf16 v[124:127], v[48:51], a[196:199], v[124:127]
    s_waitcnt lgkmcnt(9)
    v_exp_f32 v224, v224
    v_mfma_f32_16x16x32_bf16 v[124:127], v[52:55], a[212:215], v[124:127]
    s_waitcnt lgkmcnt(8)
    ds_read_b128 a[232:235], v230 offset:18432
    v_exp_f32 v225, v225
    v_mfma_f32_16x16x32_bf16 v[128:131], v[48:51], a[200:203], v[128:131]
    s_waitcnt lgkmcnt(7)
    v_fma_f32 v224, v224, v202, v202
    v_fma_f32 v225, v225, v202, v202
    v_mfma_f32_16x16x32_bf16 v[128:131], v[52:55], a[216:219], v[128:131]
    buffer_load_dwordx4 v[116:119], v2, s[24:27], s61 offen offset:1024
    v_mfma_f32_16x16x32_bf16 v[132:135], v[48:51], a[204:207], v[132:135]
    s_waitcnt lgkmcnt(5)
    v_rcp_f32_e64 v224, v224
    v_mfma_f32_16x16x32_bf16 v[132:135], v[52:55], a[220:223], v[132:135]
    s_waitcnt vmcnt(14)
    ds_read_b128 a[248:251], v230 offset:22528
    v_rcp_f32 v225, v225
    v_mfma_f32_16x16x32_bf16 v[152:155], v[56:59], a[192:195], v[152:155]
    v_mul_f32 v224, v246, v224
    v_mul_f32 v225, v247, v225
    v_mfma_f32_16x16x32_bf16 v[152:155], v[60:63], a[208:211], v[152:155]
    buffer_load_dwordx4 v[48:51], v2, s[24:27], s61 offen offset:2048
    v_cvt_pk_bf16_f32 v211, v224, v225
    v_mul_f32 v222, v248, v248
    v_mul_f32 v223, v249, v249
    v_mfma_f32_16x16x32_bf16 v[156:159], v[56:59], a[196:199], v[156:159]
    v_fma_f32 v222, v222, v204, v203
    v_fma_f32 v223, v223, v204, v203
    v_mfma_f32_16x16x32_bf16 v[156:159], v[60:63], a[212:215], v[156:159]
    ds_write_b64 v232, v[210:211] offset:26624
    ds_read_b128 a[236:239], v230 offset:19456
    v_mfma_f32_16x16x32_bf16 v[160:163], v[56:59], a[200:203], v[160:163]
    v_mul_f32 v222, v248, v222
    v_mul_f32 v223, v249, v223
    v_mfma_f32_16x16x32_bf16 v[160:163], v[60:63], a[216:219], v[160:163]
    buffer_load_dwordx4 v[52:55], v2, s[24:27], s61 offen offset:3072
    v_exp_f32_e64 v222, v222
    v_mfma_f32_16x16x32_bf16 v[164:167], v[56:59], a[204:207], v[164:167]
    v_exp_f32_e64 v223, v223
    v_mfma_f32_16x16x32_bf16 v[164:167], v[60:63], a[220:223], v[164:167]
    s_waitcnt vmcnt(14)
    ds_read_b128 a[252:255], v230 offset:23552
    v_fma_f32 v222, v222, v205, v205
    v_fma_f32 v223, v223, v205, v205
    v_mfma_f32_16x16x32_bf16 v[168:171], v[64:67], a[192:195], v[168:171]
    v_rcp_f32 v222, v222
    v_mfma_f32_16x16x32_bf16 v[168:171], v[68:71], a[208:211], v[168:171]
    s_add_u32 s61, s59, 223232
    buffer_load_dwordx4 v[56:59], v2, s[24:27], s61 offen offset:0
    v_mfma_f32_16x16x32_bf16 v[172:175], v[64:67], a[196:199], v[172:175]
    v_rcp_f32_e64 v223, v223
    v_mfma_f32_16x16x32_bf16 v[172:175], v[68:71], a[212:215], v[172:175]
    v_mul_f32 v222, v248, v222
    v_mul_f32 v223, v249, v223
    v_cvt_pk_bf16_f32 v212, v222, v223
    v_mfma_f32_16x16x32_bf16 v[176:179], v[64:67], a[200:203], v[176:179]
    v_mul_f32 v224, v250, v250
    v_mul_f32 v225, v251, v251
    v_mfma_f32_16x16x32_bf16 v[176:179], v[68:71], a[216:219], v[176:179]
    buffer_load_dwordx4 v[60:63], v2, s[24:27], s61 offen offset:1024
    v_mfma_f32_16x16x32_bf16 v[180:183], v[64:67], a[204:207], v[180:183]
    v_fma_f32 v224, v224, v204, v203
    v_fma_f32 v225, v225, v204, v203
    v_mfma_f32_16x16x32_bf16 v[180:183], v[68:71], a[220:223], v[180:183]
    s_waitcnt vmcnt(14) lgkmcnt(8)
    v_mul_f32 v224, v250, v224
    v_mul_f32_e64 v225, v251, v225
    v_mfma_f32_16x16x32_bf16 v[120:123], v[72:75], a[224:227], v[120:123]
    s_waitcnt lgkmcnt(7)
    v_exp_f32 v224, v224
    v_mfma_f32_16x16x32_bf16 v[120:123], v[76:79], a[240:243], v[120:123]
    s_waitcnt lgkmcnt(5)
    buffer_load_dwordx4 v[64:67], v2, s[24:27], s61 offen offset:2048
    v_exp_f32 v225, v225
    v_mfma_f32_16x16x32_bf16 v[124:127], v[72:75], a[228:231], v[124:127]
    v_fma_f32 v224, v224, v205, v205
    v_fma_f32 v225, v225, v205, v205
    v_mfma_f32_16x16x32_bf16 v[124:127], v[76:79], a[244:247], v[124:127]
    s_waitcnt lgkmcnt(4)
    v_rcp_f32 v224, v224
    v_rcp_f32 v225, v225
    v_mul_f32 v224, v250, v224
    v_mul_f32_e64 v225, v251, v225
    v_mfma_f32_16x16x32_bf16 v[128:131], v[72:75], a[232:235], v[128:131]
    s_waitcnt lgkmcnt(3)
    v_cvt_pk_bf16_f32 v213, v224, v225
    v_mfma_f32_16x16x32_bf16 v[128:131], v[76:79], a[248:251], v[128:131]
    s_waitcnt lgkmcnt(1)
    ds_write_b64 v232, v[212:213] offset:27648
    buffer_load_dwordx4 v[68:71], v2, s[24:27], s61 offen offset:3072
    v_mfma_f32_16x16x32_bf16 v[132:135], v[72:75], a[236:239], v[132:135]
    s_waitcnt lgkmcnt(1)
    v_mfma_f32_16x16x32_bf16 v[132:135], v[76:79], a[252:255], v[132:135]
    s_waitcnt vmcnt(14)
    v_mfma_f32_16x16x32_bf16 v[152:155], v[80:83], a[224:227], v[152:155]
    v_mfma_f32_16x16x32_bf16 v[152:155], v[84:87], a[240:243], v[152:155]
    s_waitcnt lgkmcnt(0)
    s_barrier
    s_add_u32 s61, s59, 227328
    buffer_load_dwordx4 v[72:75], v2, s[24:27], s61 offen offset:0
    v_mfma_f32_16x16x32_bf16 v[156:159], v[80:83], a[228:231], v[156:159]
    v_mfma_f32_16x16x32_bf16 v[156:159], v[84:87], a[244:247], v[156:159]
    ds_read_b128 v[16:19], v230 offset:24576
    ds_read_b128 v[20:23], v230 offset:25600
    v_mfma_f32_16x16x32_bf16 v[160:163], v[80:83], a[232:235], v[160:163]
    v_mfma_f32_16x16x32_bf16 v[160:163], v[84:87], a[248:251], v[160:163]
    buffer_load_dwordx4 v[76:79], v2, s[24:27], s61 offen offset:1024
    v_mfma_f32_16x16x32_bf16 v[164:167], v[80:83], a[236:239], v[164:167]
    v_mfma_f32_16x16x32_bf16 v[164:167], v[84:87], a[252:255], v[164:167]
    s_waitcnt vmcnt(14)
    ds_read_b128 v[32:35], v230 offset:28672
    ds_read_b128 v[36:39], v230 offset:29696
    v_mfma_f32_16x16x32_bf16 v[168:171], v[88:91], a[224:227], v[168:171]
    v_mfma_f32_16x16x32_bf16 v[168:171], v[92:95], a[240:243], v[168:171]
    buffer_load_dwordx4 v[80:83], v2, s[24:27], s61 offen offset:2048
    v_mfma_f32_16x16x32_bf16 v[172:175], v[88:91], a[228:231], v[172:175]
    v_mfma_f32_16x16x32_bf16 v[172:175], v[92:95], a[244:247], v[172:175]
    ds_read_b128 v[24:27], v230 offset:26624
    ds_read_b128 v[28:31], v230 offset:27648
    v_mfma_f32_16x16x32_bf16 v[176:179], v[88:91], a[232:235], v[176:179]
    v_mfma_f32_16x16x32_bf16 v[176:179], v[92:95], a[248:251], v[176:179]
    buffer_load_dwordx4 v[84:87], v2, s[24:27], s61 offen offset:3072
    v_mfma_f32_16x16x32_bf16 v[180:183], v[88:91], a[236:239], v[180:183]
    v_mfma_f32_16x16x32_bf16 v[180:183], v[92:95], a[252:255], v[180:183]
    s_waitcnt vmcnt(14) lgkmcnt(5)
    ds_read_b128 v[40:43], v230 offset:30720
    ds_read_b128 v[44:47], v230 offset:31744
    v_mfma_f32_16x16x32_bf16 v[120:123], v[96:99], v[16:19], v[120:123]
    s_waitcnt lgkmcnt(5)
    v_mfma_f32_16x16x32_bf16 v[120:123], v[100:103], v[32:35], v[120:123]
    s_add_u32 s61, s59, 231424
    buffer_load_dwordx4 v[88:91], v2, s[24:27], s61 offen offset:0
    v_mfma_f32_16x16x32_bf16 v[124:127], v[96:99], v[20:23], v[124:127]
    s_waitcnt lgkmcnt(4)
    v_mfma_f32_16x16x32_bf16 v[124:127], v[100:103], v[36:39], v[124:127]
    s_waitcnt lgkmcnt(3)
    v_mfma_f32_16x16x32_bf16 v[128:131], v[96:99], v[24:27], v[128:131]
    s_waitcnt lgkmcnt(1)
    v_mfma_f32_16x16x32_bf16 v[128:131], v[100:103], v[40:43], v[128:131]
    buffer_load_dwordx4 v[92:95], v2, s[24:27], s61 offen offset:1024
    v_mfma_f32_16x16x32_bf16 v[132:135], v[96:99], v[28:31], v[132:135]
    s_waitcnt lgkmcnt(0)
    v_mfma_f32_16x16x32_bf16 v[132:135], v[100:103], v[44:47], v[132:135]
    s_waitcnt vmcnt(14)
    v_mfma_f32_16x16x32_bf16 v[152:155], v[104:107], v[16:19], v[152:155]
    v_cvt_pk_bf16_f32 v206, v120, v121
    v_cvt_pk_bf16_f32 v207, v122, v123
    v_mfma_f32_16x16x32_bf16 v[152:155], v[108:111], v[32:35], v[152:155]
    buffer_load_dwordx4 v[96:99], v2, s[24:27], s61 offen offset:2048
    v_mfma_f32_16x16x32_bf16 v[156:159], v[104:107], v[20:23], v[156:159]
    v_cvt_pk_bf16_f32 v208, v124, v125
    v_cvt_pk_bf16_f32 v209, v126, v127
    v_mfma_f32_16x16x32_bf16 v[156:159], v[108:111], v[36:39], v[156:159]
    buffer_store_dwordx4 v[206:209], v237, s[24:27], s76 offen offset:0 sc1
    ds_write_b128 v241, v[206:209] offset:0
    v_mfma_f32_16x16x32_bf16 v[160:163], v[104:107], v[24:27], v[160:163]
    v_mfma_f32_16x16x32_bf16 v[160:163], v[108:111], v[40:43], v[160:163]
    buffer_load_dwordx4 v[100:103], v2, s[24:27], s61 offen offset:3072
    v_mfma_f32_16x16x32_bf16 v[164:167], v[104:107], v[28:31], v[164:167]
    v_mfma_f32_16x16x32_bf16 v[164:167], v[108:111], v[44:47], v[164:167]
    s_waitcnt vmcnt(15)
    v_mfma_f32_16x16x32_bf16 v[168:171], v[112:115], v[16:19], v[168:171]
    v_and_b32 v222, 3, v1
    v_mul_u32_u24 v222, 2624, v222
    v_mfma_f32_16x16x32_bf16 v[168:171], v[116:119], v[32:35], v[168:171]
    s_add_u32 s61, s59, 235520
    buffer_load_dwordx4 v[104:107], v2, s[24:27], s61 offen offset:0
    v_mfma_f32_16x16x32_bf16 v[172:175], v[112:115], v[20:23], v[172:175]
    v_bfe_u32 v223, v1, 2, 1
    v_mul_u32_u24 v223, 144, v223
    v_mfma_f32_16x16x32_bf16 v[172:175], v[116:119], v[36:39], v[172:175]
    v_bfe_u32 v224, v1, 3, 1
    v_lshl_add_u32 v223, v224, 2, v223
    v_mfma_f32_16x16x32_bf16 v[176:179], v[112:115], v[24:27], v[176:179]
    s_lshl_b32 s66, s46, 3
    v_add3_u32 v222, v222, v223, s66
    v_mfma_f32_16x16x32_bf16 v[176:179], v[116:119], v[40:43], v[176:179]
    buffer_load_dwordx4 v[108:111], v2, s[24:27], s61 offen offset:1024
    v_mfma_f32_16x16x32_bf16 v[180:183], v[112:115], v[28:31], v[180:183]
    v_mfma_f32_16x16x32_bf16 v[180:183], v[116:119], v[44:47], v[180:183]
    s_waitcnt vmcnt(15)
    v_mfma_f32_16x16x32_bf16 v[136:139], v[48:51], a[0:3], 0
    v_lshrrev_b32_e64 v223, 4, v1
    v_mul_u32_u24 v224, 288, v223
    v_mfma_f32_16x16x32_bf16 v[136:139], v[52:55], a[16:19], v[136:139]
    buffer_load_dwordx4 v[112:115], v2, s[24:27], s61 offen offset:2048
    v_mfma_f32_16x16x32_bf16 v[140:143], v[48:51], a[4:7], 0
    v_add_u32 v3, v222, v224
    v_and_b32 v224, 1, v223
    v_mfma_f32_16x16x32_bf16 v[140:143], v[52:55], a[20:23], v[140:143]
    v_mul_u32_u24 v224, 288, v224
    v_lshrrev_b32_e64 v225, 5, v1
    v_mfma_f32_16x16x32_bf16 v[144:147], v[48:51], a[8:11], 0
    v_mul_u32_u24 v225, 10496, v225
    v_add3_u32 v4, v222, v224, v225
    v_mfma_f32_16x16x32_bf16 v[144:147], v[52:55], a[24:27], v[144:147]
    buffer_load_dwordx4 v[116:119], v2, s[24:27], s61 offen offset:3072
    v_mfma_f32_16x16x32_bf16 v[148:151], v[48:51], a[12:15], 0
    v_mfma_f32_16x16x32_bf16 v[148:151], v[52:55], a[28:31], v[148:151]
    s_waitcnt vmcnt(15)
    v_mfma_f32_16x16x32_bf16 v[136:139], v[56:59], a[32:35], v[136:139]
    v_cvt_pk_bf16_f32 v210, v128, v129
    v_cvt_pk_bf16_f32 v211, v130, v131
    v_mfma_f32_16x16x32_bf16 v[136:139], v[60:63], a[48:51], v[136:139]
    s_add_u32 s61, s59, 239616
    buffer_load_dwordx4 v[48:51], v2, s[24:27], s61 offen offset:0
    v_mfma_f32_16x16x32_bf16 v[140:143], v[56:59], a[36:39], v[140:143]
    v_cvt_pk_bf16_f32 v212, v132, v133
    v_cvt_pk_bf16_f32 v213, v134, v135
    v_mfma_f32_16x16x32_bf16 v[140:143], v[60:63], a[52:55], v[140:143]
    buffer_store_dwordx4 v[210:213], v238, s[24:27], s76 offen offset:0 sc1
    ds_write_b128 v242, v[210:213] offset:0
    v_mfma_f32_16x16x32_bf16 v[144:147], v[56:59], a[40:43], v[144:147]
    v_mfma_f32_16x16x32_bf16 v[144:147], v[60:63], a[56:59], v[144:147]
    buffer_load_dwordx4 v[52:55], v2, s[24:27], s61 offen offset:1024
    v_mfma_f32_16x16x32_bf16 v[148:151], v[56:59], a[44:47], v[148:151]
    v_mfma_f32_16x16x32_bf16 v[148:151], v[60:63], a[60:63], v[148:151]
    s_waitcnt vmcnt(16)
    v_mfma_f32_16x16x32_bf16 v[136:139], v[64:67], a[64:67], v[136:139]
    s_barrier
    s_lshr_b32 s66, s46, 1
    v_mfma_f32_16x16x32_bf16 v[136:139], v[68:71], a[80:83], v[136:139]
    buffer_load_dwordx4 v[56:59], v2, s[24:27], s61 offen offset:2048
    v_mfma_f32_16x16x32_bf16 v[140:143], v[64:67], a[68:71], v[140:143]
    s_and_b32 s67, s46, 1
    s_lshl_b32 s58, s67, 4
    v_mfma_f32_16x16x32_bf16 v[140:143], v[68:71], a[84:87], v[140:143]
    v_and_b32 v222, 15, v1
    v_add_u32 v222, s58, v222
    v_mfma_f32_16x16x32_bf16 v[144:147], v[64:67], a[72:75], v[144:147]
    s_mul_i32 s58, s66, 10496
    v_mul_u32_u24 v224, 2624, v223
    v_mfma_f32_16x16x32_bf16 v[144:147], v[68:71], a[88:91], v[144:147]
    buffer_load_dwordx4 v[60:63], v2, s[24:27], s61 offen offset:3072
    v_mfma_f32_16x16x32_bf16 v[148:151], v[64:67], a[76:79], v[148:151]
    v_add_u32_e64 v224, s58, v224
    v_mfma_f32_16x16x32_bf16 v[148:151], v[68:71], a[92:95], v[148:151]
    s_waitcnt vmcnt(16)
    v_mfma_f32_16x16x32_bf16 v[136:139], v[72:75], a[96:99], v[136:139]
    v_cvt_pk_bf16_f32 v214, v152, v153
    v_cvt_pk_bf16_f32 v215, v154, v155
    v_mfma_f32_16x16x32_bf16 v[136:139], v[76:79], a[112:115], v[136:139]
    s_add_u32 s61, s59, 243712
    buffer_load_dwordx4 v[64:67], v2, s[24:27], s61 offen offset:0
    v_mfma_f32_16x16x32_bf16 v[140:143], v[72:75], a[100:103], v[140:143]
    v_cvt_pk_bf16_f32 v216, v156, v157
    v_cvt_pk_bf16_f32 v217, v158, v159
    v_mfma_f32_16x16x32_bf16 v[140:143], v[76:79], a[116:119], v[140:143]
    buffer_store_dwordx4 v[214:217], v237, s[24:27], s76 offen offset:256 sc1
    ds_write_b128 v241, v[214:217] offset:256
    v_mfma_f32_16x16x32_bf16 v[144:147], v[72:75], a[104:107], v[144:147]
    v_mfma_f32_16x16x32_bf16 v[144:147], v[76:79], a[120:123], v[144:147]
    buffer_load_dwordx4 v[68:71], v2, s[24:27], s61 offen offset:1024
    v_mfma_f32_16x16x32_bf16 v[148:151], v[72:75], a[108:111], v[148:151]
    v_mfma_f32_16x16x32_bf16 v[148:151], v[76:79], a[124:127], v[148:151]
    s_waitcnt vmcnt(17)
    v_mfma_f32_16x16x32_bf16 v[136:139], v[80:83], a[128:131], v[136:139]
    v_lshrrev_b32_e64 v225, 2, v222
    v_lshl_add_u32 v225, v225, 4, v224
    v_mfma_f32_16x16x32_bf16 v[136:139], v[84:87], a[144:147], v[136:139]
    buffer_load_dwordx4 v[72:75], v2, s[24:27], s61 offen offset:2048
    v_mfma_f32_16x16x32_bf16 v[140:143], v[80:83], a[132:135], v[140:143]
    v_lshl_add_u32 v5, v222, 5, v225
    v_lshrrev_b32_e64 v225, 3, v222
    v_mfma_f32_16x16x32_bf16 v[140:143], v[84:87], a[148:151], v[140:143]
    v_add_u32_e64 v225, v225, v222
    v_lshl_add_u32 v6, v225, 4, v224
    v_mfma_f32_16x16x32_bf16 v[144:147], v[80:83], a[136:139], v[144:147]
    s_lshr_b32 s58, s45, 2
    s_lshl_b32 s58, s58, 1
    v_mfma_f32_16x16x32_bf16 v[144:147], v[84:87], a[152:155], v[144:147]
    buffer_load_dwordx4 v[76:79], v2, s[24:27], s61 offen offset:3072
    v_mfma_f32_16x16x32_bf16 v[148:151], v[80:83], a[140:143], v[148:151]
    v_mfma_f32_16x16x32_bf16 v[148:151], v[84:87], a[156:159], v[148:151]
    s_waitcnt vmcnt(17)
    v_mfma_f32_16x16x32_bf16 v[136:139], v[88:91], a[160:163], v[136:139]
    v_cvt_pk_bf16_f32 v218, v160, v161
    v_cvt_pk_bf16_f32 v219, v162, v163
    v_mfma_f32_16x16x32_bf16 v[136:139], v[92:95], a[176:179], v[136:139]
    s_add_u32 s61, s59, 247808
    buffer_load_dwordx4 v[80:83], v2, s[24:27], s61 offen offset:0
    v_mfma_f32_16x16x32_bf16 v[140:143], v[88:91], a[164:167], v[140:143]
    v_cvt_pk_bf16_f32 v220, v164, v165
    v_cvt_pk_bf16_f32 v221, v166, v167
    v_mfma_f32_16x16x32_bf16 v[140:143], v[92:95], a[180:183], v[140:143]
    buffer_store_dwordx4 v[218:221], v238, s[24:27], s76 offen offset:256 sc1
    ds_write_b128 v242, v[218:221] offset:256
    v_mfma_f32_16x16x32_bf16 v[144:147], v[88:91], a[168:171], v[144:147]
    v_mfma_f32_16x16x32_bf16 v[144:147], v[92:95], a[184:187], v[144:147]
    buffer_load_dwordx4 v[84:87], v2, s[24:27], s61 offen offset:1024
    v_mfma_f32_16x16x32_bf16 v[148:151], v[88:91], a[172:175], v[148:151]
    v_mfma_f32_16x16x32_bf16 v[148:151], v[92:95], a[188:191], v[148:151]
    s_waitcnt vmcnt(17)
    v_mfma_f32_16x16x32_bf16 v[136:139], v[96:99], a[192:195], v[136:139]
    s_add_u32 s58, s58, s66
    s_and_b32 s60, s45, 3
    v_mfma_f32_16x16x32_bf16 v[136:139], v[100:103], a[208:211], v[136:139]
    buffer_load_dwordx4 v[88:91], v2, s[24:27], s61 offen offset:2048
    v_mfma_f32_16x16x32_bf16 v[140:143], v[96:99], a[196:199], v[140:143]
    s_mul_i32 s66, s58, 19456
    s_lshl_b32 s67, s60, 6
    v_mfma_f32_16x16x32_bf16 v[140:143], v[100:103], a[212:215], v[140:143]
    s_add_u32 s66, s66, s67
    s_add_u32 s66, s66, 86016
    v_mfma_f32_16x16x32_bf16 v[144:147], v[96:99], a[200:203], v[144:147]
    v_lshl_add_u32 v224, v223, 4, s66
    v_lshl_add_u32 v7, v222, 8, v224
L_pg9:
    s_cbranch_execz L_pg13
    v_mfma_f32_16x16x32_bf16 v[144:147], v[100:103], a[216:219], v[144:147]
    buffer_load_dwordx4 v[92:95], v2, s[24:27], s61 offen offset:3072
    v_mfma_f32_16x16x32_bf16 v[148:151], v[96:99], a[204:207], v[148:151]
    v_mfma_f32_16x16x32_bf16 v[148:151], v[100:103], a[220:223], v[148:151]
    s_waitcnt vmcnt(17)
    v_mfma_f32_16x16x32_bf16 v[136:139], v[104:107], a[224:227], v[136:139]
    v_cvt_pk_bf16_f32 v206, v168, v169
    v_cvt_pk_bf16_f32 v207, v170, v171
    v_mfma_f32_16x16x32_bf16 v[136:139], v[108:111], a[240:243], v[136:139]
    s_add_u32 s61, s59, 251904
    buffer_load_dwordx4 v[96:99], v2, s[24:27], s61 offen offset:0
    v_mfma_f32_16x16x32_bf16 v[140:143], v[104:107], a[228:231], v[140:143]
    v_cvt_pk_bf16_f32 v208, v172, v173
    v_cvt_pk_bf16_f32 v209, v174, v175
    v_mfma_f32_16x16x32_bf16 v[140:143], v[108:111], a[244:247], v[140:143]
    buffer_store_dwordx4 v[206:209], v237, s[24:27], s76 offen offset:512 sc1
    ds_write_b128 v241, v[206:209] offset:512
    v_mfma_f32_16x16x32_bf16 v[144:147], v[104:107], a[232:235], v[144:147]
    v_mfma_f32_16x16x32_bf16 v[144:147], v[108:111], a[248:251], v[144:147]
    buffer_load_dwordx4 v[100:103], v2, s[24:27], s61 offen offset:1024
    v_mfma_f32_16x16x32_bf16 v[148:151], v[104:107], a[236:239], v[148:151]
    v_mfma_f32_16x16x32_bf16 v[148:151], v[108:111], a[252:255], v[148:151]
    s_waitcnt vmcnt(18)
    v_mfma_f32_16x16x32_bf16 v[136:139], v[112:115], v[16:19], v[136:139]
    v_lshrrev_b32 v225, 1, v222
    v_lshl_add_u32 v224, v225, 8, v224
    v_mfma_f32_16x16x32_bf16 v[136:139], v[116:119], v[32:35], v[136:139]
    buffer_load_dwordx4 v[104:107], v2, s[24:27], s61 offen offset:2048
    v_mfma_f32_16x16x32_bf16 v[140:143], v[112:115], v[20:23], v[140:143]
    v_and_b32_e64 v225, 1, v222
    v_lshl_add_u32 v9, v225, 3, v224
    v_mfma_f32_16x16x32_bf16 v[140:143], v[116:119], v[36:39], v[140:143]
    v_lshlrev_b32 v243, 4, v222
    v_lshlrev_b32 v244, 3, v222
    v_mfma_f32_16x16x32_bf16 v[144:147], v[112:115], v[24:27], v[144:147]
    v_mul_u32_u24 v223, 1152, v223
    v_add_u32_e64 v245, v223, v243
    v_mfma_f32_16x16x32_bf16 v[144:147], v[116:119], v[40:43], v[144:147]
    buffer_load_dwordx4 v[108:111], v2, s[24:27], s61 offen offset:3072
    v_mfma_f32_16x16x32_bf16 v[148:151], v[112:115], v[28:31], v[148:151]
    v_mfma_f32_16x16x32_bf16 v[148:151], v[116:119], v[44:47], v[148:151]
    s_waitcnt vmcnt(17)
    v_mfma_f32_16x16x32_bf16 v[120:123], v[48:51], a[0:3], 0
    v_add_u32 v247, v223, v244
    v_cmp_gt_u32 vcc, 24, v222
    v_mfma_f32_16x16x32_bf16 v[120:123], v[52:55], a[16:19], v[120:123]
    s_add_u32 s61, s59, 256000
    buffer_load_dwordx4 v[112:115], v2, s[24:27], s61 offen offset:0
    v_mfma_f32_16x16x32_bf16 v[124:127], v[48:51], a[4:7], 0
    s_lshl_b32 s57, s44, 2
    s_add_u32 s57, s57, s58
    v_mfma_f32_16x16x32_bf16 v[124:127], v[52:55], a[20:23], v[124:127]
    s_lshl_b32 s57, s57, 2
    s_add_u32 s57, s57, s60
    v_mfma_f32_16x16x32_bf16 v[128:131], v[48:51], a[8:11], 0
    s_mul_i32 s57, s57, 4608
    v_cndmask_b32 v246, v235, v245, vcc
    v_mfma_f32_16x16x32_bf16 v[128:131], v[52:55], a[24:27], v[128:131]
    buffer_load_dwordx4 v[116:119], v2, s[24:27], s61 offen offset:1024
    v_mfma_f32_16x16x32_bf16 v[132:135], v[48:51], a[12:15], 0
    v_mfma_f32_16x16x32_bf16 v[132:135], v[52:55], a[28:31], v[132:135]
    s_waitcnt vmcnt(17)
    v_mfma_f32_16x16x32_bf16 v[120:123], v[56:59], a[32:35], v[120:123]
    v_cvt_pk_bf16_f32 v210, v176, v177
    v_cvt_pk_bf16_f32 v211, v178, v179
    v_mfma_f32_16x16x32_bf16 v[120:123], v[60:63], a[48:51], v[120:123]
    buffer_load_dwordx4 v[48:51], v2, s[24:27], s61 offen offset:2048
    v_mfma_f32_16x16x32_bf16 v[124:127], v[56:59], a[36:39], v[124:127]
    v_cvt_pk_bf16_f32 v212, v180, v181
    v_cvt_pk_bf16_f32 v213, v182, v183
    v_mfma_f32_16x16x32_bf16 v[124:127], v[60:63], a[52:55], v[124:127]
    buffer_store_dwordx4 v[210:213], v238, s[24:27], s76 offen offset:512 sc1
    ds_write_b128 v242, v[210:213] offset:512
    v_mfma_f32_16x16x32_bf16 v[128:131], v[56:59], a[40:43], v[128:131]
    v_mfma_f32_16x16x32_bf16 v[128:131], v[60:63], a[56:59], v[128:131]
    buffer_load_dwordx4 v[52:55], v2, s[24:27], s61 offen offset:3072
    v_mfma_f32_16x16x32_bf16 v[132:135], v[56:59], a[44:47], v[132:135]
    v_mfma_f32_16x16x32_bf16 v[132:135], v[60:63], a[60:63], v[132:135]
    s_waitcnt vmcnt(17)
    v_mfma_f32_16x16x32_bf16 v[120:123], v[64:67], a[64:67], v[120:123]
    s_mov_b32 s66, 0
    s_mov_b32 s67, 0xffff0000
    v_mfma_f32_16x16x32_bf16 v[120:123], v[68:71], a[80:83], v[120:123]
    s_add_u32 s61, s59, 260096
    buffer_load_dwordx4 v[56:59], v2, s[24:27], s61 offen offset:0
    v_mfma_f32_16x16x32_bf16 v[124:127], v[64:67], a[68:71], v[124:127]
    v_cndmask_b32 v14, v2, v235, s[66:67]
    s_mov_b32 s67, -1
    v_mfma_f32_16x16x32_bf16 v[124:127], v[68:71], a[84:87], v[124:127]
    v_cndmask_b32 v10, v235, v2, s[66:67]
    v_mfma_f32_16x16x32_bf16 v[128:131], v[64:67], a[72:75], v[128:131]
    v_mfma_f32_16x16x32_bf16 v[128:131], v[68:71], a[88:91], v[128:131]
    buffer_load_dwordx4 v[60:63], v2, s[24:27], s61 offen offset:1024
    v_mfma_f32_16x16x32_bf16 v[132:135], v[64:67], a[76:79], v[132:135]
    v_mfma_f32_16x16x32_bf16 v[132:135], v[68:71], a[92:95], v[132:135]
    s_waitcnt vmcnt(17)
    v_mfma_f32_16x16x32_bf16 v[120:123], v[72:75], a[96:99], v[120:123]
    v_cvt_pk_bf16_f32 v214, v136, v137
    v_cvt_pk_bf16_f32 v215, v138, v139
    v_mfma_f32_16x16x32_bf16 v[120:123], v[76:79], a[112:115], v[120:123]
    buffer_load_dwordx4 v[64:67], v2, s[24:27], s61 offen offset:2048
    v_mfma_f32_16x16x32_bf16 v[124:127], v[72:75], a[100:103], v[124:127]
    v_cvt_pk_bf16_f32 v216, v140, v141
    v_cvt_pk_bf16_f32 v217, v142, v143
    v_mfma_f32_16x16x32_bf16 v[124:127], v[76:79], a[116:119], v[124:127]
    buffer_store_dwordx4 v[214:217], v237, s[24:27], s76 offen offset:768 sc1
    ds_write_b128 v241, v[214:217] offset:768
    v_mfma_f32_16x16x32_bf16 v[128:131], v[72:75], a[104:107], v[128:131]
    v_mfma_f32_16x16x32_bf16 v[128:131], v[76:79], a[120:123], v[128:131]
    buffer_load_dwordx4 v[68:71], v2, s[24:27], s61 offen offset:3072
    v_mfma_f32_16x16x32_bf16 v[132:135], v[72:75], a[108:111], v[132:135]
    v_mfma_f32_16x16x32_bf16 v[132:135], v[76:79], a[124:127], v[132:135]
    s_waitcnt vmcnt(17)
    v_mfma_f32_16x16x32_bf16 v[120:123], v[80:83], a[128:131], v[120:123]
    v_mfma_f32_16x16x32_bf16 v[120:123], v[84:87], a[144:147], v[120:123]
    s_add_u32 s61, s59, 264192
    buffer_load_dwordx4 v[72:75], v2, s[24:27], s61 offen offset:0
    v_mfma_f32_16x16x32_bf16 v[124:127], v[80:83], a[132:135], v[124:127]
    v_mfma_f32_16x16x32_bf16 v[124:127], v[84:87], a[148:151], v[124:127]
    v_mfma_f32_16x16x32_bf16 v[128:131], v[80:83], a[136:139], v[128:131]
    v_mfma_f32_16x16x32_bf16 v[128:131], v[84:87], a[152:155], v[128:131]
    buffer_load_dwordx4 v[76:79], v2, s[24:27], s61 offen offset:1024
    v_mfma_f32_16x16x32_bf16 v[132:135], v[80:83], a[140:143], v[132:135]
    v_mfma_f32_16x16x32_bf16 v[132:135], v[84:87], a[156:159], v[132:135]
    s_waitcnt vmcnt(17)
    v_mfma_f32_16x16x32_bf16 v[120:123], v[88:91], a[160:163], v[120:123]
    v_mfma_f32_16x16x32_bf16 v[120:123], v[92:95], a[176:179], v[120:123]
    buffer_load_dwordx4 v[80:83], v2, s[24:27], s61 offen offset:2048
    v_mfma_f32_16x16x32_bf16 v[124:127], v[88:91], a[164:167], v[124:127]
    v_mfma_f32_16x16x32_bf16 v[124:127], v[92:95], a[180:183], v[124:127]
    v_mfma_f32_16x16x32_bf16 v[128:131], v[88:91], a[168:171], v[128:131]
    v_mfma_f32_16x16x32_bf16 v[128:131], v[92:95], a[184:187], v[128:131]
    buffer_load_dwordx4 v[84:87], v2, s[24:27], s61 offen offset:3072
    v_mfma_f32_16x16x32_bf16 v[132:135], v[88:91], a[172:175], v[132:135]
    v_mfma_f32_16x16x32_bf16 v[132:135], v[92:95], a[188:191], v[132:135]
    s_waitcnt vmcnt(16)
    v_mfma_f32_16x16x32_bf16 v[120:123], v[96:99], a[192:195], v[120:123]
    v_cvt_pk_bf16_f32 v218, v144, v145
    v_cvt_pk_bf16_f32 v219, v146, v147
    v_mfma_f32_16x16x32_bf16 v[120:123], v[100:103], a[208:211], v[120:123]
    s_add_u32 s61, s59, 268288
    buffer_load_dwordx4 v[88:91], v2, s[24:27], s61 offen offset:0
    v_mfma_f32_16x16x32_bf16 v[124:127], v[96:99], a[196:199], v[124:127]
    v_cvt_pk_bf16_f32 v220, v148, v149
    v_cvt_pk_bf16_f32 v221, v150, v151
    v_mfma_f32_16x16x32_bf16 v[124:127], v[100:103], a[212:215], v[124:127]
    buffer_store_dwordx4 v[218:221], v238, s[24:27], s76 offen offset:768 sc1
    ds_write_b128 v242, v[218:221] offset:768
    v_mfma_f32_16x16x32_bf16 v[128:131], v[96:99], a[200:203], v[128:131]
    v_mfma_f32_16x16x32_bf16 v[128:131], v[100:103], a[216:219], v[128:131]
    buffer_load_dwordx4 v[92:95], v2, s[24:27], s61 offen offset:1024
    v_mfma_f32_16x16x32_bf16 v[132:135], v[96:99], a[204:207], v[132:135]
    v_mfma_f32_16x16x32_bf16 v[132:135], v[100:103], a[220:223], v[132:135]
    s_waitcnt vmcnt(17)
    v_mfma_f32_16x16x32_bf16 v[120:123], v[104:107], a[224:227], v[120:123]
    v_mfma_f32_16x16x32_bf16 v[120:123], v[108:111], a[240:243], v[120:123]
    buffer_load_dwordx4 v[96:99], v2, s[24:27], s61 offen offset:2048
    v_mfma_f32_16x16x32_bf16 v[124:127], v[104:107], a[228:231], v[124:127]
    v_mfma_f32_16x16x32_bf16 v[124:127], v[108:111], a[244:247], v[124:127]
    v_mfma_f32_16x16x32_bf16 v[128:131], v[104:107], a[232:235], v[128:131]
    v_mfma_f32_16x16x32_bf16 v[128:131], v[108:111], a[248:251], v[128:131]
    buffer_load_dwordx4 v[100:103], v2, s[24:27], s61 offen offset:3072
    v_mfma_f32_16x16x32_bf16 v[132:135], v[104:107], a[236:239], v[132:135]
    v_mfma_f32_16x16x32_bf16 v[132:135], v[108:111], a[252:255], v[132:135]
    s_waitcnt vmcnt(17)
    v_mfma_f32_16x16x32_bf16 v[120:123], v[112:115], v[16:19], v[120:123]
    v_mfma_f32_16x16x32_bf16 v[120:123], v[116:119], v[32:35], v[120:123]
    s_add_u32 s61, s59, 272384
    buffer_load_dwordx4 v[104:107], v2, s[24:27], s61 offen offset:0
    v_mfma_f32_16x16x32_bf16 v[124:127], v[112:115], v[20:23], v[124:127]
    v_mfma_f32_16x16x32_bf16 v[124:127], v[116:119], v[36:39], v[124:127]
    v_mfma_f32_16x16x32_bf16 v[128:131], v[112:115], v[24:27], v[128:131]
    v_mfma_f32_16x16x32_bf16 v[128:131], v[116:119], v[40:43], v[128:131]
    buffer_load_dwordx4 v[108:111], v2, s[24:27], s61 offen offset:1024
    v_mfma_f32_16x16x32_bf16 v[132:135], v[112:115], v[28:31], v[132:135]
    v_mfma_f32_16x16x32_bf16 v[132:135], v[116:119], v[44:47], v[132:135]
    s_waitcnt vmcnt(16)
    v_mfma_f32_16x16x32_bf16 v[136:139], v[48:51], a[0:3], 0
    s_nop 0
    v_cvt_pk_bf16_f32 v206, v120, v121
    v_cvt_pk_bf16_f32 v207, v122, v123
    v_mfma_f32_16x16x32_bf16 v[136:139], v[52:55], a[16:19], v[136:139]
    buffer_load_dwordx4 v[112:115], v2, s[24:27], s61 offen offset:2048
    v_mfma_f32_16x16x32_bf16 v[140:143], v[48:51], a[4:7], 0
    v_cvt_pk_bf16_f32 v208, v124, v125
    v_cvt_pk_bf16_f32 v209, v126, v127
    v_mfma_f32_16x16x32_bf16 v[140:143], v[52:55], a[20:23], v[140:143]
    buffer_store_dwordx4 v[206:209], v237, s[24:27], s76 offen offset:1024 sc1
    ds_write_b128 v241, v[206:209] offset:1024
    v_mfma_f32_16x16x32_bf16 v[144:147], v[48:51], a[8:11], 0
    v_mfma_f32_16x16x32_bf16 v[144:147], v[52:55], a[24:27], v[144:147]
    buffer_load_dwordx4 v[116:119], v2, s[24:27], s61 offen offset:3072
    v_mfma_f32_16x16x32_bf16 v[148:151], v[48:51], a[12:15], 0
    v_mfma_f32_16x16x32_bf16 v[148:151], v[52:55], a[28:31], v[148:151]
    s_waitcnt vmcnt(17)
    v_mfma_f32_16x16x32_bf16 v[136:139], v[56:59], a[32:35], v[136:139]
    v_mfma_f32_16x16x32_bf16 v[136:139], v[60:63], a[48:51], v[136:139]
    s_add_u32 s61, s59, 276480
    buffer_load_dwordx4 v[48:51], v2, s[24:27], s61 offen offset:0
    v_mfma_f32_16x16x32_bf16 v[140:143], v[56:59], a[36:39], v[140:143]
    v_mfma_f32_16x16x32_bf16 v[140:143], v[60:63], a[52:55], v[140:143]
    v_mfma_f32_16x16x32_bf16 v[144:147], v[56:59], a[40:43], v[144:147]
    v_mfma_f32_16x16x32_bf16 v[144:147], v[60:63], a[56:59], v[144:147]
    buffer_load_dwordx4 v[52:55], v2, s[24:27], s61 offen offset:1024
    v_mfma_f32_16x16x32_bf16 v[148:151], v[56:59], a[44:47], v[148:151]
    v_mfma_f32_16x16x32_bf16 v[148:151], v[60:63], a[60:63], v[148:151]
    s_waitcnt vmcnt(16)
    v_mfma_f32_16x16x32_bf16 v[136:139], v[64:67], a[64:67], v[136:139]
    v_mfma_f32_16x16x32_bf16 v[136:139], v[68:71], a[80:83], v[136:139]
    buffer_load_dwordx4 v[56:59], v2, s[24:27], s61 offen offset:2048
    v_mfma_f32_16x16x32_bf16 v[140:143], v[64:67], a[68:71], v[140:143]
    v_mfma_f32_16x16x32_bf16 v[140:143], v[68:71], a[84:87], v[140:143]
    s_waitcnt vmcnt(11)
    buffer_atomic_add v13, v254, s[24:27], s48 offen offset:1024 sc1
    v_mfma_f32_16x16x32_bf16 v[144:147], v[64:67], a[72:75], v[144:147]
    v_mfma_f32_16x16x32_bf16 v[144:147], v[68:71], a[88:91], v[144:147]
    buffer_load_dwordx4 v[60:63], v2, s[24:27], s61 offen offset:3072
    v_mfma_f32_16x16x32_bf16 v[148:151], v[64:67], a[76:79], v[148:151]
    v_mfma_f32_16x16x32_bf16 v[148:151], v[68:71], a[92:95], v[148:151]
    v_mfma_f32_16x16x32_bf16 v[136:139], v[72:75], a[96:99], v[136:139]
    v_cvt_pk_bf16_f32 v210, v128, v129
    v_cvt_pk_bf16_f32 v211, v130, v131
    v_mfma_f32_16x16x32_bf16 v[136:139], v[76:79], a[112:115], v[136:139]
    s_add_u32 s61, s59, 280576
    buffer_load_dwordx4 v[64:67], v2, s[24:27], s61 offen offset:0
    v_mfma_f32_16x16x32_bf16 v[140:143], v[72:75], a[100:103], v[140:143]
    v_cvt_pk_bf16_f32 v212, v132, v133
    v_cvt_pk_bf16_f32 v213, v134, v135
    v_mfma_f32_16x16x32_bf16 v[140:143], v[76:79], a[116:119], v[140:143]
    buffer_store_dwordx4 v[210:213], v238, s[24:27], s76 offen offset:1024 sc1
    ds_write_b128 v242, v[210:213] offset:1024
    v_mfma_f32_16x16x32_bf16 v[144:147], v[72:75], a[104:107], v[144:147]
    v_mfma_f32_16x16x32_bf16 v[144:147], v[76:79], a[120:123], v[144:147]
    buffer_load_dwordx4 v[68:71], v2, s[24:27], s61 offen offset:1024
    v_mfma_f32_16x16x32_bf16 v[148:151], v[72:75], a[108:111], v[148:151]
    v_mfma_f32_16x16x32_bf16 v[148:151], v[76:79], a[124:127], v[148:151]
    v_mfma_f32_16x16x32_bf16 v[136:139], v[80:83], a[128:131], v[136:139]
    v_mfma_f32_16x16x32_bf16 v[136:139], v[84:87], a[144:147], v[136:139]
    buffer_load_dwordx4 v[72:75], v2, s[24:27], s61 offen offset:2048
    v_mfma_f32_16x16x32_bf16 v[140:143], v[80:83], a[132:135], v[140:143]
    v_mfma_f32_16x16x32_bf16 v[140:143], v[84:87], a[148:151], v[140:143]
    v_mfma_f32_16x16x32_bf16 v[144:147], v[80:83], a[136:139], v[144:147]
    v_mfma_f32_16x16x32_bf16 v[144:147], v[84:87], a[152:155], v[144:147]
    buffer_load_dwordx4 v[76:79], v2, s[24:27], s61 offen offset:3072
    v_mfma_f32_16x16x32_bf16 v[148:151], v[80:83], a[140:143], v[148:151]
    v_mfma_f32_16x16x32_bf16 v[148:151], v[84:87], a[156:159], v[148:151]
    s_waitcnt vmcnt(17)
    v_mfma_f32_16x16x32_bf16 v[136:139], v[88:91], a[160:163], v[136:139]
    v_mfma_f32_16x16x32_bf16 v[136:139], v[92:95], a[176:179], v[136:139]
    s_add_u32 s61, s59, 284672
    buffer_load_dwordx4 v[80:83], v2, s[24:27], s61 offen offset:0
    v_mfma_f32_16x16x32_bf16 v[140:143], v[88:91], a[164:167], v[140:143]
    v_mfma_f32_16x16x32_bf16 v[140:143], v[92:95], a[180:183], v[140:143]
    v_mfma_f32_16x16x32_bf16 v[144:147], v[88:91], a[168:171], v[144:147]
    v_mfma_f32_16x16x32_bf16 v[144:147], v[92:95], a[184:187], v[144:147]
    buffer_load_dwordx4 v[84:87], v2, s[24:27], s61 offen offset:1024
    v_mfma_f32_16x16x32_bf16 v[148:151], v[88:91], a[172:175], v[148:151]
    v_mfma_f32_16x16x32_bf16 v[148:151], v[92:95], a[188:191], v[148:151]
    s_waitcnt vmcnt(17)
    v_mfma_f32_16x16x32_bf16 v[136:139], v[96:99], a[192:195], v[136:139]
    v_mfma_f32_16x16x32_bf16 v[136:139], v[100:103], a[208:211], v[136:139]
    buffer_load_dwordx4 v[88:91], v2, s[24:27], s61 offen offset:2048
    v_mfma_f32_16x16x32_bf16 v[140:143], v[96:99], a[196:199], v[140:143]
    v_mfma_f32_16x16x32_bf16 v[140:143], v[100:103], a[212:215], v[140:143]
    v_mfma_f32_16x16x32_bf16 v[144:147], v[96:99], a[200:203], v[144:147]
    v_mfma_f32_16x16x32_bf16 v[144:147], v[100:103], a[216:219], v[144:147]
    buffer_load_dwordx4 v[92:95], v2, s[24:27], s61 offen offset:3072
    v_mfma_f32_16x16x32_bf16 v[148:151], v[96:99], a[204:207], v[148:151]
    v_mfma_f32_16x16x32_bf16 v[148:151], v[100:103], a[220:223], v[148:151]
    s_waitcnt vmcnt(17)
    v_mfma_f32_16x16x32_bf16 v[136:139], v[104:107], a[224:227], v[136:139]
    v_mfma_f32_16x16x32_bf16 v[136:139], v[108:111], a[240:243], v[136:139]
    s_add_u32 s61, s59, 288768
    buffer_load_dwordx4 v[96:99], v2, s[24:27], s61 offen offset:0
    v_mfma_f32_16x16x32_bf16 v[140:143], v[104:107], a[228:231], v[140:143]
    v_mfma_f32_16x16x32_bf16 v[140:143], v[108:111], a[244:247], v[140:143]
    v_mfma_f32_16x16x32_bf16 v[144:147], v[104:107], a[232:235], v[144:147]
    v_mfma_f32_16x16x32_bf16 v[144:147], v[108:111], a[248:251], v[144:147]
    buffer_load_dwordx4 v[100:103], v2, s[24:27], s61 offen offset:1024
    v_mfma_f32_16x16x32_bf16 v[148:151], v[104:107], a[236:239], v[148:151]
    v_mfma_f32_16x16x32_bf16 v[148:151], v[108:111], a[252:255], v[148:151]
    s_waitcnt vmcnt(16)
    v_mfma_f32_16x16x32_bf16 v[136:139], v[112:115], v[16:19], v[136:139]
    v_mfma_f32_16x16x32_bf16 v[136:139], v[116:119], v[32:35], v[136:139]
    buffer_load_dwordx4 v[104:107], v2, s[24:27], s61 offen offset:2048
    v_mfma_f32_16x16x32_bf16 v[140:143], v[112:115], v[20:23], v[140:143]
    v_mfma_f32_16x16x32_bf16 v[140:143], v[116:119], v[36:39], v[140:143]
    v_mfma_f32_16x16x32_bf16 v[144:147], v[112:115], v[24:27], v[144:147]
    v_mfma_f32_16x16x32_bf16 v[144:147], v[116:119], v[40:43], v[144:147]
    buffer_load_dwordx4 v[108:111], v2, s[24:27], s61 offen offset:3072
    v_mfma_f32_16x16x32_bf16 v[148:151], v[112:115], v[28:31], v[148:151]
    v_mfma_f32_16x16x32_bf16 v[148:151], v[116:119], v[44:47], v[148:151]
    s_waitcnt vmcnt(16)
    v_mfma_f32_16x16x32_bf16 v[120:123], v[48:51], a[0:3], 0
    s_nop 0
    v_cvt_pk_bf16_f32 v214, v136, v137
    v_cvt_pk_bf16_f32 v215, v138, v139
    v_mfma_f32_16x16x32_bf16 v[120:123], v[52:55], a[16:19], v[120:123]
    s_add_u32 s61, s59, 292864
    buffer_load_dwordx4 v[112:115], v2, s[24:27], s61 offen offset:0
    v_mfma_f32_16x16x32_bf16 v[124:127], v[48:51], a[4:7], 0
    v_cvt_pk_bf16_f32 v216, v140, v141
    v_cvt_pk_bf16_f32 v217, v142, v143
    v_mfma_f32_16x16x32_bf16 v[124:127], v[52:55], a[20:23], v[124:127]
    buffer_store_dwordx4 v[214:217], v237, s[24:27], s76 offen offset:1280 sc1
    ds_write_b128 v241, v[214:217] offset:1280
    v_mfma_f32_16x16x32_bf16 v[128:131], v[48:51], a[8:11], 0
    v_mfma_f32_16x16x32_bf16 v[128:131], v[52:55], a[24:27], v[128:131]
    buffer_load_dwordx4 v[116:119], v2, s[24:27], s61 offen offset:1024
    v_mfma_f32_16x16x32_bf16 v[132:135], v[48:51], a[12:15], 0
    v_mfma_f32_16x16x32_bf16 v[132:135], v[52:55], a[28:31], v[132:135]
    s_waitcnt vmcnt(16)
    v_mfma_f32_16x16x32_bf16 v[120:123], v[56:59], a[32:35], v[120:123]
    v_mfma_f32_16x16x32_bf16 v[120:123], v[60:63], a[48:51], v[120:123]
    buffer_load_dwordx4 v[48:51], v2, s[24:27], s61 offen offset:2048
    v_mfma_f32_16x16x32_bf16 v[124:127], v[56:59], a[36:39], v[124:127]
    v_mfma_f32_16x16x32_bf16 v[124:127], v[60:63], a[52:55], v[124:127]
    v_mfma_f32_16x16x32_bf16 v[128:131], v[56:59], a[40:43], v[128:131]
    v_mfma_f32_16x16x32_bf16 v[128:131], v[60:63], a[56:59], v[128:131]
    buffer_load_dwordx4 v[52:55], v2, s[24:27], s61 offen offset:3072
    v_mfma_f32_16x16x32_bf16 v[132:135], v[56:59], a[44:47], v[132:135]
    v_mfma_f32_16x16x32_bf16 v[132:135], v[60:63], a[60:63], v[132:135]
    s_waitcnt vmcnt(15)
    v_mfma_f32_16x16x32_bf16 v[120:123], v[64:67], a[64:67], v[120:123]
    v_mfma_f32_16x16x32_bf16 v[120:123], v[68:71], a[80:83], v[120:123]
    s_add_u32 s61, s59, 296960
    buffer_load_dwordx4 v[56:59], v2, s[24:27], s61 offen offset:0
    v_mfma_f32_16x16x32_bf16 v[124:127], v[64:67], a[68:71], v[124:127]
    v_mfma_f32_16x16x32_bf16 v[124:127], v[68:71], a[84:87], v[124:127]
    v_mfma_f32_16x16x32_bf16 v[128:131], v[64:67], a[72:75], v[128:131]
    v_mfma_f32_16x16x32_bf16 v[128:131], v[68:71], a[88:91], v[128:131]
    buffer_load_dwordx4 v[60:63], v2, s[24:27], s61 offen offset:1024
    v_mfma_f32_16x16x32_bf16 v[132:135], v[64:67], a[76:79], v[132:135]
    v_mfma_f32_16x16x32_bf16 v[132:135], v[68:71], a[92:95], v[132:135]
    s_waitcnt vmcnt(15)
    v_mfma_f32_16x16x32_bf16 v[120:123], v[72:75], a[96:99], v[120:123]
    v_cvt_pk_bf16_f32 v218, v144, v145
    v_cvt_pk_bf16_f32 v219, v146, v147
    v_mfma_f32_16x16x32_bf16 v[120:123], v[76:79], a[112:115], v[120:123]
    buffer_load_dwordx4 v[64:67], v2, s[24:27], s61 offen offset:2048
    v_mfma_f32_16x16x32_bf16 v[124:127], v[72:75], a[100:103], v[124:127]
    v_cvt_pk_bf16_f32 v220, v148, v149
    v_cvt_pk_bf16_f32 v221, v150, v151
    v_mfma_f32_16x16x32_bf16 v[124:127], v[76:79], a[116:119], v[124:127]
    buffer_store_dwordx4 v[218:221], v238, s[24:27], s76 offen offset:1280 sc1
    ds_write_b128 v242, v[218:221] offset:1280
    v_mfma_f32_16x16x32_bf16 v[128:131], v[72:75], a[104:107], v[128:131]
    v_mfma_f32_16x16x32_bf16 v[128:131], v[76:79], a[120:123], v[128:131]
    buffer_load_dwordx4 v[68:71], v2, s[24:27], s61 offen offset:3072
    v_mfma_f32_16x16x32_bf16 v[132:135], v[72:75], a[108:111], v[132:135]
    v_mfma_f32_16x16x32_bf16 v[132:135], v[76:79], a[124:127], v[132:135]
    s_waitcnt vmcnt(16)
    v_mfma_f32_16x16x32_bf16 v[120:123], v[80:83], a[128:131], v[120:123]
    v_mfma_f32_16x16x32_bf16 v[120:123], v[84:87], a[144:147], v[120:123]
    s_add_u32 s61, s59, 301056
    buffer_load_dwordx4 v[72:75], v2, s[24:27], s61 offen offset:0
    v_mfma_f32_16x16x32_bf16 v[124:127], v[80:83], a[132:135], v[124:127]
    v_mfma_f32_16x16x32_bf16 v[124:127], v[84:87], a[148:151], v[124:127]
    v_mfma_f32_16x16x32_bf16 v[128:131], v[80:83], a[136:139], v[128:131]
    v_mfma_f32_16x16x32_bf16 v[128:131], v[84:87], a[152:155], v[128:131]
    buffer_load_dwordx4 v[76:79], v2, s[24:27], s61 offen offset:1024
    v_mfma_f32_16x16x32_bf16 v[132:135], v[80:83], a[140:143], v[132:135]
    v_mfma_f32_16x16x32_bf16 v[132:135], v[84:87], a[156:159], v[132:135]
    s_waitcnt vmcnt(16)
    v_mfma_f32_16x16x32_bf16 v[120:123], v[88:91], a[160:163], v[120:123]
    v_mfma_f32_16x16x32_bf16 v[120:123], v[92:95], a[176:179], v[120:123]
    buffer_load_dwordx4 v[80:83], v2, s[24:27], s61 offen offset:2048
    v_mfma_f32_16x16x32_bf16 v[124:127], v[88:91], a[164:167], v[124:127]
    v_mfma_f32_16x16x32_bf16 v[124:127], v[92:95], a[180:183], v[124:127]
    v_mfma_f32_16x16x32_bf16 v[128:131], v[88:91], a[168:171], v[128:131]
    v_mfma_f32_16x16x32_bf16 v[128:131], v[92:95], a[184:187], v[128:131]
    buffer_load_dwordx4 v[84:87], v2, s[24:27], s61 offen offset:3072
    v_mfma_f32_16x16x32_bf16 v[132:135], v[88:91], a[172:175], v[132:135]
    v_mfma_f32_16x16x32_bf16 v[132:135], v[92:95], a[188:191], v[132:135]
    s_waitcnt vmcnt(16)
    v_mfma_f32_16x16x32_bf16 v[120:123], v[96:99], a[192:195], v[120:123]
    v_mfma_f32_16x16x32_bf16 v[120:123], v[100:103], a[208:211], v[120:123]
    s_add_u32 s61, s59, 305152
    buffer_load_dwordx4 v[88:91], v2, s[24:27], s61 offen offset:0
    v_mfma_f32_16x16x32_bf16 v[124:127], v[96:99], a[196:199], v[124:127]
    v_mfma_f32_16x16x32_bf16 v[124:127], v[100:103], a[212:215], v[124:127]
    v_mfma_f32_16x16x32_bf16 v[128:131], v[96:99], a[200:203], v[128:131]
    v_mfma_f32_16x16x32_bf16 v[128:131], v[100:103], a[216:219], v[128:131]
    buffer_load_dwordx4 v[92:95], v2, s[24:27], s61 offen offset:1024
    v_mfma_f32_16x16x32_bf16 v[132:135], v[96:99], a[204:207], v[132:135]
    v_mfma_f32_16x16x32_bf16 v[132:135], v[100:103], a[220:223], v[132:135]
    s_waitcnt vmcnt(16)
    ds_read_b128 v[184:187], v7 offset:0
    v_mfma_f32_16x16x32_bf16 v[120:123], v[104:107], a[224:227], v[120:123]
    v_mfma_f32_16x16x32_bf16 v[120:123], v[108:111], a[240:243], v[120:123]
    buffer_load_dwordx4 v[96:99], v2, s[24:27], s61 offen offset:2048
    v_mfma_f32_16x16x32_bf16 v[124:127], v[104:107], a[228:231], v[124:127]
    v_mfma_f32_16x16x32_bf16 v[124:127], v[108:111], a[244:247], v[124:127]
    v_mfma_f32_16x16x32_bf16 v[128:131], v[104:107], a[232:235], v[128:131]
    v_mfma_f32_16x16x32_bf16 v[128:131], v[108:111], a[248:251], v[128:131]
    buffer_load_dwordx4 v[100:103], v2, s[24:27], s61 offen offset:3072
    v_mfma_f32_16x16x32_bf16 v[132:135], v[104:107], a[236:239], v[132:135]
    v_mfma_f32_16x16x32_bf16 v[132:135], v[108:111], a[252:255], v[132:135]
    s_waitcnt vmcnt(15)
    buffer_load_dwordx4 v[194:197], v243, s[40:43], 0 offen offset:0
    v_mfma_f32_16x16x32_bf16 v[120:123], v[112:115], v[16:19], v[120:123]
    v_mfma_f32_16x16x32_bf16 v[120:123], v[116:119], v[32:35], v[120:123]
    s_add_u32 s61, s59, 309248
    buffer_load_dwordx4 v[104:107], v2, s[24:27], s61 offen offset:0
    v_mfma_f32_16x16x32_bf16 v[124:127], v[112:115], v[20:23], v[124:127]
    v_mfma_f32_16x16x32_bf16 v[124:127], v[116:119], v[36:39], v[124:127]
    v_mfma_f32_16x16x32_bf16 v[128:131], v[112:115], v[24:27], v[128:131]
    v_mfma_f32_16x16x32_bf16 v[128:131], v[116:119], v[40:43], v[128:131]
    buffer_load_dwordx4 v[108:111], v2, s[24:27], s61 offen offset:1024
    v_mfma_f32_16x16x32_bf16 v[132:135], v[112:115], v[28:31], v[132:135]
    v_mfma_f32_16x16x32_bf16 v[132:135], v[116:119], v[44:47], v[132:135]
    s_waitcnt vmcnt(16)
    ds_read_b128 v[188:191], v7 offset:8192
    v_mfma_f32_16x16x32_bf16 v[136:139], v[48:51], a[0:3], 0
    v_cvt_pk_bf16_f32 v206, v120, v121
    v_cvt_pk_bf16_f32 v207, v122, v123
    v_mfma_f32_16x16x32_bf16 v[136:139], v[52:55], a[16:19], v[136:139]
    buffer_load_dwordx4 v[112:115], v2, s[24:27], s61 offen offset:2048
    v_cvt_pk_bf16_f32 v208, v124, v125
    v_mfma_f32_16x16x32_bf16 v[140:143], v[48:51], a[4:7], 0
    v_cvt_pk_bf16_f32 v209, v126, v127
    v_mfma_f32_16x16x32_bf16 v[140:143], v[52:55], a[20:23], v[140:143]
    buffer_store_dwordx4 v[206:209], v237, s[24:27], s76 offen offset:1536 sc1
    ds_write_b128 v241, v[206:209] offset:1536
    v_mov_b32_e64 v11, 0
    buffer_atomic_add v11, v254, s[24:27], s48 offen offset:1024 sc0 sc1
    v_mfma_f32_16x16x32_bf16 v[144:147], v[48:51], a[8:11], 0
    v_mfma_f32_16x16x32_bf16 v[144:147], v[52:55], a[24:27], v[144:147]
    buffer_load_dwordx4 v[116:119], v2, s[24:27], s61 offen offset:3072
    v_mfma_f32_16x16x32_bf16 v[148:151], v[48:51], a[12:15], 0
    v_mfma_f32_16x16x32_bf16 v[148:151], v[52:55], a[28:31], v[148:151]
    s_waitcnt vmcnt(18)
    buffer_load_dwordx4 v[198:201], v243, s[40:43], 0 offen offset:512
    v_mfma_f32_16x16x32_bf16 v[136:139], v[56:59], a[32:35], v[136:139]
    v_mfma_f32_16x16x32_bf16 v[136:139], v[60:63], a[48:51], v[136:139]
    s_add_u32 s61, s59, 313344
    buffer_load_dwordx4 v[48:51], v2, s[24:27], s61 offen offset:0
    v_mfma_f32_16x16x32_bf16 v[140:143], v[56:59], a[36:39], v[140:143]
    v_mfma_f32_16x16x32_bf16 v[140:143], v[60:63], a[52:55], v[140:143]
    v_mfma_f32_16x16x32_bf16 v[144:147], v[56:59], a[40:43], v[144:147]
    v_mfma_f32_16x16x32_bf16 v[144:147], v[60:63], a[56:59], v[144:147]
    buffer_load_dwordx4 v[52:55], v2, s[24:27], s61 offen offset:1024
    v_mfma_f32_16x16x32_bf16 v[148:151], v[56:59], a[44:47], v[148:151]
    v_mfma_f32_16x16x32_bf16 v[148:151], v[60:63], a[60:63], v[148:151]
    s_waitcnt vmcnt(18)
    ds_read_b64 v[192:193], v9 offset:14336
    v_mfma_f32_16x16x32_bf16 v[136:139], v[64:67], a[64:67], v[136:139]
    v_mfma_f32_16x16x32_bf16 v[136:139], v[68:71], a[80:83], v[136:139]
    buffer_load_dwordx4 v[56:59], v2, s[24:27], s61 offen offset:2048
    v_mfma_f32_16x16x32_bf16 v[140:143], v[64:67], a[68:71], v[140:143]
    v_mfma_f32_16x16x32_bf16 v[140:143], v[68:71], a[84:87], v[140:143]
    v_mfma_f32_16x16x32_bf16 v[144:147], v[64:67], a[72:75], v[144:147]
    v_mfma_f32_16x16x32_bf16 v[144:147], v[68:71], a[88:91], v[144:147]
    buffer_load_dwordx4 v[60:63], v2, s[24:27], s61 offen offset:3072
    v_mfma_f32_16x16x32_bf16 v[148:151], v[64:67], a[76:79], v[148:151]
    v_mfma_f32_16x16x32_bf16 v[148:151], v[68:71], a[92:95], v[148:151]
    s_waitcnt vmcnt(18)
    buffer_load_dwordx2 v[202:203], v244, s[40:43], 0 offen offset:896
    v_mfma_f32_16x16x32_bf16 v[136:139], v[72:75], a[96:99], v[136:139]
    v_cvt_pk_bf16_f32 v210, v128, v129
    v_cvt_pk_bf16_f32 v211, v130, v131
    v_mfma_f32_16x16x32_bf16 v[136:139], v[76:79], a[112:115], v[136:139]
    s_add_u32 s61, s59, 317440
    buffer_load_dwordx4 v[64:67], v2, s[24:27], s61 offen offset:0
    v_mfma_f32_16x16x32_bf16 v[140:143], v[72:75], a[100:103], v[140:143]
    v_cvt_pk_bf16_f32 v212, v132, v133
    v_cvt_pk_bf16_f32 v213, v134, v135
    v_mfma_f32_16x16x32_bf16 v[140:143], v[76:79], a[116:119], v[140:143]
    buffer_store_dwordx4 v[210:213], v238, s[24:27], s76 offen offset:1536 sc1
    ds_write_b128 v242, v[210:213] offset:1536
    v_mfma_f32_16x16x32_bf16 v[144:147], v[72:75], a[104:107], v[144:147]
    v_mfma_f32_16x16x32_bf16 v[144:147], v[76:79], a[120:123], v[144:147]
    buffer_load_dwordx4 v[68:71], v2, s[24:27], s61 offen offset:1024
    v_mfma_f32_16x16x32_bf16 v[148:151], v[72:75], a[108:111], v[148:151]
    v_mfma_f32_16x16x32_bf16 v[148:151], v[76:79], a[124:127], v[148:151]
    s_waitcnt vmcnt(20)
    v_mfma_f32_16x16x32_bf16 v[136:139], v[80:83], a[128:131], v[136:139]
    v_mfma_f32_16x16x32_bf16 v[136:139], v[84:87], a[144:147], v[136:139]
    buffer_load_dwordx4 v[72:75], v2, s[24:27], s61 offen offset:2048
    v_mfma_f32_16x16x32_bf16 v[140:143], v[80:83], a[132:135], v[140:143]
    v_mfma_f32_16x16x32_bf16 v[140:143], v[84:87], a[148:151], v[140:143]
    v_mfma_f32_16x16x32_bf16 v[144:147], v[80:83], a[136:139], v[144:147]
    v_mfma_f32_16x16x32_bf16 v[144:147], v[84:87], a[152:155], v[144:147]
    buffer_load_dwordx4 v[76:79], v2, s[24:27], s61 offen offset:3072
    v_mfma_f32_16x16x32_bf16 v[148:151], v[80:83], a[140:143], v[148:151]
    v_mfma_f32_16x16x32_bf16 v[148:151], v[84:87], a[156:159], v[148:151]
    s_waitcnt vmcnt(20)
    v_mfma_f32_16x16x32_bf16 v[136:139], v[88:91], a[160:163], v[136:139]
    v_mfma_f32_16x16x32_bf16 v[136:139], v[92:95], a[176:179], v[136:139]
    s_add_u32 s61, s59, 321536
    buffer_load_dwordx4 v[80:83], v2, s[24:27], s61 offen offset:0
    v_mfma_f32_16x16x32_bf16 v[140:143], v[88:91], a[164:167], v[140:143]
    v_mfma_f32_16x16x32_bf16 v[140:143], v[92:95], a[180:183], v[140:143]
    s_waitcnt vmcnt(13)
    v_readfirstlane_b32 s50, v11
    s_mov_b32 s49, 0
    s_cmp_ge_u32 s50, 8
    s_cbranch_scc1 spout_12
spin_11:
    v_mov_b32_e64 v11, 0
    buffer_atomic_add v11, v254, s[24:27], s48 offen offset:1024 sc0 sc1
    s_add_u32 s49, s49, 1
    s_waitcnt vmcnt(0)
    v_readfirstlane_b32 s50, v11
    s_cmp_ge_u32 s49, 262144
    s_cbranch_scc1 spout_12
    s_cmp_ge_u32 s50, 8
    s_cbranch_scc0 spin_11
spout_12:
    v_mfma_f32_16x16x32_bf16 v[144:147], v[88:91], a[168:171], v[144:147]
    v_mfma_f32_16x16x32_bf16 v[144:147], v[92:95], a[184:187], v[144:147]
    buffer_load_dwordx4 v[84:87], v2, s[24:27], s61 offen offset:1024
    v_mfma_f32_16x16x32_bf16 v[148:151], v[88:91], a[172:175], v[148:151]
    v_mfma_f32_16x16x32_bf16 v[148:151], v[92:95], a[188:191], v[148:151]
    v_mfma_f32_16x16x32_bf16 v[136:139], v[96:99], a[192:195], v[136:139]
    v_mfma_f32_16x16x32_bf16 v[136:139], v[100:103], a[208:211], v[136:139]
    buffer_load_dwordx4 v[88:91], v2, s[24:27], s61 offen offset:2048
    v_mfma_f32_16x16x32_bf16 v[140:143], v[96:99], a[196:199], v[140:143]
    v_mfma_f32_16x16x32_bf16 v[140:143], v[100:103], a[212:215], v[140:143]
    s_add_u32 s50, s56, 2048
    buffer_load_dwordx4 v[156:159], v2, s[24:27], s50 offen sc1
    v_mfma_f32_16x16x32_bf16 v[144:147], v[96:99], a[200:203], v[144:147]
    v_mfma_f32_16x16x32_bf16 v[144:147], v[100:103], a[216:219], v[144:147]
    buffer_load_dwordx4 v[92:95], v2, s[24:27], s61 offen offset:3072
    v_mfma_f32_16x16x32_bf16 v[148:151], v[96:99], a[204:207], v[148:151]
    v_mfma_f32_16x16x32_bf16 v[148:151], v[100:103], a[220:223], v[148:151]
    v_mfma_f32_16x16x32_bf16 v[136:139], v[104:107], a[224:227], v[136:139]
    v_mfma_f32_16x16x32_bf16 v[136:139], v[108:111], a[240:243], v[136:139]
    s_add_u32 s61, s59, 325632
    buffer_load_dwordx4 v[96:99], v2, s[24:27], s61 offen offset:0
    v_mfma_f32_16x16x32_bf16 v[140:143], v[104:107], a[228:231], v[140:143]
    v_mfma_f32_16x16x32_bf16 v[140:143], v[108:111], a[244:247], v[140:143]
    s_add_u32 s50, s56, 4096
    buffer_load_dwordx4 v[160:163], v2, s[24:27], s50 offen sc1
    v_mfma_f32_16x16x32_bf16 v[144:147], v[104:107], a[232:235], v[144:147]
    v_mfma_f32_16x16x32_bf16 v[144:147], v[108:111], a[248:251], v[144:147]
    buffer_load_dwordx4 v[100:103], v2, s[24:27], s61 offen offset:1024
    v_mfma_f32_16x16x32_bf16 v[148:151], v[104:107], a[236:239], v[148:151]
    v_mfma_f32_16x16x32_bf16 v[148:151], v[108:111], a[252:255], v[148:151]
    s_waitcnt vmcnt(19)
    v_mfma_f32_16x16x32_bf16 v[136:139], v[112:115], v[16:19], v[136:139]
    v_mfma_f32_16x16x32_bf16 v[136:139], v[116:119], v[32:35], v[136:139]
    buffer_load_dwordx4 v[104:107], v2, s[24:27], s61 offen offset:2048
    v_mfma_f32_16x16x32_bf16 v[140:143], v[112:115], v[20:23], v[140:143]
L_pg10:
    s_cbranch_execz L_tourx
    v_mfma_f32_16x16x32_bf16 v[140:143], v[116:119], v[36:39], v[140:143]
    s_waitcnt vmcnt(12)
    buffer_atomic_add v13, v254, s[24:27], s48 offen offset:1536 sc1
    s_add_u32 s50, s56, 6144
    buffer_load_dwordx4 v[164:167], v2, s[24:27], s50 offen sc1
    v_mfma_f32_16x16x32_bf16 v[144:147], v[112:115], v[24:27], v[144:147]
    v_mfma_f32_16x16x32_bf16 v[144:147], v[116:119], v[40:43], v[144:147]
    buffer_load_dwordx4 v[108:111], v2, s[24:27], s61 offen offset:3072
    v_mfma_f32_16x16x32_bf16 v[148:151], v[112:115], v[28:31], v[148:151]
    v_mfma_f32_16x16x32_bf16 v[148:151], v[116:119], v[44:47], v[148:151]
    v_mfma_f32_16x16x32_bf16 v[120:123], v[48:51], a[0:3], 0
    v_cvt_pk_bf16_f32 v214, v136, v137
    v_cvt_pk_bf16_f32 v215, v138, v139
    v_mfma_f32_16x16x32_bf16 v[120:123], v[52:55], a[16:19], v[120:123]
    s_add_u32 s61, s59, 329728
    buffer_load_dwordx4 v[112:115], v2, s[24:27], s61 offen offset:0
    v_mfma_f32_16x16x32_bf16 v[124:127], v[48:51], a[4:7], 0
    v_cvt_pk_bf16_f32 v216, v140, v141
    v_cvt_pk_bf16_f32 v217, v142, v143
    v_mfma_f32_16x16x32_bf16 v[124:127], v[52:55], a[20:23], v[124:127]
    buffer_store_dwordx4 v[214:217], v239, s[24:27], s77 offen offset:0 sc1
    ds_write_b128 v241, v[214:217] offset:1792
    s_add_u32 s50, s56, 8192
    buffer_load_dwordx4 v[168:171], v2, s[24:27], s50 offen sc1
    v_mfma_f32_16x16x32_bf16 v[128:131], v[48:51], a[8:11], 0
    v_mfma_f32_16x16x32_bf16 v[128:131], v[52:55], a[24:27], v[128:131]
    buffer_load_dwordx4 v[116:119], v2, s[24:27], s61 offen offset:1024
    v_mfma_f32_16x16x32_bf16 v[132:135], v[48:51], a[12:15], 0
    v_mfma_f32_16x16x32_bf16 v[132:135], v[52:55], a[28:31], v[132:135]
    v_mfma_f32_16x16x32_bf16 v[120:123], v[56:59], a[32:35], v[120:123]
    v_mfma_f32_16x16x32_bf16 v[120:123], v[60:63], a[48:51], v[120:123]
    v_mfma_f32_16x16x32_bf16 v[124:127], v[56:59], a[36:39], v[124:127]
    v_mfma_f32_16x16x32_bf16 v[124:127], v[60:63], a[52:55], v[124:127]
    s_add_u32 s50, s56, 10240
    buffer_load_dwordx4 v[172:175], v2, s[24:27], s50 offen sc1
    v_mfma_f32_16x16x32_bf16 v[128:131], v[56:59], a[40:43], v[128:131]
    v_mfma_f32_16x16x32_bf16 v[128:131], v[60:63], a[56:59], v[128:131]
    v_mfma_f32_16x16x32_bf16 v[132:135], v[56:59], a[44:47], v[132:135]
    v_mfma_f32_16x16x32_bf16 v[132:135], v[60:63], a[60:63], v[132:135]
    s_waitcnt vmcnt(19)
    v_mfma_f32_16x16x32_bf16 v[120:123], v[64:67], a[64:67], v[120:123]
    v_mfma_f32_16x16x32_bf16 v[120:123], v[68:71], a[80:83], v[120:123]
    v_mfma_f32_16x16x32_bf16 v[124:127], v[64:67], a[68:71], v[124:127]
    v_mfma_f32_16x16x32_bf16 v[124:127], v[68:71], a[84:87], v[124:127]
    s_add_u32 s50, s56, 12288
    buffer_load_dwordx4 v[176:179], v2, s[24:27], s50 offen sc1
    v_mfma_f32_16x16x32_bf16 v[128:131], v[64:67], a[72:75], v[128:131]
    v_mfma_f32_16x16x32_bf16 v[128:131], v[68:71], a[88:91], v[128:131]
    v_mfma_f32_16x16x32_bf16 v[132:135], v[64:67], a[76:79], v[132:135]
    v_mfma_f32_16x16x32_bf16 v[132:135], v[68:71], a[92:95], v[132:135]
    s_waitcnt vmcnt(18)
    v_mfma_f32_16x16x32_bf16 v[120:123], v[72:75], a[96:99], v[120:123]
    v_cvt_pk_bf16_f32 v218, v144, v145
    v_cvt_pk_bf16_f32 v219, v146, v147
    v_mfma_f32_16x16x32_bf16 v[120:123], v[76:79], a[112:115], v[120:123]
    v_cvt_pk_bf16_f32 v220, v148, v149
    v_cvt_pk_bf16_f32 v221, v150, v151
    v_mfma_f32_16x16x32_bf16 v[124:127], v[72:75], a[100:103], v[124:127]
    v_mfma_f32_16x16x32_bf16 v[124:127], v[76:79], a[116:119], v[124:127]
    buffer_store_dwordx4 v[218:221], v240, s[24:27], s77 offen offset:0 sc1
    ds_write_b128 v242, v[218:221] offset:1792
    s_add_u32 s50, s56, 14336
    buffer_load_dwordx4 v[180:183], v2, s[24:27], s50 offen sc1
    v_mfma_f32_16x16x32_bf16 v[128:131], v[72:75], a[104:107], v[128:131]
    v_mfma_f32_16x16x32_bf16 v[128:131], v[76:79], a[120:123], v[128:131]
    v_mfma_f32_16x16x32_bf16 v[132:135], v[72:75], a[108:111], v[132:135]
    v_mfma_f32_16x16x32_bf16 v[132:135], v[76:79], a[124:127], v[132:135]
    s_waitcnt vmcnt(18)
    v_mfma_f32_16x16x32_bf16 v[120:123], v[80:83], a[128:131], v[120:123]
    v_mfma_f32_16x16x32_bf16 v[120:123], v[84:87], a[144:147], v[120:123]
    v_mfma_f32_16x16x32_bf16 v[124:127], v[80:83], a[132:135], v[124:127]
    v_mfma_f32_16x16x32_bf16 v[124:127], v[84:87], a[148:151], v[124:127]
    v_mfma_f32_16x16x32_bf16 v[128:131], v[80:83], a[136:139], v[128:131]
    v_mfma_f32_16x16x32_bf16 v[128:131], v[84:87], a[152:155], v[128:131]
    v_mfma_f32_16x16x32_bf16 v[132:135], v[80:83], a[140:143], v[132:135]
    v_mfma_f32_16x16x32_bf16 v[132:135], v[84:87], a[156:159], v[132:135]
    s_waitcnt vmcnt(15)
    v_mfma_f32_16x16x32_bf16 v[120:123], v[88:91], a[160:163], v[120:123]
    v_mfma_f32_16x16x32_bf16 v[120:123], v[92:95], a[176:179], v[120:123]
    v_mfma_f32_16x16x32_bf16 v[124:127], v[88:91], a[164:167], v[124:127]
    v_mfma_f32_16x16x32_bf16 v[124:127], v[92:95], a[180:183], v[124:127]
    v_mfma_f32_16x16x32_bf16 v[128:131], v[88:91], a[168:171], v[128:131]
    v_mfma_f32_16x16x32_bf16 v[128:131], v[92:95], a[184:187], v[128:131]
    v_mfma_f32_16x16x32_bf16 v[132:135], v[88:91], a[172:175], v[132:135]
    v_mfma_f32_16x16x32_bf16 v[132:135], v[92:95], a[188:191], v[132:135]
    s_waitcnt vmcnt(12)
    v_mfma_f32_16x16x32_bf16 v[120:123], v[96:99], a[192:195], v[120:123]
    v_mfma_f32_16x16x32_bf16 v[120:123], v[100:103], a[208:211], v[120:123]
    v_mfma_f32_16x16x32_bf16 v[124:127], v[96:99], a[196:199], v[124:127]
    v_mfma_f32_16x16x32_bf16 v[124:127], v[100:103], a[212:215], v[124:127]
    v_mfma_f32_16x16x32_bf16 v[128:131], v[96:99], a[200:203], v[128:131]
    v_mfma_f32_16x16x32_bf16 v[128:131], v[100:103], a[216:219], v[128:131]
    v_mfma_f32_16x16x32_bf16 v[132:135], v[96:99], a[204:207], v[132:135]
    v_mfma_f32_16x16x32_bf16 v[132:135], v[100:103], a[220:223], v[132:135]
    s_waitcnt vmcnt(8)
    v_mov_b32 v11, 0
    buffer_atomic_add v11, v254, s[24:27], s48 offen offset:1536 sc0 sc1
    v_mfma_f32_16x16x32_bf16 v[120:123], v[104:107], a[224:227], v[120:123]
    v_mfma_f32_16x16x32_bf16 v[120:123], v[108:111], a[240:243], v[120:123]
    v_mfma_f32_16x16x32_bf16 v[124:127], v[104:107], a[228:231], v[124:127]
    v_mfma_f32_16x16x32_bf16 v[124:127], v[108:111], a[244:247], v[124:127]
    v_mfma_f32_16x16x32_bf16 v[128:131], v[104:107], a[232:235], v[128:131]
    v_mfma_f32_16x16x32_bf16 v[128:131], v[108:111], a[248:251], v[128:131]
    v_mfma_f32_16x16x32_bf16 v[132:135], v[104:107], a[236:239], v[132:135]
    v_mfma_f32_16x16x32_bf16 v[132:135], v[108:111], a[252:255], v[132:135]
    s_waitcnt vmcnt(5)
    v_mfma_f32_16x16x32_bf16 v[120:123], v[112:115], v[16:19], v[120:123]
    v_mfma_f32_16x16x32_bf16 v[120:123], v[116:119], v[32:35], v[120:123]
    v_mfma_f32_16x16x32_bf16 v[124:127], v[112:115], v[20:23], v[124:127]
    v_mfma_f32_16x16x32_bf16 v[124:127], v[116:119], v[36:39], v[124:127]
    v_mfma_f32_16x16x32_bf16 v[128:131], v[112:115], v[24:27], v[128:131]
    v_mfma_f32_16x16x32_bf16 v[128:131], v[116:119], v[40:43], v[128:131]
    v_mfma_f32_16x16x32_bf16 v[132:135], v[112:115], v[28:31], v[132:135]
    v_mfma_f32_16x16x32_bf16 v[132:135], v[116:119], v[44:47], v[132:135]
    s_nop 1
    s_nop 1
    v_cvt_pk_bf16_f32 v206, v120, v121
    v_cvt_pk_bf16_f32 v207, v122, v123
    v_cvt_pk_bf16_f32 v208, v124, v125
    v_cvt_pk_bf16_f32 v209, v126, v127
    buffer_store_dwordx4 v[206:209], v239, s[24:27], s77 offen offset:256 sc1
    ds_write_b128 v241, v[206:209] offset:2048
    v_cvt_pk_bf16_f32 v210, v128, v129
    v_cvt_pk_bf16_f32 v211, v130, v131
    v_cvt_pk_bf16_f32 v212, v132, v133
    v_cvt_pk_bf16_f32 v213, v134, v135
    buffer_store_dwordx4 v[210:213], v240, s[24:27], s77 offen offset:256 sc1
    ds_write_b128 v242, v[210:213] offset:2048
    ds_read_b128 v[152:155], v236
    ds_read_b128 v[48:51], v236 offset:1024
    ds_read_b128 v[96:99], v236 offset:1792
    s_waitcnt vmcnt(2)
    v_readfirstlane_b32 s66, v11
    s_cmp_ge_u32 s66, 8
    s_cbranch_scc0 L_b0
    s_call_b64 s[84:85], L_bload
L_b0:
    s_waitcnt lgkmcnt(0)
    v_lshlrev_b32 v136, 16, v152
    v_and_b32 v137, 0xffff0000, v152
    v_lshlrev_b32_e64 v138, 16, v153
    v_and_b32 v139, 0xffff0000, v153
    v_lshlrev_b32_e64 v140, 16, v154
    v_and_b32 v141, 0xffff0000, v154
    v_lshlrev_b32_e64 v142, 16, v155
    v_and_b32 v143, 0xffff0000, v155
    v_lshlrev_b32_e64 v222, 16, v156
    v_and_b32 v223, 0xffff0000, v156
    v_pk_add_f32 v[136:137], v[136:137], v[222:223]
    v_lshlrev_b32_e64 v224, 16, v157
    v_and_b32 v225, 0xffff0000, v157
    v_pk_add_f32 v[138:139], v[138:139], v[224:225]
    v_lshlrev_b32_e64 v222, 16, v158
    v_and_b32 v223, 0xffff0000, v158
    v_pk_add_f32 v[140:141], v[140:141], v[222:223]
    v_lshlrev_b32_e64 v224, 16, v159
    v_and_b32 v225, 0xffff0000, v159
    v_pk_add_f32 v[142:143], v[142:143], v[224:225]
    v_lshlrev_b32_e64 v222, 16, v160
    v_and_b32 v223, 0xffff0000, v160
    v_pk_add_f32 v[136:137], v[136:137], v[222:223]
    v_lshlrev_b32_e64 v224, 16, v161
    v_and_b32 v225, 0xffff0000, v161
    v_pk_add_f32 v[138:139], v[138:139], v[224:225]
    v_lshlrev_b32_e64 v222, 16, v162
    v_and_b32 v223, 0xffff0000, v162
    v_pk_add_f32 v[140:141], v[140:141], v[222:223]
    v_lshlrev_b32_e64 v224, 16, v163
    v_and_b32 v225, 0xffff0000, v163
    v_pk_add_f32 v[142:143], v[142:143], v[224:225]
    v_lshlrev_b32_e64 v222, 16, v164
    v_and_b32 v223, 0xffff0000, v164
    v_pk_add_f32 v[136:137], v[136:137], v[222:223]
    v_lshlrev_b32_e64 v224, 16, v165
    v_and_b32 v225, 0xffff0000, v165
    v_pk_add_f32 v[138:139], v[138:139], v[224:225]
    v_lshlrev_b32_e64 v222, 16, v166
    v_and_b32 v223, 0xffff0000, v166
    v_pk_add_f32 v[140:141], v[140:141], v[222:223]
    v_lshlrev_b32_e64 v224, 16, v167
    v_and_b32 v225, 0xffff0000, v167
    v_pk_add_f32 v[142:143], v[142:143], v[224:225]
    v_lshlrev_b32_e64 v222, 16, v168
    v_and_b32 v223, 0xffff0000, v168
    v_pk_add_f32 v[136:137], v[136:137], v[222:223]
    v_lshlrev_b32_e64 v224, 16, v169
    v_and_b32 v225, 0xffff0000, v169
    v_pk_add_f32 v[138:139], v[138:139], v[224:225]
    v_lshlrev_b32_e64 v222, 16, v170
    v_and_b32 v223, 0xffff0000, v170
    v_pk_add_f32 v[140:141], v[140:141], v[222:223]
    v_lshlrev_b32_e64 v224, 16, v171
    v_and_b32 v225, 0xffff0000, v171
    v_pk_add_f32 v[142:143], v[142:143], v[224:225]
    v_lshlrev_b32_e64 v222, 16, v172
    v_and_b32 v223, 0xffff0000, v172
    v_pk_add_f32 v[136:137], v[136:137], v[222:223]
    v_lshlrev_b32_e64 v224, 16, v173
    v_and_b32 v225, 0xffff0000, v173
    v_pk_add_f32 v[138:139], v[138:139], v[224:225]
    v_lshlrev_b32_e64 v222, 16, v174
    v_and_b32 v223, 0xffff0000, v174
    v_pk_add_f32 v[140:141], v[140:141], v[222:223]
    v_lshlrev_b32_e64 v224, 16, v175
    v_and_b32 v225, 0xffff0000, v175
    v_pk_add_f32 v[142:143], v[142:143], v[224:225]
    s_cmp_ge_u32 s66, 8
    s_cbranch_scc0 L_b1
    s_waitcnt vmcnt(7)
    v_mov_b32 v11, 1
    buffer_atomic_add v11, v254, s[24:27], s48 offen offset:2048 sc0 sc1
    s_mov_b32 s67, 7
    s_branch L_b2
L_bload:
    s_add_u32 s50, s56, 0
    buffer_load_dwordx4 v[52:55], v14, s[24:27], s50 offen offset:3072 sc1
    s_add_u32 s50, s56, 4096
    buffer_load_dwordx4 v[56:59], v14, s[24:27], s50 offen offset:1024 sc1
    buffer_load_dwordx4 v[60:63], v14, s[24:27], s50 offen offset:3072 sc1
    s_add_u32 s50, s56, 8192
    buffer_load_dwordx4 v[64:67], v14, s[24:27], s50 offen offset:1024 sc1
    buffer_load_dwordx4 v[68:71], v14, s[24:27], s50 offen offset:3072 sc1
    s_add_u32 s50, s56, 12288
    buffer_load_dwordx4 v[72:75], v14, s[24:27], s50 offen offset:1024 sc1
    buffer_load_dwordx4 v[76:79], v14, s[24:27], s50 offen offset:3072 sc1
    s_setpc_b64 s[84:85]
L_b1:
    s_waitcnt vmcnt(0)
    buffer_atomic_add v13, v254, s[24:27], s48 offen offset:2048 sc1
    v_readfirstlane_b32 s50, v11
    s_mov_b32 s49, 0
    s_cmp_ge_u32 s50, 8
    s_cbranch_scc1 spout_14
spin_13:
    v_mov_b32 v11, 0
    buffer_atomic_add v11, v254, s[24:27], s48 offen offset:1536 sc0 sc1
    s_add_u32 s49, s49, 1
    s_waitcnt vmcnt(0)
    v_readfirstlane_b32 s50, v11
    s_cmp_ge_u32 s49, 262144
    s_cbranch_scc1 spout_14
    s_cmp_ge_u32 s50, 8
    s_cbranch_scc0 spin_13
spout_14:
    s_call_b64 s[84:85], L_bload
    v_mov_b32 v11, 0
    buffer_atomic_add v11, v254, s[24:27], s48 offen offset:2048 sc0 sc1
    s_mov_b32 s67, 8
L_b2:
    v_lshlrev_b32 v222, 16, v176
    v_and_b32 v223, 0xffff0000, v176
    v_pk_add_f32 v[136:137], v[136:137], v[222:223]
    v_lshlrev_b32_e64 v224, 16, v177
    v_and_b32 v225, 0xffff0000, v177
    v_pk_add_f32 v[138:139], v[138:139], v[224:225]
    v_lshlrev_b32_e64 v222, 16, v178
    v_and_b32 v223, 0xffff0000, v178
    v_pk_add_f32 v[140:141], v[140:141], v[222:223]
    v_lshlrev_b32_e64 v224, 16, v179
    v_and_b32 v225, 0xffff0000, v179
    v_pk_add_f32 v[142:143], v[142:143], v[224:225]
    v_lshlrev_b32_e64 v222, 16, v180
    v_and_b32 v223, 0xffff0000, v180
    v_pk_add_f32 v[136:137], v[136:137], v[222:223]
    v_lshlrev_b32_e64 v224, 16, v181
    v_and_b32 v225, 0xffff0000, v181
    v_pk_add_f32 v[138:139], v[138:139], v[224:225]
    v_lshlrev_b32_e64 v222, 16, v182
    v_and_b32 v223, 0xffff0000, v182
    v_pk_add_f32 v[140:141], v[140:141], v[222:223]
    v_lshlrev_b32_e64 v224, 16, v183
    v_and_b32 v225, 0xffff0000, v183
    v_pk_add_f32 v[142:143], v[142:143], v[224:225]
    ds_write_b32 v3, v136 offset:0
    ds_write_b32 v3, v137 offset:32
    ds_write_b32 v3, v138 offset:64
    ds_write_b32 v3, v139 offset:96
    ds_write_b32 v3, v140 offset:10496
    ds_write_b32 v3, v141 offset:10528
    ds_write_b32 v3, v142 offset:10560
    ds_write_b32 v3, v143 offset:10592
    v_lshlrev_b32_e64 v16, 16, v184
    v_and_b32 v17, 0xffff0000, v184
    v_lshlrev_b32_e64 v222, 16, v194
    v_and_b32 v223, 0xffff0000, v194
    v_pk_add_f32 v[16:17], v[16:17], v[222:223]
    v_lshlrev_b32_e64 v18, 16, v185
    v_and_b32 v19, 0xffff0000, v185
    v_lshlrev_b32_e64 v224, 16, v195
    v_and_b32 v225, 0xffff0000, v195
    v_pk_add_f32 v[18:19], v[18:19], v[224:225]
    v_lshlrev_b32_e64 v20, 16, v186
    v_and_b32 v21, 0xffff0000, v186
    v_lshlrev_b32_e64 v222, 16, v196
    v_and_b32 v223, 0xffff0000, v196
    v_pk_add_f32 v[20:21], v[20:21], v[222:223]
    v_lshlrev_b32_e64 v22, 16, v187
    v_and_b32 v23, 0xffff0000, v187
    v_lshlrev_b32_e64 v224, 16, v197
    v_and_b32 v225, 0xffff0000, v197
    v_pk_add_f32 v[22:23], v[22:23], v[224:225]
    v_lshlrev_b32_e64 v24, 16, v188
    v_and_b32 v25, 0xffff0000, v188
    v_lshlrev_b32_e64 v222, 16, v198
    v_and_b32 v223, 0xffff0000, v198
    v_pk_add_f32 v[24:25], v[24:25], v[222:223]
    v_lshlrev_b32_e64 v26, 16, v189
    v_and_b32 v27, 0xffff0000, v189
    v_lshlrev_b32_e64 v224, 16, v199
    v_and_b32 v225, 0xffff0000, v199
    v_pk_add_f32 v[26:27], v[26:27], v[224:225]
    v_lshlrev_b32_e64 v28, 16, v190
    v_and_b32 v29, 0xffff0000, v190
    v_lshlrev_b32_e64 v222, 16, v200
    v_and_b32 v223, 0xffff0000, v200
    v_pk_add_f32 v[28:29], v[28:29], v[222:223]
    v_lshlrev_b32_e64 v30, 16, v191
    v_and_b32 v31, 0xffff0000, v191
    v_lshlrev_b32_e64 v224, 16, v201
    v_and_b32 v225, 0xffff0000, v201
    v_pk_add_f32 v[30:31], v[30:31], v[224:225]
    v_lshlrev_b32_e64 v32, 16, v192
    v_and_b32 v33, 0xffff0000, v192
    v_lshlrev_b32_e64 v222, 16, v202
    v_and_b32 v223, 0xffff0000, v202
    v_pk_add_f32 v[32:33], v[32:33], v[222:223]
    v_lshlrev_b32_e64 v34, 16, v193
    v_and_b32 v35, 0xffff0000, v193
    v_lshlrev_b32_e64 v224, 16, v203
    v_and_b32 v225, 0xffff0000, v203
    v_pk_add_f32 v[34:35], v[34:35], v[224:225]
    s_waitcnt vmcnt(0)
    v_readfirstlane_b32 s50, v11
    s_mov_b32 s49, 0
    s_cmp_ge_u32 s50, s67
    s_cbranch_scc1 spout_16
spin_15:
    v_mov_b32 v11, 0
    buffer_atomic_add v11, v254, s[24:27], s48 offen offset:2048 sc0 sc1
    s_add_u32 s49, s49, 1
    s_waitcnt vmcnt(0)
    v_readfirstlane_b32 s50, v11
    s_cmp_ge_u32 s49, 262144
    s_cbranch_scc1 spout_16
    s_cmp_ge_u32 s50, 8
    s_cbranch_scc0 spin_15
spout_16:
    s_add_u32 s50, s56, 16384
    buffer_load_dwordx4 v[80:83], v10, s[24:27], s50 offen offset:0 sc1
    buffer_load_dwordx4 v[84:87], v2, s[24:27], s50 offen offset:1024 sc1
    buffer_load_dwordx4 v[88:91], v2, s[24:27], s50 offen offset:2048 sc1
    buffer_load_dwordx4 v[92:95], v2, s[24:27], s50 offen offset:3072 sc1
    v_lshlrev_b32_e64 v144, 16, v48
    v_and_b32 v145, 0xffff0000, v48
    v_lshlrev_b32_e64 v146, 16, v49
    v_and_b32 v147, 0xffff0000, v49
    v_lshlrev_b32_e64 v148, 16, v50
    v_and_b32 v149, 0xffff0000, v50
    v_lshlrev_b32_e64 v150, 16, v51
    v_and_b32 v151, 0xffff0000, v51
    v_lshlrev_b32_e64 v222, 16, v52
    v_and_b32 v223, 0xffff0000, v52
    v_pk_add_f32 v[144:145], v[144:145], v[222:223]
    v_lshlrev_b32_e64 v224, 16, v53
    v_and_b32 v225, 0xffff0000, v53
    v_pk_add_f32 v[146:147], v[146:147], v[224:225]
    v_lshlrev_b32_e64 v222, 16, v54
    v_and_b32 v223, 0xffff0000, v54
    v_pk_add_f32 v[148:149], v[148:149], v[222:223]
    v_lshlrev_b32_e64 v224, 16, v55
    v_and_b32 v225, 0xffff0000, v55
    v_pk_add_f32 v[150:151], v[150:151], v[224:225]
    v_lshlrev_b32_e64 v222, 16, v56
    v_and_b32 v223, 0xffff0000, v56
    v_pk_add_f32 v[144:145], v[144:145], v[222:223]
    v_lshlrev_b32_e64 v224, 16, v57
    v_and_b32 v225, 0xffff0000, v57
    v_pk_add_f32 v[146:147], v[146:147], v[224:225]
    v_lshlrev_b32_e64 v222, 16, v58
    v_and_b32 v223, 0xffff0000, v58
    v_pk_add_f32 v[148:149], v[148:149], v[222:223]
    v_lshlrev_b32_e64 v224, 16, v59
    v_and_b32 v225, 0xffff0000, v59
    v_pk_add_f32 v[150:151], v[150:151], v[224:225]
    v_lshlrev_b32_e64 v222, 16, v60
    v_and_b32 v223, 0xffff0000, v60
    v_pk_add_f32 v[144:145], v[144:145], v[222:223]
    v_lshlrev_b32_e64 v224, 16, v61
    v_and_b32 v225, 0xffff0000, v61
    v_pk_add_f32 v[146:147], v[146:147], v[224:225]
    v_lshlrev_b32_e64 v222, 16, v62
    v_and_b32 v223, 0xffff0000, v62
    v_pk_add_f32 v[148:149], v[148:149], v[222:223]
    v_lshlrev_b32_e64 v224, 16, v63
    v_and_b32 v225, 0xffff0000, v63
    v_pk_add_f32 v[150:151], v[150:151], v[224:225]
    v_lshlrev_b32_e64 v222, 16, v64
    v_and_b32 v223, 0xffff0000, v64
    v_pk_add_f32 v[144:145], v[144:145], v[222:223]
    v_lshlrev_b32_e64 v224, 16, v65
    v_and_b32 v225, 0xffff0000, v65
    v_pk_add_f32 v[146:147], v[146:147], v[224:225]
    v_lshlrev_b32_e64 v222, 16, v66
    v_and_b32 v223, 0xffff0000, v66
    v_pk_add_f32 v[148:149], v[148:149], v[222:223]
    v_lshlrev_b32_e64 v224, 16, v67
    v_and_b32 v225, 0xffff0000, v67
    v_pk_add_f32 v[150:151], v[150:151], v[224:225]
    v_lshlrev_b32_e64 v222, 16, v68
    v_and_b32 v223, 0xffff0000, v68
    v_pk_add_f32 v[144:145], v[144:145], v[222:223]
    v_lshlrev_b32_e64 v224, 16, v69
    v_and_b32 v225, 0xffff0000, v69
    v_pk_add_f32 v[146:147], v[146:147], v[224:225]
    v_lshlrev_b32_e64 v222, 16, v70
    v_and_b32 v223, 0xffff0000, v70
    v_pk_add_f32 v[148:149], v[148:149], v[222:223]
    v_lshlrev_b32_e64 v224, 16, v71
    v_and_b32 v225, 0xffff0000, v71
    v_pk_add_f32 v[150:151], v[150:151], v[224:225]
    v_lshlrev_b32_e64 v222, 16, v72
    v_and_b32 v223, 0xffff0000, v72
    v_pk_add_f32 v[144:145], v[144:145], v[222:223]
    v_lshlrev_b32_e64 v224, 16, v73
    v_and_b32 v225, 0xffff0000, v73
    v_pk_add_f32 v[146:147], v[146:147], v[224:225]
    v_lshlrev_b32_e64 v222, 16, v74
    v_and_b32 v223, 0xffff0000, v74
    v_pk_add_f32 v[148:149], v[148:149], v[222:223]
    v_lshlrev_b32_e64 v224, 16, v75
    v_and_b32 v225, 0xffff0000, v75
    v_pk_add_f32 v[150:151], v[150:151], v[224:225]
    v_lshlrev_b32_e64 v222, 16, v76
    v_and_b32 v223, 0xffff0000, v76
    v_pk_add_f32 v[144:145], v[144:145], v[222:223]
    v_lshlrev_b32_e64 v224, 16, v77
    v_and_b32 v225, 0xffff0000, v77
    v_pk_add_f32 v[146:147], v[146:147], v[224:225]
    v_lshlrev_b32_e64 v222, 16, v78
    v_and_b32 v223, 0xffff0000, v78
    v_pk_add_f32 v[148:149], v[148:149], v[222:223]
    v_lshlrev_b32_e64 v224, 16, v79
    v_and_b32 v225, 0xffff0000, v79
    v_pk_add_f32 v[150:151], v[150:151], v[224:225]
    ds_write_b32 v3, v144 offset:1152
    ds_write_b32 v3, v145 offset:1184
    ds_write_b32 v3, v146 offset:1216
    ds_write_b32 v3, v147 offset:1248
    ds_write_b32 v3, v148 offset:11648
    ds_write_b32 v3, v149 offset:11680
    ds_write_b32 v3, v150 offset:11712
    ds_write_b32 v3, v151 offset:11744
    s_mov_b32 exec_lo, 0
    v_mov_b32 v96, 0
    v_mov_b32 v97, 0
    v_mov_b32 v98, 0
    v_mov_b32 v99, 0
    s_mov_b32 exec_lo, -1
    v_lshlrev_b32_e64 v136, 16, v96
    v_and_b32 v137, 0xffff0000, v96
    v_lshlrev_b32_e64 v138, 16, v97
    v_and_b32 v139, 0xffff0000, v97
    v_lshlrev_b32_e64 v140, 16, v98
    v_and_b32 v141, 0xffff0000, v98
    v_lshlrev_b32_e64 v142, 16, v99
    v_and_b32 v143, 0xffff0000, v99
    s_waitcnt lgkmcnt(0)
    s_barrier
    ds_read_b128 v[100:103], v5 offset:0
    ds_read_b128 v[104:107], v5 offset:16
    ds_read_b128 v[108:111], v5 offset:1152
    ds_read_b128 v[112:115], v5 offset:1168
    s_waitcnt lgkmcnt(2)
    v_pk_add_f32 v[100:101], v[100:101], v[16:17]
    v_pk_add_f32 v[102:103], v[102:103], v[18:19]
    v_pk_add_f32 v[104:105], v[104:105], v[20:21]
    v_pk_add_f32 v[106:107], v[106:107], v[22:23]
    v_cvt_pk_bf16_f32 v48, v100, v101
    v_cvt_pk_bf16_f32 v49, v102, v103
    v_cvt_pk_bf16_f32 v50, v104, v105
    v_cvt_pk_bf16_f32 v51, v106, v107
    buffer_store_dwordx4 v[48:51], v245, s[28:31], s57 offen offset:0
    s_waitcnt lgkmcnt(0)
    v_pk_add_f32 v[108:109], v[108:109], v[24:25]
    v_pk_add_f32 v[110:111], v[110:111], v[26:27]
    v_pk_add_f32 v[112:113], v[112:113], v[28:29]
    v_pk_add_f32 v[114:115], v[114:115], v[30:31]
    v_cvt_pk_bf16_f32 v52, v108, v109
    v_cvt_pk_bf16_f32 v53, v110, v111
    v_cvt_pk_bf16_f32 v54, v112, v113
    v_cvt_pk_bf16_f32 v55, v114, v115
    buffer_store_dwordx4 v[52:55], v246, s[28:31], s57 offen offset:512
    s_waitcnt vmcnt(5)
    v_lshlrev_b32 v222, 16, v80
    v_and_b32 v223, 0xffff0000, v80
    v_pk_add_f32 v[136:137], v[136:137], v[222:223]
    v_lshlrev_b32_e64 v224, 16, v81
    v_and_b32 v225, 0xffff0000, v81
    v_pk_add_f32 v[138:139], v[138:139], v[224:225]
    v_lshlrev_b32_e64 v222, 16, v82
    v_and_b32 v223, 0xffff0000, v82
    v_pk_add_f32 v[140:141], v[140:141], v[222:223]
    v_lshlrev_b32_e64 v224, 16, v83
    v_and_b32 v225, 0xffff0000, v83
    v_pk_add_f32 v[142:143], v[142:143], v[224:225]
    s_waitcnt vmcnt(4)
    v_lshlrev_b32 v222, 16, v84
    v_and_b32 v223, 0xffff0000, v84
    v_pk_add_f32 v[136:137], v[136:137], v[222:223]
    v_lshlrev_b32_e64 v224, 16, v85
    v_and_b32 v225, 0xffff0000, v85
    v_pk_add_f32 v[138:139], v[138:139], v[224:225]
    v_lshlrev_b32_e64 v222, 16, v86
    v_and_b32 v223, 0xffff0000, v86
    v_pk_add_f32 v[140:141], v[140:141], v[222:223]
    v_lshlrev_b32_e64 v224, 16, v87
    v_and_b32 v225, 0xffff0000, v87
    v_pk_add_f32 v[142:143], v[142:143], v[224:225]
    s_waitcnt vmcnt(3)
    v_lshlrev_b32 v222, 16, v88
    v_and_b32 v223, 0xffff0000, v88
    v_pk_add_f32 v[136:137], v[136:137], v[222:223]
    v_lshlrev_b32_e64 v224, 16, v89
    v_and_b32 v225, 0xffff0000, v89
    v_pk_add_f32 v[138:139], v[138:139], v[224:225]
    v_lshlrev_b32_e64 v222, 16, v90
    v_and_b32 v223, 0xffff0000, v90
    v_pk_add_f32 v[140:141], v[140:141], v[222:223]
    v_lshlrev_b32_e64 v224, 16, v91
    v_and_b32 v225, 0xffff0000, v91
    v_pk_add_f32 v[142:143], v[142:143], v[224:225]
    s_waitcnt vmcnt(2)
    v_lshlrev_b32 v222, 16, v92
    v_and_b32 v223, 0xffff0000, v92
    v_pk_add_f32 v[136:137], v[136:137], v[222:223]
    v_lshlrev_b32_e64 v224, 16, v93
    v_and_b32 v225, 0xffff0000, v93
    v_pk_add_f32 v[138:139], v[138:139], v[224:225]
    v_lshlrev_b32_e64 v222, 16, v94
    v_and_b32 v223, 0xffff0000, v94
    v_pk_add_f32 v[140:141], v[140:141], v[222:223]
    v_lshlrev_b32_e64 v224, 16, v95
    v_and_b32 v225, 0xffff0000, v95
    v_pk_add_f32 v[142:143], v[142:143], v[224:225]
    s_nop 1
    v_permlane32_swap_b32 v136, v140
    v_permlane32_swap_b32 v137, v141
    v_permlane32_swap_b32 v138, v142
    v_permlane32_swap_b32 v139, v143
    s_nop 0
    v_pk_add_f32 v[136:137], v[136:137], v[140:141]
    v_pk_add_f32 v[138:139], v[138:139], v[142:143]
    ds_write_b32 v4, v136 offset:2016
    ds_write_b32 v4, v137 offset:2048
    ds_write_b32 v4, v138 offset:2080
    ds_write_b32 v4, v139 offset:2112
    s_waitcnt lgkmcnt(0)
    s_barrier
    ds_read_b128 v[116:119], v6 offset:2016
L_pg11:
    s_cbranch_execz L_tourx
    s_waitcnt lgkmcnt(0)
    v_pk_add_f32 v[116:117], v[116:117], v[32:33]
    v_pk_add_f32 v[118:119], v[118:119], v[34:35]
    v_cvt_pk_bf16_f32 v56, v116, v117
    v_cvt_pk_bf16_f32 v57, v118, v119
    buffer_store_dwordx2 v[56:57], v247, s[28:31], s57 offen offset:896
    s_endpgm
L_helper2:
    v_lshrrev_b32 v10, 2, v1
    v_mul_u32_u24 v10, 288, v10
    v_and_b32_e64 v11, 3, v1
    v_lshl_add_u32 v9, v11, 3, v10
    v_bfe_u32 v10, v1, 3, 1
    v_and_b32 v11, 7, v1
    v_lshlrev_b32 v11, 7, v11
    v_lshl_or_b32 v11, v10, 10, v11
    v_lshrrev_b32 v10, 4, v1
    v_and_b32 v12, 6, v1
    v_xor_b32_e64 v10, v10, v12
    v_lshl_or_b32 v108, v10, 4, v11
    v_xor_b32_e64 v109, 64, v108
    v_mov_b32 v110, 163680
    s_mov_b32 s72, 0x00010001
    s_mov_b32 s73, 0x00010001
    s_mov_b32 s26, 67108864
    s_mov_b32 s27, 0x20000
    v_bfe_u32 v10, v1, 1, 1
    v_mul_u32_u24 v10, 9216, v10
    v_add_u32 v10, 128, v10
    v_add_u32_e64 v102, v10, v9
    s_mov_b32 s82, 0xcccccccc
    s_mov_b32 s83, 0xcccccccc
    v_mov_b32 v12, 0x3f803f80
    v_mov_b32 v13, 0x3f803f80
    v_mov_b32 v14, 0x3f803f80
    v_mov_b32 v15, 0x3f803f80
    v_min_u32 v10, 144, v2
    v_add_u32 v10, 163680, v10
    ds_write_b128 v10, v[12:15]
    s_cmp_eq_u32 s45, 0
    s_cbranch_scc0 L_h_nozero
    s_lshl_b32 s49, s44, 13
    v_mov_b32 v190, 0
    v_mov_b32 v191, 0
    v_mov_b32 v192, 0
    v_mov_b32_e64 v193, 0
    buffer_store_dwordx4 v[190:193], v2, s[24:27], s49 offen offset:0 sc1
    buffer_store_dwordx4 v[190:193], v2, s[24:27], s49 offen offset:1024 sc1
    buffer_store_dwordx4 v[190:193], v2, s[24:27], s49 offen offset:2048 sc1
    buffer_store_dwordx4 v[190:193], v2, s[24:27], s49 offen offset:3072 sc1
    buffer_store_dwordx4 v[190:193], v2, s[24:27], s49 offen offset:3584 sc1
L_h_nozero:
    v_add_u32 v104, 76240, v108
    v_add_u32 v105, 76240, v109
    v_add_u32 v98, 48544, v102
    v_cndmask_b32 v106, v104, v110, s[72:73]
    v_cndmask_b32 v107, v105, v110, s[72:73]
    v_add_u32 v99, 67136, v9
    v_add_u32 v100, 71744, v9
    v_cndmask_b32 v99, v99, v110, s[82:83]
    v_cndmask_b32 v100, v100, v110, s[82:83]
    s_lshl_b32 s65, s57, 7
    s_add_u32 s57, s57, 1
    s_cmp_eq_u32 s57, 9
    s_cselect_b32 s57, 0, s57
    s_add_u32 m0, s59, 86496
    s_nop 0
    buffer_load_dwordx4 v88, s[68:71], s65 offen offset:0 lds
    buffer_load_dwordx4 v89, s[68:71], s65 offen offset:1024 lds
    buffer_load_dwordx4 v90, s[68:71], s65 offen offset:2048 lds
    buffer_load_dwordx4 v91, s[68:71], s65 offen offset:3072 lds
    s_add_u32 m0, s59, 90592
    s_nop 0
    buffer_load_dwordx4 v92, s[68:71], s65 offen offset:0 lds
    buffer_load_dwordx4 v93, s[68:71], s65 offen offset:1024 lds
    buffer_load_dwordx4 v94, s[68:71], s65 offen offset:2048 lds
    buffer_load_dwordx4 v95, s[68:71], s65 offen offset:3072 lds
    s_add_u32 m0, s59, 94688
    s_nop 0
    buffer_load_dwordx4 v96, s[68:71], s65 offen offset:0 lds
    buffer_load_dwordx4 v97, s[68:71], s65 offen offset:1024 lds
    s_waitcnt vmcnt(10) lgkmcnt(0)
    s_barrier
    s_lshl_b32 s65, s57, 7
    s_add_u32 s57, s57, 1
    s_cmp_eq_u32 s57, 9
    s_cselect_b32 s57, 0, s57
    ds_read_b64_tr_b16 v[16:17], v98 offset:0
    ds_read_b64_tr_b16 v[18:19], v98 offset:144
    ds_read_b128 v[48:51], v106 offset:0
    ds_read_b128 v[52:55], v104 offset:2048
    ds_read_b128 v[56:59], v104 offset:4096
    ds_read_b128 v[60:63], v104 offset:6144
    ds_read_b128 v[64:67], v104 offset:8192
    ds_read_b64_tr_b16 v[20:21], v99 offset:0
    ds_read_b64_tr_b16 v[22:23], v99 offset:144
    s_add_u32 m0, s59, 124448
    s_nop 0
    buffer_load_dwordx4 v88, s[68:71], s65 offen offset:0 lds
    buffer_load_dwordx4 v89, s[68:71], s65 offen offset:1024 lds
    buffer_load_dwordx4 v90, s[68:71], s65 offen offset:2048 lds
    buffer_load_dwordx4 v91, s[68:71], s65 offen offset:3072 lds
    s_add_u32 m0, s59, 128544
    s_nop 0
    buffer_load_dwordx4 v92, s[68:71], s65 offen offset:0 lds
    s_mov_b32 s34, 256
    s_mov_b32 s35, 0x20000
    s_mov_b32 s18, 5308416
    s_mov_b32 s19, 0x20000
    s_mov_b32 s22, 5308416
    s_mov_b32 s23, 0x20000
    s_mov_b32 s14, 663552
    s_mov_b32 s15, 0x20000
    s_mov_b32 s38, 9216
    s_mov_b32 s39, 0x20000
    v_and_b32 v246, 7, v1
    v_lshlrev_b32 v246, 4, v246
    v_lshrrev_b32 v247, 3, v1
    v_mul_u32_u24 v248, 73728, v247
    v_add_u32 v224, v248, v246
    s_waitcnt lgkmcnt(0)
    v_mfma_f32_16x16x32_bf16 a[0:3], v[16:19], v[48:51], 0
    ds_read_b64_tr_b16 v[32:33], v98 offset:4608
    ds_read_b64_tr_b16 v[34:35], v98 offset:4752
    v_mfma_f32_16x16x32_bf16 a[4:7], v[16:19], v[52:55], 0
    ds_read_b128 v[68:71], v107 offset:0
    ds_read_b128 v[72:75], v105 offset:2048
    v_mfma_f32_16x16x32_bf16 a[8:11], v[16:19], v[56:59], 0
    ds_read_b128 v[76:79], v105 offset:4096
    ds_read_b128 v[80:83], v105 offset:6144
    v_mfma_f32_16x16x32_bf16 a[12:15], v[16:19], v[60:63], 0
    ds_read_b128 v[84:87], v105 offset:8192
    ds_read_b64_tr_b16 v[36:37], v100 offset:0
    v_mfma_f32_16x16x32_bf16 a[16:19], v[16:19], v[64:67], 0
    ds_read_b64_tr_b16 v[38:39], v100 offset:144
    buffer_load_dwordx4 v93, s[68:71], s65 offen offset:1024 lds
    v_mfma_f32_16x16x32_bf16 a[20:23], v[20:23], v[48:51], 0
    v_lshl_add_u32 v223, v247, 1, v246
    v_lshl_or_b32 v0, v247, 8, v246
    v_lshlrev_b32_e64 v225, 1, v1
    v_mfma_f32_16x16x32_bf16 a[24:27], v[20:23], v[52:55], 0
    buffer_load_dwordx4 v94, s[68:71], s65 offen offset:2048 lds
    v_bfe_u32 v248, v247, 1, 1
    v_and_or_b32 v248, v247, 4, v248
    v_mfma_f32_16x16x32_bf16 a[28:31], v[20:23], v[56:59], 0
    v_and_b32_e64 v247, 1, v247
    v_lshl_or_b32 v248, v247, 5, v248
    v_mul_u32_u24 v248, 1152, v248
    v_mfma_f32_16x16x32_bf16 a[32:35], v[20:23], v[60:63], 0
    buffer_load_dwordx4 v95, s[68:71], s65 offen offset:3072 lds
    v_add_u32_e64 v226, v248, v246
    s_mov_b32 s76, 0x05040100
    v_mfma_f32_16x16x32_bf16 a[36:39], v[20:23], v[64:67], 0
    s_mov_b32 s77, 0x07060302
    s_mul_i32 s78, s45, 1327104
    v_mfma_f32_16x16x32_bf16 a[40:43], v[48:51], v[48:51], 0
    s_add_u32 m0, s59, 132640
    s_nop 0
    buffer_load_dwordx4 v96, s[68:71], s65 offen offset:0 lds
    s_add_u32 s78, s78, 8388608
    s_lshl_b32 s66, s46, 5
    s_add_u32 s10, s66, s44
    v_mfma_f32_16x16x32_bf16 a[44:47], v[52:55], v[52:55], 0
    v_add_u32 v104, 114192, v108
    v_add_u32 v105, 114192, v109
    v_mfma_f32_16x16x32_bf16 a[48:51], v[56:59], v[56:59], 0
    buffer_load_dwordx4 v97, s[68:71], s65 offen offset:1024 lds
    v_add_u32 v98, 86496, v102
    v_cndmask_b32 v106, v104, v110, s[72:73]
    v_cndmask_b32 v107, v105, v110, s[72:73]
    v_mfma_f32_16x16x32_bf16 a[52:55], v[60:63], v[60:63], 0
    v_add_u32 v99, 105088, v9
    v_add_u32 v100, 109696, v9
    v_mfma_f32_16x16x32_bf16 a[56:59], v[64:67], v[64:67], 0
    v_cndmask_b32 v99, v99, v110, s[82:83]
    v_cndmask_b32 v100, v100, v110, s[82:83]
    s_waitcnt vmcnt(10) lgkmcnt(0)
    s_barrier
    s_lshl_b32 s65, s57, 7
    s_add_u32 s57, s57, 1
    s_cmp_eq_u32 s57, 9
    s_cselect_b32 s57, 0, s57
    v_mfma_f32_16x16x32_bf16 a[0:3], v[32:35], v[68:71], a[0:3]
    ds_read_b64_tr_b16 v[16:17], v98 offset:0
    ds_read_b64_tr_b16 v[18:19], v98 offset:144
    v_mfma_f32_16x16x32_bf16 a[4:7], v[32:35], v[72:75], a[4:7]
    ds_read_b128 v[48:51], v106 offset:0
    ds_read_b128 v[52:55], v104 offset:2048
    v_mfma_f32_16x16x32_bf16 a[8:11], v[32:35], v[76:79], a[8:11]
    ds_read_b128 v[56:59], v104 offset:4096
    ds_read_b128 v[60:63], v104 offset:6144
    v_mfma_f32_16x16x32_bf16 a[12:15], v[32:35], v[80:83], a[12:15]
    ds_read_b128 v[64:67], v104 offset:8192
    ds_read_b64_tr_b16 v[20:21], v99 offset:0
    v_mfma_f32_16x16x32_bf16 a[16:19], v[32:35], v[84:87], a[16:19]
    ds_read_b64_tr_b16 v[22:23], v99 offset:144
    s_add_u32 m0, s59, 48544
    s_nop 0
    buffer_load_dwordx4 v88, s[68:71], s65 offen offset:0 lds
    v_mfma_f32_16x16x32_bf16 a[20:23], v[36:39], v[68:71], a[20:23]
    s_sub_u32 s66, 127, s10
    s_mov_b32 s11, s66
    v_mfma_f32_16x16x32_bf16 a[24:27], v[36:39], v[72:75], a[24:27]
    buffer_load_dwordx4 v89, s[68:71], s65 offen offset:1024 lds
    s_mul_i32 s8, s66, 57
    v_mfma_f32_16x16x32_bf16 a[28:31], v[36:39], v[76:79], a[28:31]
    s_lshr_b32 s8, s8, 9
    s_mul_i32 s67, s8, 9
    v_mfma_f32_16x16x32_bf16 a[32:35], v[36:39], v[80:83], a[32:35]
    buffer_load_dwordx4 v90, s[68:71], s65 offen offset:2048 lds
    s_sub_u32 s9, s66, s67
    v_mfma_f32_16x16x32_bf16 a[36:39], v[36:39], v[84:87], a[36:39]
    s_mul_i32 s79, s45, 9
    s_add_u32 s79, s79, s9
    v_mfma_f32_16x16x32_bf16 a[40:43], v[68:71], v[68:71], a[40:43]
    buffer_load_dwordx4 v91, s[68:71], s65 offen offset:3072 lds
    s_mul_i32 s79, s79, 73728
    v_mfma_f32_16x16x32_bf16 a[44:47], v[72:75], v[72:75], a[44:47]
    s_lshl_b32 s67, s8, 7
    s_add_u32 s79, s79, s67
    v_mfma_f32_16x16x32_bf16 a[48:51], v[76:79], v[76:79], a[48:51]
    s_add_u32 m0, s59, 52640
    s_nop 0
    buffer_load_dwordx4 v92, s[68:71], s65 offen offset:0 lds
    s_lshl_b32 s64, s11, 11
    v_mfma_f32_16x16x32_bf16 a[52:55], v[80:83], v[80:83], a[52:55]
    s_add_u32 s64, s64, s78
    s_add_u32 s64, s64, 165888
    v_mfma_f32_16x16x32_bf16 a[56:59], v[84:87], v[84:87], a[56:59]
    s_cmp_lt_u32 s11, 81
    s_cselect_b32 s79, s79, 1073741824
    s_cselect_b32 s64, s64, 1073741824
    s_waitcnt lgkmcnt(0)
    v_mfma_f32_16x16x32_bf16 a[0:3], v[16:19], v[48:51], a[0:3]
    ds_read_b64_tr_b16 v[32:33], v98 offset:4608
    ds_read_b64_tr_b16 v[34:35], v98 offset:4752
    v_mfma_f32_16x16x32_bf16 a[4:7], v[16:19], v[52:55], a[4:7]
    ds_read_b128 v[68:71], v107 offset:0
    ds_read_b128 v[72:75], v105 offset:2048
    v_mfma_f32_16x16x32_bf16 a[8:11], v[16:19], v[56:59], a[8:11]
    ds_read_b128 v[76:79], v105 offset:4096
    ds_read_b128 v[80:83], v105 offset:6144
    v_mfma_f32_16x16x32_bf16 a[12:15], v[16:19], v[60:63], a[12:15]
    ds_read_b128 v[84:87], v105 offset:8192
    ds_read_b64_tr_b16 v[36:37], v100 offset:0
    v_mfma_f32_16x16x32_bf16 a[16:19], v[16:19], v[64:67], a[16:19]
    ds_read_b64_tr_b16 v[38:39], v100 offset:144
    buffer_load_dwordx4 v93, s[68:71], s65 offen offset:1024 lds
    v_mfma_f32_16x16x32_bf16 a[20:23], v[20:23], v[48:51], a[20:23]
    s_mov_b32 s66, s10
    s_and_b32 s74, s44, 15
    s_mul_i32 s74, s74, 41472
    v_mfma_f32_16x16x32_bf16 a[24:27], v[20:23], v[52:55], a[24:27]
    buffer_load_dwordx4 v94, s[68:71], s65 offen offset:2048 lds
    s_mul_i32 s67, s45, 144
    s_add_u32 s74, s74, s67
    v_mfma_f32_16x16x32_bf16 a[28:31], v[20:23], v[56:59], a[28:31]
    v_add_u32 v190, 0, v1
    v_min_u32 v190, 35, v190
    v_mul_u32_u24 v190, 1152, v190
    v_mfma_f32_16x16x32_bf16 a[32:35], v[20:23], v[60:63], a[32:35]
    buffer_load_dwordx4 v95, s[68:71], s65 offen offset:3072 lds
    s_movk_i32 s66, 1152
    s_mul_i32 s55, s45, 144
    v_mfma_f32_16x16x32_bf16 a[36:39], v[20:23], v[64:67], a[36:39]
    s_mul_i32 s60, s46, 165888
    s_add_u32 s60, s60, s55
    v_mfma_f32_16x16x32_bf16 a[40:43], v[48:51], v[48:51], a[40:43]
    s_add_u32 m0, s59, 56736
    s_nop 0
    buffer_load_dwordx4 v96, s[68:71], s65 offen offset:0 lds
    s_add_u32 s61, s60, 82944
    s_mul_i32 s54, s46, 18432
    s_lshl_b32 s56, s46, 10
    v_mfma_f32_16x16x32_bf16 a[44:47], v[52:55], v[52:55], a[44:47]
    v_add_u32 v104, 152144, v108
    v_add_u32 v105, 152144, v109
    v_mfma_f32_16x16x32_bf16 a[48:51], v[56:59], v[56:59], a[48:51]
    buffer_load_dwordx4 v97, s[68:71], s65 offen offset:1024 lds
    v_add_u32 v98, 124448, v102
    v_cndmask_b32 v106, v104, v110, s[72:73]
    v_cndmask_b32 v107, v105, v110, s[72:73]
    v_mfma_f32_16x16x32_bf16 a[52:55], v[60:63], v[60:63], a[52:55]
    v_add_u32 v99, 143040, v9
    v_add_u32 v100, 147648, v9
    v_mfma_f32_16x16x32_bf16 a[56:59], v[64:67], v[64:67], a[56:59]
    v_cndmask_b32 v99, v99, v110, s[82:83]
    v_cndmask_b32 v100, v100, v110, s[82:83]
    s_cmp_eq_u32 s45, 0
    s_cbranch_scc0 L_p1e
    s_lshl_b32 s49, s44, 2
    v_mov_b32 v11, 1
    v_mov_b32 v10, s49
    s_mov_b64 exec, 1
    buffer_store_dword v11, v10, s[32:35], 0 offen sc1
    s_mov_b64 exec, -1
L_p1e:
    s_waitcnt vmcnt(10) lgkmcnt(0)
    s_barrier
    s_lshl_b32 s65, s57, 7
    s_add_u32 s57, s57, 1
    s_cmp_eq_u32 s57, 9
    s_cselect_b32 s57, 0, s57
    v_mfma_f32_16x16x32_bf16 a[0:3], v[32:35], v[68:71], a[0:3]
    ds_read_b64_tr_b16 v[16:17], v98 offset:0
    ds_read_b64_tr_b16 v[18:19], v98 offset:144
    v_mfma_f32_16x16x32_bf16 a[4:7], v[32:35], v[72:75], a[4:7]
    ds_read_b128 v[48:51], v106 offset:0
    ds_read_b128 v[52:55], v104 offset:2048
    v_mfma_f32_16x16x32_bf16 a[8:11], v[32:35], v[76:79], a[8:11]
    ds_read_b128 v[56:59], v104 offset:4096
    ds_read_b128 v[60:63], v104 offset:6144
    v_mfma_f32_16x16x32_bf16 a[12:15], v[32:35], v[80:83], a[12:15]
    ds_read_b128 v[64:67], v104 offset:8192
    ds_read_b64_tr_b16 v[20:21], v99 offset:0
    v_mfma_f32_16x16x32_bf16 a[16:19], v[32:35], v[84:87], a[16:19]
    ds_read_b64_tr_b16 v[22:23], v99 offset:144
    s_add_u32 m0, s59, 86496
    s_nop 0
    buffer_load_dwordx4 v88, s[68:71], s65 offen offset:0 lds
    v_mfma_f32_16x16x32_bf16 a[20:23], v[36:39], v[68:71], a[20:23]
    v_add_u32 v246, 0, v1
    v_add_u32 v248, 0, v2
    v_mfma_f32_16x16x32_bf16 a[24:27], v[36:39], v[72:75], a[24:27]
    buffer_load_dwordx4 v89, s[68:71], s65 offen offset:1024 lds
    v_mul_u32_u24 v247, 7282, v246
    v_mfma_f32_16x16x32_bf16 a[28:31], v[36:39], v[76:79], a[28:31]
    v_lshrrev_b32_e64 v247, 16, v247
    v_mad_i32_i24 v248, v247, s51, v248
    v_mfma_f32_16x16x32_bf16 a[32:35], v[36:39], v[80:83], a[32:35]
    buffer_load_dwordx4 v90, s[68:71], s65 offen offset:2048 lds
    v_bfe_u32 v249, v247, 1, 2
    v_mfma_f32_16x16x32_bf16 a[36:39], v[36:39], v[84:87], a[36:39]
    v_and_b32_e64 v250, 1, v247
    v_lshl_or_b32 v249, v250, 2, v249
    v_mfma_f32_16x16x32_bf16 a[40:43], v[68:71], v[68:71], a[40:43]
    buffer_load_dwordx4 v91, s[68:71], s65 offen offset:3072 lds
    v_lshrrev_b32_e64 v250, 5, v247
    v_mfma_f32_16x16x32_bf16 a[44:47], v[72:75], v[72:75], a[44:47]
    v_lshl_or_b32 v249, v250, 3, v249
    v_bfe_u32 v250, v247, 3, 2
    v_mfma_f32_16x16x32_bf16 a[48:51], v[76:79], v[76:79], a[48:51]
    s_add_u32 m0, s59, 90592
    s_nop 0
    buffer_load_dwordx4 v92, s[68:71], s65 offen offset:0 lds
    v_mad_u32_u24 v249, v250, 18, v249
    v_mfma_f32_16x16x32_bf16 a[52:55], v[80:83], v[80:83], a[52:55]
    v_bfe_u32 v250, v247, 3, 1
    v_lshl_add_u32 v249, v250, 1, v249
    v_mfma_f32_16x16x32_bf16 a[56:59], v[84:87], v[84:87], a[56:59]
    v_mad_u32_u24 v228, v249, s66, v248
    s_waitcnt lgkmcnt(0)
    v_mfma_f32_16x16x32_bf16 a[0:3], v[16:19], v[48:51], a[0:3]
    ds_read_b64_tr_b16 v[32:33], v98 offset:4608
    ds_read_b64_tr_b16 v[34:35], v98 offset:4752
    v_mfma_f32_16x16x32_bf16 a[4:7], v[16:19], v[52:55], a[4:7]
    ds_read_b128 v[68:71], v107 offset:0
    ds_read_b128 v[72:75], v105 offset:2048
    v_mfma_f32_16x16x32_bf16 a[8:11], v[16:19], v[56:59], a[8:11]
    ds_read_b128 v[76:79], v105 offset:4096
    ds_read_b128 v[80:83], v105 offset:6144
    v_mfma_f32_16x16x32_bf16 a[12:15], v[16:19], v[60:63], a[12:15]
    ds_read_b128 v[84:87], v105 offset:8192
    ds_read_b64_tr_b16 v[36:37], v100 offset:0
    v_mfma_f32_16x16x32_bf16 a[16:19], v[16:19], v[64:67], a[16:19]
    ds_read_b64_tr_b16 v[38:39], v100 offset:144
    buffer_load_dwordx4 v93, s[68:71], s65 offen offset:1024 lds
    v_mfma_f32_16x16x32_bf16 a[20:23], v[20:23], v[48:51], a[20:23]
    v_add_u32 v246, 64, v1
    v_add_u32 v248, 0, v2
    v_mul_u32_u24 v247, 7282, v246
    v_mfma_f32_16x16x32_bf16 a[24:27], v[20:23], v[52:55], a[24:27]
    buffer_load_dwordx4 v94, s[68:71], s65 offen offset:2048 lds
    v_lshrrev_b32_e64 v247, 16, v247
    v_mad_i32_i24 v248, v247, s51, v248
    v_mfma_f32_16x16x32_bf16 a[28:31], v[20:23], v[56:59], a[28:31]
    v_bfe_u32 v249, v247, 1, 2
    v_and_b32_e64 v250, 1, v247
    v_lshl_or_b32 v249, v250, 2, v249
    v_mfma_f32_16x16x32_bf16 a[32:35], v[20:23], v[60:63], a[32:35]
    buffer_load_dwordx4 v95, s[68:71], s65 offen offset:3072 lds
    v_lshrrev_b32_e64 v250, 5, v247
    v_lshl_or_b32 v249, v250, 3, v249
    v_mfma_f32_16x16x32_bf16 a[36:39], v[20:23], v[64:67], a[36:39]
    v_bfe_u32 v250, v247, 3, 2
    v_mad_u32_u24 v249, v250, 18, v249
    v_mfma_f32_16x16x32_bf16 a[40:43], v[48:51], v[48:51], a[40:43]
    s_add_u32 m0, s59, 94688
    s_nop 0
    buffer_load_dwordx4 v96, s[68:71], s65 offen offset:0 lds
    v_bfe_u32 v250, v247, 3, 1
    v_lshl_add_u32 v249, v250, 1, v249
    v_mad_u32_u24 v229, v249, s66, v248
    v_mfma_f32_16x16x32_bf16 a[44:47], v[52:55], v[52:55], a[44:47]
    v_add_u32 v104, 76240, v108
    v_add_u32 v105, 76240, v109
    v_mfma_f32_16x16x32_bf16 a[48:51], v[56:59], v[56:59], a[48:51]
    buffer_load_dwordx4 v97, s[68:71], s65 offen offset:1024 lds
    v_add_u32 v98, 48544, v102
    v_cndmask_b32 v106, v104, v110, s[72:73]
    v_cndmask_b32 v107, v105, v110, s[72:73]
    v_mfma_f32_16x16x32_bf16 a[52:55], v[60:63], v[60:63], a[52:55]
    v_add_u32 v99, 67136, v9
    v_add_u32 v100, 71744, v9
    v_mfma_f32_16x16x32_bf16 a[56:59], v[64:67], v[64:67], a[56:59]
    v_cndmask_b32 v99, v99, v110, s[82:83]
    v_cndmask_b32 v100, v100, v110, s[82:83]
    s_waitcnt vmcnt(10) lgkmcnt(0)
    s_barrier
    s_lshl_b32 s65, s57, 7
    s_add_u32 s57, s57, 1
    s_cmp_eq_u32 s57, 9
    s_cselect_b32 s57, 0, s57
    v_mfma_f32_16x16x32_bf16 a[0:3], v[32:35], v[68:71], a[0:3]
    ds_read_b64_tr_b16 v[16:17], v98 offset:0
    ds_read_b64_tr_b16 v[18:19], v98 offset:144
    v_mfma_f32_16x16x32_bf16 a[4:7], v[32:35], v[72:75], a[4:7]
    ds_read_b128 v[48:51], v106 offset:0
    ds_read_b128 v[52:55], v104 offset:2048
    v_mfma_f32_16x16x32_bf16 a[8:11], v[32:35], v[76:79], a[8:11]
    ds_read_b128 v[56:59], v104 offset:4096
    ds_read_b128 v[60:63], v104 offset:6144
    v_mfma_f32_16x16x32_bf16 a[12:15], v[32:35], v[80:83], a[12:15]
    ds_read_b128 v[64:67], v104 offset:8192
    ds_read_b64_tr_b16 v[20:21], v99 offset:0
    v_mfma_f32_16x16x32_bf16 a[16:19], v[32:35], v[84:87], a[16:19]
    ds_read_b64_tr_b16 v[22:23], v99 offset:144
    s_add_u32 m0, s59, 124448
    s_nop 0
    buffer_load_dwordx4 v88, s[68:71], s65 offen offset:0 lds
    v_mfma_f32_16x16x32_bf16 a[20:23], v[36:39], v[68:71], a[20:23]
    v_add_u32 v246, 128, v1
    v_add_u32_e64 v248, 0, v2
    v_mfma_f32_16x16x32_bf16 a[24:27], v[36:39], v[72:75], a[24:27]
    buffer_load_dwordx4 v89, s[68:71], s65 offen offset:1024 lds
    v_mul_u32_u24 v247, 7282, v246
    v_mfma_f32_16x16x32_bf16 a[28:31], v[36:39], v[76:79], a[28:31]
    v_lshrrev_b32_e64 v247, 16, v247
    v_mad_i32_i24 v248, v247, s51, v248
    v_mfma_f32_16x16x32_bf16 a[32:35], v[36:39], v[80:83], a[32:35]
    buffer_load_dwordx4 v90, s[68:71], s65 offen offset:2048 lds
    v_bfe_u32 v249, v247, 1, 2
    v_mfma_f32_16x16x32_bf16 a[36:39], v[36:39], v[84:87], a[36:39]
    v_and_b32_e64 v250, 1, v247
    v_mfma_f32_16x16x32_bf16 a[40:43], v[68:71], v[68:71], a[40:43]
    buffer_load_dwordx4 v91, s[68:71], s65 offen offset:3072 lds
    v_lshl_or_b32 v249, v250, 2, v249
    v_lshrrev_b32_e64 v250, 5, v247
    v_mfma_f32_16x16x32_bf16 a[44:47], v[72:75], v[72:75], a[44:47]
    v_lshl_or_b32 v249, v250, 3, v249
    v_mfma_f32_16x16x32_bf16 a[48:51], v[76:79], v[76:79], a[48:51]
    s_add_u32 m0, s59, 128544
    s_nop 0
    buffer_load_dwordx4 v92, s[68:71], s65 offen offset:0 lds
    v_bfe_u32 v250, v247, 3, 2
    v_mad_u32_u24 v249, v250, 18, v249
    v_mfma_f32_16x16x32_bf16 a[52:55], v[80:83], v[80:83], a[52:55]
    v_bfe_u32 v250, v247, 3, 1
    v_mfma_f32_16x16x32_bf16 a[56:59], v[84:87], v[84:87], a[56:59]
    v_lshl_add_u32 v249, v250, 1, v249
    s_waitcnt lgkmcnt(0)
    v_mfma_f32_16x16x32_bf16 a[0:3], v[16:19], v[48:51], a[0:3]
    ds_read_b64_tr_b16 v[32:33], v98 offset:4608
    ds_read_b64_tr_b16 v[34:35], v98 offset:4752
    v_mfma_f32_16x16x32_bf16 a[4:7], v[16:19], v[52:55], a[4:7]
    ds_read_b128 v[68:71], v107 offset:0
    ds_read_b128 v[72:75], v105 offset:2048
    v_mfma_f32_16x16x32_bf16 a[8:11], v[16:19], v[56:59], a[8:11]
    ds_read_b128 v[76:79], v105 offset:4096
    ds_read_b128 v[80:83], v105 offset:6144
    v_mfma_f32_16x16x32_bf16 a[12:15], v[16:19], v[60:63], a[12:15]
    ds_read_b128 v[84:87], v105 offset:8192
    ds_read_b64_tr_b16 v[36:37], v100 offset:0
    v_mfma_f32_16x16x32_bf16 a[16:19], v[16:19], v[64:67], a[16:19]
    ds_read_b64_tr_b16 v[38:39], v100 offset:144
    buffer_load_dwordx4 v93, s[68:71], s65 offen offset:1024 lds
    v_mfma_f32_16x16x32_bf16 a[20:23], v[20:23], v[48:51], a[20:23]
    v_mad_u32_u24 v230, v249, s66, v248
    v_add_u32 v246, 192, v1
    v_add_u32_e64 v248, 0, v2
    v_mfma_f32_16x16x32_bf16 a[24:27], v[20:23], v[52:55], a[24:27]
    buffer_load_dwordx4 v94, s[68:71], s65 offen offset:2048 lds
    v_mul_u32_u24 v247, 7282, v246
    v_lshrrev_b32_e64 v247, 16, v247
    v_mfma_f32_16x16x32_bf16 a[28:31], v[20:23], v[56:59], a[28:31]
    v_mad_i32_i24 v248, v247, s51, v248
    v_bfe_u32 v249, v247, 1, 2
    v_and_b32_e64 v250, 1, v247
    v_mfma_f32_16x16x32_bf16 a[32:35], v[20:23], v[60:63], a[32:35]
    buffer_load_dwordx4 v95, s[68:71], s65 offen offset:3072 lds
    v_lshl_or_b32 v249, v250, 2, v249
    v_lshrrev_b32_e64 v250, 5, v247
    v_mfma_f32_16x16x32_bf16 a[36:39], v[20:23], v[64:67], a[36:39]
    v_lshl_or_b32 v249, v250, 3, v249
    v_bfe_u32 v250, v247, 3, 2
    v_mfma_f32_16x16x32_bf16 a[40:43], v[48:51], v[48:51], a[40:43]
    s_add_u32 m0, s59, 132640
    s_nop 0
    buffer_load_dwordx4 v96, s[68:71], s65 offen offset:0 lds
    v_mad_u32_u24 v249, v250, 18, v249
    v_bfe_u32 v250, v247, 3, 1
    v_lshl_add_u32 v249, v250, 1, v249
    v_mfma_f32_16x16x32_bf16 a[44:47], v[52:55], v[52:55], a[44:47]
    v_add_u32 v104, 114192, v108
    v_add_u32 v105, 114192, v109
    v_mfma_f32_16x16x32_bf16 a[48:51], v[56:59], v[56:59], a[48:51]
    buffer_load_dwordx4 v97, s[68:71], s65 offen offset:1024 lds
    v_add_u32 v98, 86496, v102
    v_cndmask_b32 v106, v104, v110, s[72:73]
    v_cndmask_b32 v107, v105, v110, s[72:73]
    v_mfma_f32_16x16x32_bf16 a[52:55], v[60:63], v[60:63], a[52:55]
    v_add_u32 v99, 105088, v9
    v_add_u32 v100, 109696, v9
    v_mfma_f32_16x16x32_bf16 a[56:59], v[64:67], v[64:67], a[56:59]
    v_cndmask_b32 v99, v99, v110, s[82:83]
    v_cndmask_b32 v100, v100, v110, s[82:83]
    s_waitcnt vmcnt(10) lgkmcnt(0)
    s_barrier
    s_lshl_b32 s65, s57, 7
    s_add_u32 s57, s57, 1
    s_cmp_eq_u32 s57, 9
    s_cselect_b32 s57, 0, s57
    v_mfma_f32_16x16x32_bf16 a[0:3], v[32:35], v[68:71], a[0:3]
    ds_read_b64_tr_b16 v[16:17], v98 offset:0
    ds_read_b64_tr_b16 v[18:19], v98 offset:144
    v_mfma_f32_16x16x32_bf16 a[4:7], v[32:35], v[72:75], a[4:7]
    ds_read_b128 v[48:51], v106 offset:0
    ds_read_b128 v[52:55], v104 offset:2048
    v_mfma_f32_16x16x32_bf16 a[8:11], v[32:35], v[76:79], a[8:11]
    ds_read_b128 v[56:59], v104 offset:4096
    ds_read_b128 v[60:63], v104 offset:6144
    v_mfma_f32_16x16x32_bf16 a[12:15], v[32:35], v[80:83], a[12:15]
    ds_read_b128 v[64:67], v104 offset:8192
    ds_read_b64_tr_b16 v[20:21], v99 offset:0
    v_mfma_f32_16x16x32_bf16 a[16:19], v[32:35], v[84:87], a[16:19]
    ds_read_b64_tr_b16 v[22:23], v99 offset:144
    s_add_u32 m0, s59, 48544
    s_nop 0
    buffer_load_dwordx4 v88, s[68:71], s65 offen offset:0 lds
    v_mfma_f32_16x16x32_bf16 a[20:23], v[36:39], v[68:71], a[20:23]
    v_mad_u32_u24 v231, v249, s66, v248
    v_add_u32 v246, 256, v1
    v_mfma_f32_16x16x32_bf16 a[24:27], v[36:39], v[72:75], a[24:27]
    buffer_load_dwordx4 v89, s[68:71], s65 offen offset:1024 lds
    v_add_u32 v248, 4096, v2
    v_mfma_f32_16x16x32_bf16 a[28:31], v[36:39], v[76:79], a[28:31]
    v_mul_u32_u24 v247, 7282, v246
    v_lshrrev_b32_e64 v247, 16, v247
    v_mfma_f32_16x16x32_bf16 a[32:35], v[36:39], v[80:83], a[32:35]
    buffer_load_dwordx4 v90, s[68:71], s65 offen offset:2048 lds
    v_mad_i32_i24 v248, v247, s51, v248
    v_mfma_f32_16x16x32_bf16 a[36:39], v[36:39], v[84:87], a[36:39]
    v_bfe_u32 v249, v247, 1, 2
    v_mfma_f32_16x16x32_bf16 a[40:43], v[68:71], v[68:71], a[40:43]
    buffer_load_dwordx4 v91, s[68:71], s65 offen offset:3072 lds
    v_and_b32_e64 v250, 1, v247
    v_lshl_or_b32 v249, v250, 2, v249
    v_mfma_f32_16x16x32_bf16 a[44:47], v[72:75], v[72:75], a[44:47]
    v_lshrrev_b32_e64 v250, 5, v247
    v_mfma_f32_16x16x32_bf16 a[48:51], v[76:79], v[76:79], a[48:51]
    s_add_u32 m0, s59, 52640
    s_nop 0
    buffer_load_dwordx4 v92, s[68:71], s65 offen offset:0 lds
    v_lshl_or_b32 v249, v250, 3, v249
    v_bfe_u32 v250, v247, 3, 2
    v_mfma_f32_16x16x32_bf16 a[52:55], v[80:83], v[80:83], a[52:55]
    v_mad_u32_u24 v249, v250, 18, v249
    v_mfma_f32_16x16x32_bf16 a[56:59], v[84:87], v[84:87], a[56:59]
L_pg12:
    s_cbranch_execz L_tourx
    v_bfe_u32 v250, v247, 3, 1
    s_waitcnt lgkmcnt(0)
    v_mfma_f32_16x16x32_bf16 a[0:3], v[16:19], v[48:51], a[0:3]
    ds_read_b64_tr_b16 v[32:33], v98 offset:4608
    ds_read_b64_tr_b16 v[34:35], v98 offset:4752
    v_mfma_f32_16x16x32_bf16 a[4:7], v[16:19], v[52:55], a[4:7]
    ds_read_b128 v[68:71], v107 offset:0
    ds_read_b128 v[72:75], v105 offset:2048
    v_mfma_f32_16x16x32_bf16 a[8:11], v[16:19], v[56:59], a[8:11]
    ds_read_b128 v[76:79], v105 offset:4096
    ds_read_b128 v[80:83], v105 offset:6144
    v_mfma_f32_16x16x32_bf16 a[12:15], v[16:19], v[60:63], a[12:15]
    ds_read_b128 v[84:87], v105 offset:8192
    ds_read_b64_tr_b16 v[36:37], v100 offset:0
    v_mfma_f32_16x16x32_bf16 a[16:19], v[16:19], v[64:67], a[16:19]
    ds_read_b64_tr_b16 v[38:39], v100 offset:144
    buffer_load_dwordx4 v93, s[68:71], s65 offen offset:1024 lds
    v_mfma_f32_16x16x32_bf16 a[20:23], v[20:23], v[48:51], a[20:23]
    v_lshl_add_u32 v249, v250, 1, v249
    v_mad_u32_u24 v232, v249, s66, v248
    v_add_u32 v246, 320, v1
    v_mfma_f32_16x16x32_bf16 a[24:27], v[20:23], v[52:55], a[24:27]
    buffer_load_dwordx4 v94, s[68:71], s65 offen offset:2048 lds
    v_add_u32 v248, 4096, v2
    v_mul_u32_u24 v247, 7282, v246
    v_mfma_f32_16x16x32_bf16 a[28:31], v[20:23], v[56:59], a[28:31]
    v_lshrrev_b32 v247, 16, v247
    v_mad_i32_i24 v248, v247, s51, v248
    v_bfe_u32 v249, v247, 1, 2
    v_mfma_f32_16x16x32_bf16 a[32:35], v[20:23], v[60:63], a[32:35]
    buffer_load_dwordx4 v95, s[68:71], s65 offen offset:3072 lds
    v_and_b32_e64 v250, 1, v247
    v_lshl_or_b32 v249, v250, 2, v249
    v_mfma_f32_16x16x32_bf16 a[36:39], v[20:23], v[64:67], a[36:39]
    v_lshrrev_b32_e64 v250, 5, v247
    v_lshl_or_b32 v249, v250, 3, v249
    v_mfma_f32_16x16x32_bf16 a[40:43], v[48:51], v[48:51], a[40:43]
    s_add_u32 m0, s59, 56736
    s_nop 0
    buffer_load_dwordx4 v96, s[68:71], s65 offen offset:0 lds
    v_bfe_u32 v250, v247, 3, 2
    v_mad_u32_u24 v249, v250, 18, v249
    v_bfe_u32 v250, v247, 3, 1
    v_mfma_f32_16x16x32_bf16 a[44:47], v[52:55], v[52:55], a[44:47]
    v_add_u32 v104, 152144, v108
    v_add_u32 v105, 152144, v109
    v_mfma_f32_16x16x32_bf16 a[48:51], v[56:59], v[56:59], a[48:51]
    buffer_load_dwordx4 v97, s[68:71], s65 offen offset:1024 lds
    v_add_u32 v98, 124448, v102
    v_cndmask_b32 v106, v104, v110, s[72:73]
    v_cndmask_b32 v107, v105, v110, s[72:73]
    v_mfma_f32_16x16x32_bf16 a[52:55], v[60:63], v[60:63], a[52:55]
    v_add_u32 v99, 143040, v9
    v_add_u32 v100, 147648, v9
    v_mfma_f32_16x16x32_bf16 a[56:59], v[64:67], v[64:67], a[56:59]
    v_cndmask_b32 v99, v99, v110, s[82:83]
    v_cndmask_b32 v100, v100, v110, s[82:83]
    s_waitcnt vmcnt(10) lgkmcnt(0)
    s_barrier
    s_lshl_b32 s65, s57, 7
    s_add_u32 s57, s57, 1
    s_cmp_eq_u32 s57, 9
    s_cselect_b32 s57, 0, s57
    v_mfma_f32_16x16x32_bf16 a[0:3], v[32:35], v[68:71], a[0:3]
    ds_read_b64_tr_b16 v[16:17], v98 offset:0
    ds_read_b64_tr_b16 v[18:19], v98 offset:144
    v_mfma_f32_16x16x32_bf16 a[4:7], v[32:35], v[72:75], a[4:7]
    ds_read_b128 v[48:51], v106 offset:0
    ds_read_b128 v[52:55], v104 offset:2048
    v_mfma_f32_16x16x32_bf16 a[8:11], v[32:35], v[76:79], a[8:11]
    ds_read_b128 v[56:59], v104 offset:4096
    ds_read_b128 v[60:63], v104 offset:6144
    v_mfma_f32_16x16x32_bf16 a[12:15], v[32:35], v[80:83], a[12:15]
    ds_read_b128 v[64:67], v104 offset:8192
    ds_read_b64_tr_b16 v[20:21], v99 offset:0
    v_mfma_f32_16x16x32_bf16 a[16:19], v[32:35], v[84:87], a[16:19]
    ds_read_b64_tr_b16 v[22:23], v99 offset:144
    s_add_u32 m0, s59, 86496
    s_nop 0
    buffer_load_dwordx4 v88, s[68:71], s65 offen offset:0 lds
    v_mfma_f32_16x16x32_bf16 a[20:23], v[36:39], v[68:71], a[20:23]
    v_lshl_add_u32 v249, v250, 1, v249
    v_mad_u32_u24 v233, v249, s66, v248
    v_mfma_f32_16x16x32_bf16 a[24:27], v[36:39], v[72:75], a[24:27]
    buffer_load_dwordx4 v89, s[68:71], s65 offen offset:1024 lds
    v_add_u32 v246, 384, v1
    v_mfma_f32_16x16x32_bf16 a[28:31], v[36:39], v[76:79], a[28:31]
    v_add_u32 v248, 4096, v2
    v_mul_u32_u24 v247, 7282, v246
    v_mfma_f32_16x16x32_bf16 a[32:35], v[36:39], v[80:83], a[32:35]
    buffer_load_dwordx4 v90, s[68:71], s65 offen offset:2048 lds
    v_lshrrev_b32_e64 v247, 16, v247
    v_mfma_f32_16x16x32_bf16 a[36:39], v[36:39], v[84:87], a[36:39]
    v_mad_i32_i24 v248, v247, s51, v248
    v_mfma_f32_16x16x32_bf16 a[40:43], v[68:71], v[68:71], a[40:43]
    buffer_load_dwordx4 v91, s[68:71], s65 offen offset:3072 lds
    v_bfe_u32 v249, v247, 1, 2
    v_and_b32_e64 v250, 1, v247
    v_mfma_f32_16x16x32_bf16 a[44:47], v[72:75], v[72:75], a[44:47]
    v_lshl_or_b32 v249, v250, 2, v249
    v_mfma_f32_16x16x32_bf16 a[48:51], v[76:79], v[76:79], a[48:51]
    s_add_u32 m0, s59, 90592
    s_nop 0
    buffer_load_dwordx4 v92, s[68:71], s65 offen offset:0 lds
    v_lshrrev_b32 v250, 5, v247
    v_lshl_or_b32 v249, v250, 3, v249
    v_mfma_f32_16x16x32_bf16 a[52:55], v[80:83], v[80:83], a[52:55]
    v_bfe_u32 v250, v247, 3, 2
    v_mfma_f32_16x16x32_bf16 a[56:59], v[84:87], v[84:87], a[56:59]
    v_mad_u32_u24 v249, v250, 18, v249
    s_waitcnt lgkmcnt(0)
    v_mfma_f32_16x16x32_bf16 a[0:3], v[16:19], v[48:51], a[0:3]
    ds_read_b64_tr_b16 v[32:33], v98 offset:4608
    ds_read_b64_tr_b16 v[34:35], v98 offset:4752
    v_mfma_f32_16x16x32_bf16 a[4:7], v[16:19], v[52:55], a[4:7]
    ds_read_b128 v[68:71], v107 offset:0
    ds_read_b128 v[72:75], v105 offset:2048
    v_mfma_f32_16x16x32_bf16 a[8:11], v[16:19], v[56:59], a[8:11]
    ds_read_b128 v[76:79], v105 offset:4096
    ds_read_b128 v[80:83], v105 offset:6144
    v_mfma_f32_16x16x32_bf16 a[12:15], v[16:19], v[60:63], a[12:15]
    ds_read_b128 v[84:87], v105 offset:8192
    ds_read_b64_tr_b16 v[36:37], v100 offset:0
    v_mfma_f32_16x16x32_bf16 a[16:19], v[16:19], v[64:67], a[16:19]
    ds_read_b64_tr_b16 v[38:39], v100 offset:144
    buffer_load_dwordx4 v93, s[68:71], s65 offen offset:1024 lds
    v_mfma_f32_16x16x32_bf16 a[20:23], v[20:23], v[48:51], a[20:23]
    v_bfe_u32 v250, v247, 3, 1
    v_lshl_add_u32 v249, v250, 1, v249
    v_mad_u32_u24 v234, v249, s66, v248
    v_mfma_f32_16x16x32_bf16 a[24:27], v[20:23], v[52:55], a[24:27]
    buffer_load_dwordx4 v94, s[68:71], s65 offen offset:2048 lds
    v_add_u32 v246, 448, v1
    v_add_u32 v248, 4096, v2
    v_mfma_f32_16x16x32_bf16 a[28:31], v[20:23], v[56:59], a[28:31]
    v_mul_u32_u24 v247, 7282, v246
    v_lshrrev_b32 v247, 16, v247
    v_mad_i32_i24 v248, v247, s51, v248
    v_mfma_f32_16x16x32_bf16 a[32:35], v[20:23], v[60:63], a[32:35]
    buffer_load_dwordx4 v95, s[68:71], s65 offen offset:3072 lds
    v_bfe_u32 v249, v247, 1, 2
    v_and_b32_e64 v250, 1, v247
    v_mfma_f32_16x16x32_bf16 a[36:39], v[20:23], v[64:67], a[36:39]
    v_lshl_or_b32 v249, v250, 2, v249
    v_lshrrev_b32_e64 v250, 5, v247
    v_mfma_f32_16x16x32_bf16 a[40:43], v[48:51], v[48:51], a[40:43]
    s_add_u32 m0, s59, 94688
    s_nop 0
    buffer_load_dwordx4 v96, s[68:71], s65 offen offset:0 lds
    v_lshl_or_b32 v249, v250, 3, v249
    v_bfe_u32 v250, v247, 3, 2
    v_mad_u32_u24 v249, v250, 18, v249
    v_mfma_f32_16x16x32_bf16 a[44:47], v[52:55], v[52:55], a[44:47]
    v_add_u32 v104, 76240, v108
    v_add_u32 v105, 76240, v109
    v_mfma_f32_16x16x32_bf16 a[48:51], v[56:59], v[56:59], a[48:51]
    buffer_load_dwordx4 v97, s[68:71], s65 offen offset:1024 lds
    v_add_u32 v98, 48544, v102
    v_cndmask_b32 v106, v104, v110, s[72:73]
    v_cndmask_b32 v107, v105, v110, s[72:73]
    v_mfma_f32_16x16x32_bf16 a[52:55], v[60:63], v[60:63], a[52:55]
    v_add_u32 v99, 67136, v9
    v_add_u32 v100, 71744, v9
    v_mfma_f32_16x16x32_bf16 a[56:59], v[64:67], v[64:67], a[56:59]
    v_cndmask_b32 v99, v99, v110, s[82:83]
    v_cndmask_b32 v100, v100, v110, s[82:83]
    s_waitcnt vmcnt(10) lgkmcnt(0)
    s_barrier
    s_lshl_b32 s65, s57, 7
    s_add_u32 s57, s57, 1
    s_cmp_eq_u32 s57, 9
    s_cselect_b32 s57, 0, s57
    v_mfma_f32_16x16x32_bf16 a[0:3], v[32:35], v[68:71], a[0:3]
    ds_read_b64_tr_b16 v[16:17], v98 offset:0
    ds_read_b64_tr_b16 v[18:19], v98 offset:144
    v_mfma_f32_16x16x32_bf16 a[4:7], v[32:35], v[72:75], a[4:7]
    ds_read_b128 v[48:51], v106 offset:0
    ds_read_b128 v[52:55], v104 offset:2048
    v_mfma_f32_16x16x32_bf16 a[8:11], v[32:35], v[76:79], a[8:11]
    ds_read_b128 v[56:59], v104 offset:4096
    ds_read_b128 v[60:63], v104 offset:6144
    v_mfma_f32_16x16x32_bf16 a[12:15], v[32:35], v[80:83], a[12:15]
    ds_read_b128 v[64:67], v104 offset:8192
    ds_read_b64_tr_b16 v[20:21], v99 offset:0
    v_mfma_f32_16x16x32_bf16 a[16:19], v[32:35], v[84:87], a[16:19]
    ds_read_b64_tr_b16 v[22:23], v99 offset:144
    s_add_u32 m0, s59, 124448
    s_nop 0
    buffer_load_dwordx4 v88, s[68:71], s65 offen offset:0 lds
    v_mfma_f32_16x16x32_bf16 a[20:23], v[36:39], v[68:71], a[20:23]
    v_bfe_u32 v250, v247, 3, 1
    v_lshl_add_u32 v249, v250, 1, v249
    v_mfma_f32_16x16x32_bf16 a[24:27], v[36:39], v[72:75], a[24:27]
    buffer_load_dwordx4 v89, s[68:71], s65 offen offset:1024 lds
    v_mad_u32_u24 v235, v249, s66, v248
    v_mfma_f32_16x16x32_bf16 a[28:31], v[36:39], v[76:79], a[28:31]
    v_add_u32 v246, 512, v1
    v_add_u32 v248, 8192, v2
    v_mfma_f32_16x16x32_bf16 a[32:35], v[36:39], v[80:83], a[32:35]
    buffer_load_dwordx4 v90, s[68:71], s65 offen offset:2048 lds
    v_mul_u32_u24 v247, 7282, v246
    v_mfma_f32_16x16x32_bf16 a[36:39], v[36:39], v[84:87], a[36:39]
    v_lshrrev_b32_e64 v247, 16, v247
    v_mfma_f32_16x16x32_bf16 a[40:43], v[68:71], v[68:71], a[40:43]
    buffer_load_dwordx4 v91, s[68:71], s65 offen offset:3072 lds
    v_mad_i32_i24 v248, v247, s51, v248
    v_bfe_u32 v249, v247, 1, 2
    v_mfma_f32_16x16x32_bf16 a[44:47], v[72:75], v[72:75], a[44:47]
    v_and_b32_e64 v250, 1, v247
    v_mfma_f32_16x16x32_bf16 a[48:51], v[76:79], v[76:79], a[48:51]
    s_add_u32 m0, s59, 128544
    s_nop 0
    buffer_load_dwordx4 v92, s[68:71], s65 offen offset:0 lds
    v_lshl_or_b32 v249, v250, 2, v249
    v_lshrrev_b32 v250, 5, v247
    v_mfma_f32_16x16x32_bf16 a[52:55], v[80:83], v[80:83], a[52:55]
    v_lshl_or_b32 v249, v250, 3, v249
    v_mfma_f32_16x16x32_bf16 a[56:59], v[84:87], v[84:87], a[56:59]
    v_bfe_u32 v250, v247, 3, 2
    s_waitcnt lgkmcnt(0)
    v_mfma_f32_16x16x32_bf16 a[0:3], v[16:19], v[48:51], a[0:3]
    ds_read_b64_tr_b16 v[32:33], v98 offset:4608
    ds_read_b64_tr_b16 v[34:35], v98 offset:4752
    v_mfma_f32_16x16x32_bf16 a[4:7], v[16:19], v[52:55], a[4:7]
    ds_read_b128 v[68:71], v107 offset:0
    ds_read_b128 v[72:75], v105 offset:2048
    v_mfma_f32_16x16x32_bf16 a[8:11], v[16:19], v[56:59], a[8:11]
    ds_read_b128 v[76:79], v105 offset:4096
    ds_read_b128 v[80:83], v105 offset:6144
    v_mfma_f32_16x16x32_bf16 a[12:15], v[16:19], v[60:63], a[12:15]
    ds_read_b128 v[84:87], v105 offset:8192
    ds_read_b64_tr_b16 v[36:37], v100 offset:0
    v_mfma_f32_16x16x32_bf16 a[16:19], v[16:19], v[64:67], a[16:19]
    ds_read_b64_tr_b16 v[38:39], v100 offset:144
    buffer_load_dwordx4 v93, s[68:71], s65 offen offset:1024 lds
    v_mfma_f32_16x16x32_bf16 a[20:23], v[20:23], v[48:51], a[20:23]
    v_mad_u32_u24 v249, v250, 18, v249
    v_bfe_u32 v250, v247, 3, 1
    v_lshl_add_u32 v249, v250, 1, v249
    v_mfma_f32_16x16x32_bf16 a[24:27], v[20:23], v[52:55], a[24:27]
    buffer_load_dwordx4 v94, s[68:71], s65 offen offset:2048 lds
    v_mad_u32_u24 v236, v249, s66, v248
    s_lshl_b32 s67, s46, 6
    v_mfma_f32_16x16x32_bf16 a[28:31], v[20:23], v[56:59], a[28:31]
    v_add_u32 v246, s67, v1
    v_lshlrev_b32 v248, 4, v246
    v_mul_u32_u24 v247, 7282, v246
    v_mfma_f32_16x16x32_bf16 a[32:35], v[20:23], v[60:63], a[32:35]
    buffer_load_dwordx4 v95, s[68:71], s65 offen offset:3072 lds
    v_lshrrev_b32_e64 v247, 16, v247
    v_mad_i32_i24 v248, v247, s51, v248
    v_mfma_f32_16x16x32_bf16 a[36:39], v[20:23], v[64:67], a[36:39]
    v_lshrrev_b32 v249, 3, v247
    v_and_b32 v250, 1, v247
    v_mfma_f32_16x16x32_bf16 a[40:43], v[48:51], v[48:51], a[40:43]
    s_add_u32 m0, s59, 132640
    s_nop 0
    buffer_load_dwordx4 v96, s[68:71], s65 offen offset:0 lds
    v_lshl_or_b32 v249, v249, 1, v250
    v_bfe_u32 v250, v247, 1, 2
    v_or_b32 v250, 16, v250
    v_mfma_f32_16x16x32_bf16 a[44:47], v[52:55], v[52:55], a[44:47]
    v_add_u32 v104, 114192, v108
    v_add_u32 v105, 114192, v109
    v_mfma_f32_16x16x32_bf16 a[48:51], v[56:59], v[56:59], a[48:51]
    buffer_load_dwordx4 v97, s[68:71], s65 offen offset:1024 lds
    v_add_u32 v98, 86496, v102
    v_cndmask_b32 v106, v104, v110, s[72:73]
    v_cndmask_b32 v107, v105, v110, s[72:73]
    v_mfma_f32_16x16x32_bf16 a[52:55], v[60:63], v[60:63], a[52:55]
    v_add_u32 v99, 105088, v9
    v_add_u32 v100, 109696, v9
    v_mfma_f32_16x16x32_bf16 a[56:59], v[64:67], v[64:67], a[56:59]
    v_cndmask_b32 v99, v99, v110, s[82:83]
    v_cndmask_b32 v100, v100, v110, s[82:83]
    v_lshlrev_b32_e64 v10, 2, v1
    v_and_b32 v10, 127, v10
    buffer_load_dword v253, v10, s[32:35], 0 offen sc1
    s_waitcnt vmcnt(11) lgkmcnt(0)
    s_barrier
    v_mfma_f32_16x16x32_bf16 a[0:3], v[32:35], v[68:71], a[0:3]
    ds_read_b64_tr_b16 v[16:17], v98 offset:0
    ds_read_b64_tr_b16 v[18:19], v98 offset:144
    v_mfma_f32_16x16x32_bf16 a[4:7], v[32:35], v[72:75], a[4:7]
    ds_read_b128 v[48:51], v106 offset:0
    ds_read_b128 v[52:55], v104 offset:2048
    v_mfma_f32_16x16x32_bf16 a[8:11], v[32:35], v[76:79], a[8:11]
    ds_read_b128 v[56:59], v104 offset:4096
    ds_read_b128 v[60:63], v104 offset:6144
    v_mfma_f32_16x16x32_bf16 a[12:15], v[32:35], v[80:83], a[12:15]
    ds_read_b128 v[64:67], v104 offset:8192
    ds_read_b64_tr_b16 v[20:21], v99 offset:0
    v_mfma_f32_16x16x32_bf16 a[16:19], v[32:35], v[84:87], a[16:19]
    ds_read_b64_tr_b16 v[22:23], v99 offset:144
    buffer_load_dword v255, v190, s[12:15], s74 offen
    v_mfma_f32_16x16x32_bf16 a[20:23], v[36:39], v[68:71], a[20:23]
    v_mad_u32_u24 v249, v249, 36, v250
    v_mad_u32_u24 v237, v249, s66, v248
    v_mfma_f32_16x16x32_bf16 a[24:27], v[36:39], v[72:75], a[24:27]
    s_add_u32 s67, s67, 256
    v_mfma_f32_16x16x32_bf16 a[28:31], v[36:39], v[76:79], a[28:31]
    v_add_u32 v246, s67, v1
    v_lshlrev_b32 v248, 4, v246
    v_mfma_f32_16x16x32_bf16 a[32:35], v[36:39], v[80:83], a[32:35]
    v_mul_u32_u24 v247, 7282, v246
    v_mfma_f32_16x16x32_bf16 a[36:39], v[36:39], v[84:87], a[36:39]
    v_lshrrev_b32_e64 v247, 16, v247
    v_mfma_f32_16x16x32_bf16 a[40:43], v[68:71], v[68:71], a[40:43]
    v_mad_i32_i24 v248, v247, s51, v248
    v_lshrrev_b32_e64 v249, 3, v247
    v_mfma_f32_16x16x32_bf16 a[44:47], v[72:75], v[72:75], a[44:47]
    v_and_b32_e64 v250, 1, v247
    v_mfma_f32_16x16x32_bf16 a[48:51], v[76:79], v[76:79], a[48:51]
    v_lshl_or_b32 v249, v249, 1, v250
    v_bfe_u32 v250, v247, 1, 2
    v_mfma_f32_16x16x32_bf16 a[52:55], v[80:83], v[80:83], a[52:55]
    v_or_b32_e64 v250, 16, v250
    v_mfma_f32_16x16x32_bf16 a[56:59], v[84:87], v[84:87], a[56:59]
    v_mad_u32_u24 v249, v249, 36, v250
    s_waitcnt lgkmcnt(0)
    v_mfma_f32_16x16x32_bf16 a[0:3], v[16:19], v[48:51], a[0:3]
    ds_read_b64_tr_b16 v[32:33], v98 offset:4608
    ds_read_b64_tr_b16 v[34:35], v98 offset:4752
    v_mfma_f32_16x16x32_bf16 a[4:7], v[16:19], v[52:55], a[4:7]
    ds_read_b128 v[68:71], v107 offset:0
    ds_read_b128 v[72:75], v105 offset:2048
    v_mfma_f32_16x16x32_bf16 a[8:11], v[16:19], v[56:59], a[8:11]
    ds_read_b128 v[76:79], v105 offset:4096
    ds_read_b128 v[80:83], v105 offset:6144
    v_mfma_f32_16x16x32_bf16 a[12:15], v[16:19], v[60:63], a[12:15]
    ds_read_b128 v[84:87], v105 offset:8192
    ds_read_b64_tr_b16 v[36:37], v100 offset:0
    v_mfma_f32_16x16x32_bf16 a[16:19], v[16:19], v[64:67], a[16:19]
    ds_read_b64_tr_b16 v[38:39], v100 offset:144
    buffer_load_dword v255, v190, s[12:15], s74 offen offset:140
    v_mfma_f32_16x16x32_bf16 a[20:23], v[20:23], v[48:51], a[20:23]
    v_mad_u32_u24 v238, v249, s66, v248
    v_add_u32 v246, 512, v1
    v_add_u32 v248, 8192, v2
    v_mfma_f32_16x16x32_bf16 a[24:27], v[20:23], v[52:55], a[24:27]
    v_mul_u32_u24 v247, 7282, v246
    v_lshrrev_b32 v247, 16, v247
    v_mfma_f32_16x16x32_bf16 a[28:31], v[20:23], v[56:59], a[28:31]
    v_mad_i32_i24 v248, v247, s51, v248
    v_lshrrev_b32 v249, 3, v247
    v_and_b32 v250, 1, v247
    v_mfma_f32_16x16x32_bf16 a[32:35], v[20:23], v[60:63], a[32:35]
    v_lshl_or_b32 v249, v249, 1, v250
    v_bfe_u32 v250, v247, 1, 2
    v_mfma_f32_16x16x32_bf16 a[36:39], v[20:23], v[64:67], a[36:39]
    v_or_b32_e64 v250, 16, v250
    v_mad_u32_u24 v249, v249, 36, v250
    v_mfma_f32_16x16x32_bf16 a[40:43], v[48:51], v[48:51], a[40:43]
    v_mad_u32_u24 v239, v249, s66, v248
    s_mov_b32 s6, 2359296
    s_mov_b32 s7, 0x20000
    v_mfma_f32_16x16x32_bf16 a[44:47], v[52:55], v[52:55], a[44:47]
    v_add_u32 v104, 152144, v108
    v_add_u32 v105, 152144, v109
    v_mfma_f32_16x16x32_bf16 a[48:51], v[56:59], v[56:59], a[48:51]
    v_add_u32 v98, 124448, v102
    v_cndmask_b32 v106, v104, v110, s[72:73]
    v_cndmask_b32 v107, v105, v110, s[72:73]
    v_mfma_f32_16x16x32_bf16 a[52:55], v[60:63], v[60:63], a[52:55]
    v_add_u32 v99, 143040, v9
    v_add_u32 v100, 147648, v9
    v_mfma_f32_16x16x32_bf16 a[56:59], v[64:67], v[64:67], a[56:59]
    v_cndmask_b32 v99, v99, v110, s[82:83]
    v_cndmask_b32 v100, v100, v110, s[82:83]
    s_waitcnt vmcnt(2) lgkmcnt(0)
    s_barrier
    v_mfma_f32_16x16x32_bf16 a[0:3], v[32:35], v[68:71], a[0:3]
    ds_read_b64_tr_b16 v[16:17], v98 offset:0
    ds_read_b64_tr_b16 v[18:19], v98 offset:144
    v_mfma_f32_16x16x32_bf16 a[4:7], v[32:35], v[72:75], a[4:7]
    ds_read_b128 v[48:51], v106 offset:0
    ds_read_b128 v[52:55], v104 offset:2048
    v_mfma_f32_16x16x32_bf16 a[8:11], v[32:35], v[76:79], a[8:11]
    ds_read_b128 v[56:59], v104 offset:4096
    ds_read_b128 v[60:63], v104 offset:6144
    v_mfma_f32_16x16x32_bf16 a[12:15], v[32:35], v[80:83], a[12:15]
    ds_read_b128 v[64:67], v104 offset:8192
    ds_read_b64_tr_b16 v[20:21], v99 offset:0
    v_mfma_f32_16x16x32_bf16 a[16:19], v[32:35], v[84:87], a[16:19]
    ds_read_b64_tr_b16 v[22:23], v99 offset:144
    buffer_load_dwordx4 a[128:131], v226, s[20:23], s79 offen
    v_mfma_f32_16x16x32_bf16 a[20:23], v[36:39], v[68:71], a[20:23]
    s_mov_b32 s30, 2359296
    s_mov_b32 s31, 0x20000
    v_mfma_f32_16x16x32_bf16 a[24:27], v[36:39], v[72:75], a[24:27]
    s_mov_b32 s42, 1152
    v_mfma_f32_16x16x32_bf16 a[28:31], v[36:39], v[76:79], a[28:31]
    s_mov_b32 s43, 0x20000
    s_lshl_b32 s47, s44, 2
    v_mfma_f32_16x16x32_bf16 a[32:35], v[36:39], v[80:83], a[32:35]
    s_add_u32 s47, s47, s46
    v_mfma_f32_16x16x32_bf16 a[36:39], v[36:39], v[84:87], a[36:39]
    buffer_load_dwordx4 a[144:147], v226, s[20:23], s79 offen offset:2304
    s_add_u32 s79, s79, 9216
    s_lshl_b32 s48, s44, 13
    v_mfma_f32_16x16x32_bf16 a[40:43], v[68:71], v[68:71], a[40:43]
    s_lshl_b32 s67, s46, 7
    s_add_u32 s48, s48, s67
    v_mfma_f32_16x16x32_bf16 a[44:47], v[72:75], v[72:75], a[44:47]
    v_min_u32 v254, 1, v1
    v_mfma_f32_16x16x32_bf16 a[48:51], v[76:79], v[76:79], a[48:51]
    v_lshlrev_b32 v254, 30, v254
    v_lshrrev_b32 v246, 4, v1
    v_mfma_f32_16x16x32_bf16 a[52:55], v[80:83], v[80:83], a[52:55]
    v_and_b32_e64 v247, 1, v246
    v_mfma_f32_16x16x32_bf16 a[56:59], v[84:87], v[84:87], a[56:59]
    v_mul_u32_u24 v248, 72, v246
    s_waitcnt lgkmcnt(0)
    v_mfma_f32_16x16x32_bf16 a[0:3], v[16:19], v[48:51], a[0:3]
    ds_read_b64_tr_b16 v[32:33], v98 offset:4608
    ds_read_b64_tr_b16 v[34:35], v98 offset:4752
    v_mfma_f32_16x16x32_bf16 a[4:7], v[16:19], v[52:55], a[4:7]
    ds_read_b128 v[68:71], v107 offset:0
    ds_read_b128 v[72:75], v105 offset:2048
    v_mfma_f32_16x16x32_bf16 a[8:11], v[16:19], v[56:59], a[8:11]
    ds_read_b128 v[76:79], v105 offset:4096
    ds_read_b128 v[80:83], v105 offset:6144
    v_mfma_f32_16x16x32_bf16 a[12:15], v[16:19], v[60:63], a[12:15]
    ds_read_b128 v[84:87], v105 offset:8192
    ds_read_b64_tr_b16 v[36:37], v100 offset:0
    v_mfma_f32_16x16x32_bf16 a[16:19], v[16:19], v[64:67], a[16:19]
    ds_read_b64_tr_b16 v[38:39], v100 offset:144
    buffer_load_dwordx4 a[132:135], v226, s[20:23], s79 offen
    v_mfma_f32_16x16x32_bf16 a[20:23], v[20:23], v[48:51], a[20:23]
    v_add_u32 v248, 86496, v248
    v_lshl_add_u32 v5, v247, 3, v248
    v_mfma_f32_16x16x32_bf16 a[24:27], v[20:23], v[52:55], a[24:27]
    v_xor_b32 v247, 1, v247
    v_mfma_f32_16x16x32_bf16 a[28:31], v[20:23], v[56:59], a[28:31]
    v_lshl_add_u32 v6, v247, 6, v248
    v_and_b32_e64 v247, 15, v1
    v_mfma_f32_16x16x32_bf16 a[32:35], v[20:23], v[60:63], a[32:35]
    s_lshl_b32 s67, s46, 4
    v_mfma_f32_16x16x32_bf16 a[36:39], v[20:23], v[64:67], a[36:39]
    buffer_load_dwordx4 a[148:151], v226, s[20:23], s79 offen offset:2304
    s_add_u32 s79, s79, 9216
    s_add_u32 s67, s67, 2
    v_add_u32_e64 v248, s67, v247
    v_mfma_f32_16x16x32_bf16 a[40:43], v[48:51], v[48:51], a[40:43]
    v_mul_u32_u24 v249, 288, v248
    v_mfma_f32_16x16x32_bf16 a[44:47], v[52:55], v[52:55], a[44:47]
    v_add_u32 v3, v5, v249
    v_add_u32 v4, v6, v249
    v_mfma_f32_16x16x32_bf16 a[48:51], v[56:59], v[56:59], a[48:51]
    v_lshlrev_b32_e64 v248, 3, v248
    v_mfma_f32_16x16x32_bf16 a[52:55], v[60:63], v[60:63], a[52:55]
    v_add_u32 v7, 162400, v248
    v_lshlrev_b32_e64 v247, 4, v247
    v_mfma_f32_16x16x32_bf16 a[56:59], v[64:67], v[64:67], a[56:59]
    v_lshl_add_u32 v8, v246, 2, v247
    s_waitcnt lgkmcnt(0)
    s_barrier
    v_and_b32_e64 v10, 15, v1
    v_mul_u32_u24 v11, 288, v10
    v_and_b32 v12, 16, v1
    v_lshrrev_b32 v13, 5, v1
    v_mul_u32_u24 v13, 23040, v13
    v_add3_u32 v11, v11, v12, v13
    v_add_u32 v11, 86752, v11
    v_lshlrev_b32_e64 v10, 3, v10
    v_add_u32 v10, 162400, v10
    s_mov_b32 s52, 0xaaaaaaaa
    s_mov_b32 s53, 0xaaaaaaaa
    v_mfma_f32_16x16x32_bf16 a[0:3], v[32:35], v[68:71], a[0:3]
    buffer_load_dwordx4 a[136:139], v226, s[20:23], s79 offen
    v_mfma_f32_16x16x32_bf16 a[4:7], v[32:35], v[72:75], a[4:7]
    buffer_load_dwordx4 a[152:155], v226, s[20:23], s79 offen offset:2304
    s_add_u32 s79, s79, 9216
    v_mfma_f32_16x16x32_bf16 a[8:11], v[32:35], v[76:79], a[8:11]
    v_mfma_f32_16x16x32_bf16 a[12:15], v[32:35], v[80:83], a[12:15]
    v_mfma_f32_16x16x32_bf16 a[16:19], v[32:35], v[84:87], a[16:19]
    v_mfma_f32_16x16x32_bf16 a[20:23], v[36:39], v[68:71], a[20:23]
    v_mfma_f32_16x16x32_bf16 a[24:27], v[36:39], v[72:75], a[24:27]
    v_mfma_f32_16x16x32_bf16 a[28:31], v[36:39], v[76:79], a[28:31]
    v_mfma_f32_16x16x32_bf16 a[32:35], v[36:39], v[80:83], a[32:35]
    v_mfma_f32_16x16x32_bf16 a[36:39], v[36:39], v[84:87], a[36:39]
    v_mfma_f32_16x16x32_bf16 a[40:43], v[68:71], v[68:71], a[40:43]
    ds_write_b128 v11, a[0:3] offset:0
    v_mfma_f32_16x16x32_bf16 a[44:47], v[72:75], v[72:75], a[44:47]
    ds_write_b128 v11, a[4:7] offset:4608
    v_mfma_f32_16x16x32_bf16 a[48:51], v[76:79], v[76:79], a[48:51]
    ds_write_b128 v11, a[8:11] offset:9216
    v_mfma_f32_16x16x32_bf16 a[52:55], v[80:83], v[80:83], a[52:55]
    ds_write_b128 v11, a[12:15] offset:13824
    v_mfma_f32_16x16x32_bf16 a[56:59], v[84:87], v[84:87], a[56:59]
    ds_write_b128 v11, a[16:19] offset:18432
    buffer_load_dwordx4 a[140:143], v226, s[20:23], s79 offen
    buffer_load_dwordx4 a[156:159], v226, s[20:23], s79 offen offset:2304
    s_mov_b32 exec_hi, 0
    ds_write_b128 v11, a[20:23] offset:46080
    ds_write_b128 v11, a[24:27] offset:50688
    ds_write_b128 v11, a[28:31] offset:55296
    ds_write_b128 v11, a[32:35] offset:59904
    ds_write_b128 v11, a[36:39] offset:64512
    s_mov_b32 exec_hi, -1
    s_add_u32 m0, s54, 0
    s_nop 0
    buffer_load_dwordx4 v228, s[12:15], s60 offen offset:0 lds
    buffer_load_dwordx4 v229, s[12:15], s60 offen offset:1024 lds
    v_accvgpr_read_b32 v116, a20
    v_accvgpr_read_b32 v117, a20
    v_accvgpr_read_b32 v124, a24
    v_accvgpr_read_b32 v125, a24
    v_accvgpr_read_b32 v132, a28
    v_accvgpr_read_b32 v133, a28
    v_accvgpr_read_b32 v140, a32
    v_accvgpr_read_b32 v141, a32
    v_accvgpr_read_b32 v148, a36
    v_accvgpr_read_b32 v149, a36
    v_accvgpr_read_b32 v112, a40
    v_accvgpr_read_b32 v113, a41
    v_accvgpr_read_b32 v114, a42
    v_accvgpr_read_b32 v115, a43
    v_accvgpr_read_b32 v120, a44
    v_accvgpr_read_b32 v121, a45
    v_accvgpr_read_b32 v122, a46
    v_accvgpr_read_b32 v123, a47
    v_accvgpr_read_b32 v128, a48
    v_accvgpr_read_b32 v129, a49
    v_accvgpr_read_b32 v130, a50
    v_accvgpr_read_b32 v131, a51
    v_accvgpr_read_b32 v136, a52
    v_accvgpr_read_b32 v137, a53
    v_accvgpr_read_b32 v138, a54
    v_accvgpr_read_b32 v139, a55
    v_accvgpr_read_b32 v144, a56
    v_accvgpr_read_b32 v145, a57
    v_accvgpr_read_b32 v146, a58
    v_accvgpr_read_b32 v147, a59
    v_permlane32_swap_b32 v116, v117
    v_permlane32_swap_b32 v124, v125
    v_permlane32_swap_b32 v132, v133
    v_permlane32_swap_b32 v140, v141
    v_permlane32_swap_b32 v148, v149
    v_cndmask_b32 v112, v112, v113, s[52:53]
    v_cndmask_b32 v114, v114, v115, s[52:53]
    v_mul_f32 v116, 0xbae38e39, v117
    v_cndmask_b32 v112, v112, v114, s[82:83]
    v_mul_f32 v112, 0x3ae38e39, v112
    v_fma_f32 v112, -v116, v116, v112
    v_max_f32 v112, 0, v112
L_pg13:
    s_cbranch_execz L_tourx
    v_add_f32 v112, 0x3727c5ac, v112
    v_rsq_f32 v117, v112
    v_cndmask_b32 v120, v120, v121, s[52:53]
    v_cndmask_b32 v122, v122, v123, s[52:53]
    v_mul_f32 v124, 0xbae38e39, v125
    v_cndmask_b32 v120, v120, v122, s[82:83]
    v_mul_f32 v120, 0x3ae38e39, v120
    v_fma_f32 v120, -v124, v124, v120
    v_max_f32_e64 v120, 0, v120
    v_add_f32 v120, 0x3727c5ac, v120
    v_rsq_f32_e64 v125, v120
    v_cndmask_b32 v128, v128, v129, s[52:53]
    v_cndmask_b32 v130, v130, v131, s[52:53]
    v_mul_f32 v132, 0xbae38e39, v133
    v_cndmask_b32 v128, v128, v130, s[82:83]
    v_mul_f32 v128, 0x3ae38e39, v128
    v_fma_f32 v128, -v132, v132, v128
    v_max_f32_e64 v128, 0, v128
    v_add_f32 v128, 0x3727c5ac, v128
    v_rsq_f32_e64 v133, v128
    v_cndmask_b32 v136, v136, v137, s[52:53]
    v_cndmask_b32 v138, v138, v139, s[52:53]
    v_mul_f32 v140, 0xbae38e39, v141
    v_cndmask_b32 v136, v136, v138, s[82:83]
    v_mul_f32 v136, 0x3ae38e39, v136
    v_fma_f32 v136, -v140, v140, v136
    v_max_f32_e64 v136, 0, v136
    v_add_f32 v136, 0x3727c5ac, v136
    v_rsq_f32_e64 v141, v136
    v_cndmask_b32 v144, v144, v145, s[52:53]
    v_cndmask_b32 v146, v146, v147, s[52:53]
    v_mul_f32 v148, 0xbae38e39, v149
    v_cndmask_b32 v144, v144, v146, s[82:83]
    v_mul_f32 v144, 0x3ae38e39, v144
    v_fma_f32 v144, -v148, v148, v144
    v_max_f32_e64 v144, 0, v144
    v_add_f32 v144, 0x3727c5ac, v144
    v_rsq_f32_e64 v149, v144
    s_mov_b32 exec_lo, 0x00f0000f
    s_mov_b32 exec_hi, 0xf0000f00
    ds_write_b64 v10, v[116:117] offset:0
    ds_write_b64 v10, v[124:125] offset:128
    ds_write_b64 v10, v[132:133] offset:256
    ds_write_b64 v10, v[140:141] offset:384
    ds_write_b64 v10, v[148:149] offset:512
    s_mov_b64 exec, -1
    v_cmp_gt_u32 vcc, 1, v253
    s_cbranch_vccz L_rdyok
    v_lshlrev_b32 v10, 2, v1
    s_mov_b32 s49, 0
    s_mov_b32 exec_lo, 0xffffffff
    s_mov_b32 exec_hi, 0
poll_17:
    buffer_load_dword v11, v10, s[32:35], 0 offen sc1
    s_add_u32 s49, s49, 1
    s_waitcnt vmcnt(0)
    v_cmp_gt_u32 vcc, 1, v11
    s_cmp_lt_u32 s49, 262144
    s_cbranch_scc0 pout_18
    s_cbranch_vccnz poll_17
pout_18:
    s_mov_b64 exec, -1
L_rdyok:
    buffer_load_dwordx4 v230, s[12:15], s60 offen offset:2048 lds
    s_mov_b32 s67, m0
    s_mov_b32 m0, 81920
    s_nop 0
    buffer_load_dwordx4 v239, s[12:15], s55 offen lds
    s_mov_b32 m0, s67
    s_branch L_join
L_end:
.section .rodata,"a"
.p2align 6
.amdhsa_kernel sequential_preLN__sliding_local_dilated__dense_activation_gelu__prompt_kernel
  .amdhsa_next_free_vgpr 512
  .amdhsa_next_free_sgpr 102
  .amdhsa_accum_offset 256
  .amdhsa_group_segment_fixed_size 0
  .amdhsa_kernarg_size 88
  .amdhsa_user_sgpr_count 2
  .amdhsa_user_sgpr_kernarg_segment_ptr 1
  .amdhsa_system_sgpr_workgroup_id_x 1
  .amdhsa_float_denorm_mode_32 3
.end_amdhsa_kernel
```
